```python
import torch

def _softmax(x, axis=-1):
    return torch.softmax(x, dim=axis)
def _gelu(x):
    return torch.nn.functional.gelu(x, approximate="tanh")
def _silu(x):
    return torch.nn.functional.silu(x)
def _sigmoid(x):
    return torch.sigmoid(x)
def _layernorm(x, axis=-1, eps=1e-5):
    m = x.mean(dim=axis, keepdim=True)
    v = x.var(dim=axis, keepdim=True, unbiased=False)
    return (x - m) / torch.sqrt(v + eps)
def _scatter_add(tgt, idx, src, axis=0):
    return tgt.clone().index_add_(axis, idx, src)
def _segment_sum(src, seg, n):
    out = torch.zeros((n,) + src.shape[1:], dtype=src.dtype)
    return out.index_add_(0, seg, src)
def _pad(x, pw):
    flat = tuple(v for pair in reversed(pw) for v in pair)
    return torch.nn.functional.pad(x, flat)

kernel_name = 'gated_mix__linear_kernel_hedgehog__softmax_full_mha__prompt'

def setup_inputs():

    _w = (lambda a: (lambda t: t.to(torch.bfloat16) if t.is_floating_point() else t)(torch.as_tensor(a)))
    def _A_setup():
        B, S, D, H = 1, 2048, 640, 32
        Dh = D // H
        return {
            "x": _w((lambda *s: torch.randn(*s, dtype=torch.bfloat16) * 0.05)(B, S, D)),
            "wqkv": _w((lambda *s: torch.randn(*s, dtype=torch.bfloat16) * 1.6)(D, 3 * D)),
            "w_phi": _w((lambda *s: torch.randn(*s, dtype=torch.bfloat16) * 1.6)(H, Dh, Dh) * (Dh ** -0.5)),
            "wo": _w((lambda *s: torch.randn(*s, dtype=torch.bfloat16) * 0.05)(D, D)),
        }
    _A_in = _A_setup()

    def _B_setup():
        B, S, D = 1, 2048, 640
        return {
            "x": _w((lambda *s: torch.randn(*s, dtype=torch.bfloat16) * 0.05)(B, S, D)),
            "wqkv": _w((lambda *s: torch.randn(*s, dtype=torch.bfloat16) * 0.8)(D, 3 * D)),
            "wo": _w((lambda *s: torch.randn(*s, dtype=torch.bfloat16) * 0.05)(D, D)),
        }
    _B_in = _B_setup()

    return {
        "A_x": _A_in["x"],
        "A_wqkv": _A_in["wqkv"],
        "A_w_phi": _A_in["w_phi"],
        "A_wo": _A_in["wo"],
        "B_x": _B_in["x"],
        "B_wqkv": _B_in["wqkv"],
        "B_wo": _B_in["wo"],
        "gate_w": _w((lambda *s: torch.randn(*s, dtype=torch.bfloat16) * 0.05)(640) * 16.0),
    }

def reference(A_x, A_wqkv, A_w_phi, A_wo, B_x, B_wqkv, B_wo, gate_w):
    def _A_ref(x, wqkv, w_phi, wo):
        B, S, D = x.shape
        H = 32; Dh = D // H
        qkv = (lambda x, *d: x.permute(*d))((x @ wqkv).reshape(B, S, 3, H, Dh), 2, 0, 3, 1, 4)
        q, k, v = qkv[0], qkv[1], qkv[2]
        pq = torch.einsum("bhsd,hdf->bhsf", q, w_phi)
        pk = torch.einsum("bhsd,hdf->bhsf", k, w_phi)
        phi_q = torch.concatenate([_softmax(pq, axis=-1), _softmax(-pq, axis=-1)], axis=-1)
        phi_k = torch.concatenate([_softmax(pk, axis=-1), _softmax(-pk, axis=-1)], axis=-1)
        kv = torch.einsum("bhsf,bhsd->bhfd", phi_k, v)
        z  = torch.einsum("bhsf->bhf", phi_k)
        num = torch.einsum("bhqf,bhfd->bhqd", phi_q, kv)
        den = torch.einsum("bhqf,bhf->bhq", phi_q, z)[..., None] + 1e-6
        o = num / den
        return (lambda x, *d: x.permute(*d))(o, 0, 2, 1, 3).reshape(B, S, D) @ wo

    def _B_ref(x, wqkv, wo):
        B, S, D = x.shape
        H = 32; Dh = D // H
        qkv = (lambda x, *d: x.permute(*d))((x @ wqkv).reshape(B, S, 3, H, Dh), 2, 0, 3, 1, 4)
        q, k, v = qkv[0], qkv[1], qkv[2]
        scale = Dh ** -0.5
        scores = torch.einsum("bhqd,bhkd->bhqk", q, k) * scale
        p = _softmax(scores, axis=-1)
        o = torch.einsum("bhqk,bhkd->bhqd", p, v)
        return (lambda x, *d: x.permute(*d))(o, 0, 2, 1, 3).reshape(B, S, D) @ wo

    x = A_x
    g = _sigmoid((x * gate_w).sum(-1, keepdims=True))
    a = _A_ref(x, A_wqkv, A_w_phi, A_wo)
    b = _B_ref(x, B_wqkv, B_wo)
    return g * a + (1 - g) * b
```

```asm
; @launch grid=(256,1,1) block=(512,1,1) lds=163840
.amdgcn_target "amdgcn-amd-amdhsa--gfx950"
.text
.globl gated_mix__linear_kernel_hedgehog__softmax_full_mha__prompt_kernel
.p2align 8
.type gated_mix__linear_kernel_hedgehog__softmax_full_mha__prompt_kernel,@function
gated_mix__linear_kernel_hedgehog__softmax_full_mha__prompt_kernel:

    s_cmp_ge_u32 s2, 256
    s_cbranch_scc1 L_end
    s_load_dwordx16 s[36:51], s[0:1], 0
    s_load_dwordx4 s[52:55], s[0:1], 64
    s_load_dwordx2 s[6:7], s[0:1], 80
    s_getpc_b64 s[4:5]
    v_lshlrev_b32 v1, 7, v0
    v_min_u32 v1, L_code_end - gated_mix__linear_kernel_hedgehog__softmax_full_mha__prompt_kernel - 64, v1
    global_load_dword v22, v1, s[4:5]
    v_lshrrev_b32 v1, 6, v0
    v_and_b32 v2, 63, v0
    s_and_b32 s19, s2, 7
    v_readfirstlane_b32 s3, v1
    s_lshr_b32 s20, s2, 3
    s_and_b32 s21, s19, 1
    s_lshl_b32 s21, s21, 3
    s_and_b32 s25, s20, 7
    s_add_u32 s21, s21, s25
    s_lshr_b32 s18, s19, 1
    s_lshl_b32 s18, s18, 2
    s_lshr_b32 s25, s20, 3
    s_add_u32 s18, s18, s25
    v_and_b32 v3, 15, v2
    v_lshrrev_b32 v4, 4, v2
    s_and_b32 s29, s3, 3
    s_lshr_b32 s30, s3, 2

    v_lshrrev_b32 v8, 3, v2
    v_and_b32 v9, 7, v2
    v_lshrrev_b32 v10, 1, v8
    v_xor_b32 v9, v9, v10
    s_lshl_b32 s24, s21, 7
    s_lshl_b32 s25, s3, 4
    s_add_u32 s25, s25, s24
    v_add_u32 v8, s25, v8
    v_mul_u32_u24 v8, 1280, v8
    v_lshl_add_u32 v5, v9, 4, v8
    v_xor_b32 v9, 4, v9
    v_lshl_add_u32 v6, v9, 4, v8
    v_add_u32 v6, 10240, v6

    s_and_b32 s25, s3, 1
    s_lshl_b32 s25, s25, 2
    v_or_b32 v8, s25, v4
    v_lshrrev_b32 v9, 1, v3
    v_xor_b32 v8, v8, v9
    v_lshlrev_b32 v8, 5, v8
    v_and_b32 v9, 1, v3
    v_lshl_add_u32 v8, v9, 4, v8
    s_lshl_b32 s25, s3, 3
    v_add_u32 v7, s25, v4
    v_mul_u32_u24 v7, 3840, v7
    v_add_u32 v7, v7, v8
    s_lshl_b32 s25, s18, 8
    v_add_u32 v7, s25, v7
    s_lshl_b32 s28, s3, 11
    s_waitcnt lgkmcnt(0)

    s_mov_b32 s56, s36
    s_mov_b32 s57, s37
    s_mov_b32 s58, 2621440
    s_mov_b32 s59, 0x00020000
    s_mov_b32 s60, s46
    s_mov_b32 s61, s47
    s_mov_b32 s62, 2457600
    s_mov_b32 s63, 0x00020000
    s_lshr_b32 s25, s3, 1
    s_mov_b32 s32, s36
    s_mov_b32 s33, s37
    s_mov_b32 s34, 2621440
    s_mov_b32 s45, 40
    s_cmp_eq_u32 s25, 1
    s_cselect_b32 s32, s46, s32
    s_cselect_b32 s33, s47, s33
    s_cmp_eq_u32 s25, 2
    s_cselect_b32 s32, s38, s32
    s_cselect_b32 s33, s39, s33
    s_cmp_ge_u32 s25, 1
    s_cselect_b32 s34, 2457600, s34
    s_cselect_b32 s45, 38, s45
    s_and_b32 s26, s3, 1
    s_lshl_b32 s44, s2, 1
    s_add_u32 s26, s26, s44
    s_cmp_eq_u32 s3, 6
    s_cselect_b32 s32, s42, s32
    s_cselect_b32 s33, s43, s33
    s_cmp_eq_u32 s3, 7
    s_cselect_b32 s32, s48, s32
    s_cselect_b32 s33, s49, s33
    s_cmp_ge_u32 s3, 6
    s_cselect_b32 s34, 819200, s34
    s_cselect_b32 s45, 25, s45
    s_cselect_b32 s26, s2, s26
    s_mov_b32 s35, 0x00020000
    s_mul_i32 s44, s26, s45
    s_lshl_b32 s44, s44, 7
    s_sub_u32 s45, s45, 1
    v_min_u32 v1, s45, v2
    v_lshlrev_b32 v1, 7, v1

    s_cmp_lt_u32 s3, 4
    s_cbranch_scc0 L_lt_1
    buffer_load_dword v23, v1, s[32:35], s44 offen
L_lt_1:
    s_cmp_eq_u32 s18, 15
    s_cbranch_scc1 L_p1_gate0

    s_add_u32 m0, s28, 0
    s_mov_b32 s26, 0
    buffer_load_dwordx4 v7, s[60:63], s26 offen lds
    s_add_u32 m0, s28, 1024
    s_mov_b32 s26, 15360
    buffer_load_dwordx4 v7, s[60:63], s26 offen lds
    s_add_u32 m0, s28, 16384
    s_mov_b32 s26, 0
    buffer_load_dwordx4 v5, s[56:59], s26 offen lds
    s_add_u32 m0, s28, 17408
    s_mov_b32 s26, 0
    buffer_load_dwordx4 v6, s[56:59], s26 offen lds
    s_add_u32 m0, s28, 32768
    s_mov_b32 s26, 245760
    buffer_load_dwordx4 v7, s[60:63], s26 offen lds
    s_add_u32 m0, s28, 33792
    s_mov_b32 s26, 261120
    buffer_load_dwordx4 v7, s[60:63], s26 offen lds
    s_add_u32 m0, s28, 49152
    s_mov_b32 s26, 128
    buffer_load_dwordx4 v5, s[56:59], s26 offen lds
    s_add_u32 m0, s28, 50176
    s_mov_b32 s26, 128
    buffer_load_dwordx4 v6, s[56:59], s26 offen lds
    s_add_u32 m0, s28, 65536
    s_mov_b32 s26, 491520
    buffer_load_dwordx4 v7, s[60:63], s26 offen lds
    s_add_u32 m0, s28, 66560
    s_mov_b32 s26, 506880
    buffer_load_dwordx4 v7, s[60:63], s26 offen lds
    s_add_u32 m0, s28, 81920
    s_mov_b32 s26, 256
    buffer_load_dwordx4 v5, s[56:59], s26 offen lds
    s_add_u32 m0, s28, 82944
    s_mov_b32 s26, 256
    buffer_load_dwordx4 v6, s[56:59], s26 offen lds
L_p1_gate0:
    s_mov_b32 s8, s6
    s_mov_b32 s9, s7
    s_mov_b32 s10, 24289280
    s_mov_b32 s11, 0x00020000
    s_mov_b32 s12, s52
    s_mov_b32 s13, s53
    s_mov_b32 s14, 2621440
    s_mov_b32 s15, 0x00020000
    s_add_u32 s16, s6, 24240128
    s_addc_u32 s17, s7, 0
    s_mov_b32 s4, s54
    s_mov_b32 s5, s55

    s_cmp_eq_u32 s18, 15
    s_cbranch_scc1 L_p1_gate

    s_mul_i32 s22, s18, 52
    s_lshr_b32 s22, s22, 8
    s_mul_i32 s25, s22, 5
    s_sub_u32 s23, s18, s25
    s_lshl_b32 s23, s23, 7
    s_lshl_b32 s25, s30, 6
    s_add_u32 s23, s23, s25
    s_mul_i32 s31, s22, 2621440
    s_lshl_b32 s25, s29, 5
    s_add_u32 s24, s24, s25

    v_lshrrev_b32 v8, 2, v3
    v_and_b32 v9, 3, v3
    v_and_b32 v10, 1, v4
    v_lshl_or_b32 v10, v10, 2, v8
    v_lshl_add_u32 v11, v4, 3, v8
    v_lshlrev_b32 v11, 8, v11
    v_lshl_add_u32 v11, v9, 3, v11
    s_lshl_b32 s25, s30, 2
    v_xor_b32 v10, s25, v10

    v_xor_b32 v12, 0, v10
    v_lshl_add_u32 v16, v12, 5, v11
    v_xor_b32 v12, 1, v10
    v_lshl_add_u32 v17, v12, 5, v11
    v_xor_b32 v12, 2, v10
    v_lshl_add_u32 v18, v12, 5, v11
    v_xor_b32 v12, 3, v10
    v_lshl_add_u32 v19, v12, 5, v11
    v_lshrrev_b32 v8, 1, v3
    v_xor_b32 v8, v8, v4
    v_lshlrev_b32 v9, 7, v3
    s_lshl_b32 s25, s29, 12
    v_add_u32 v9, s25, v9
    v_lshl_add_u32 v20, v8, 4, v9
    v_xor_b32 v8, 4, v8
    v_lshl_add_u32 v21, v8, 4, v9
    s_lshl_b32 s30, s18, 4
    s_add_u32 s30, s30, s21
    s_add_u32 s30, s30, 128
    s_lshl_b32 s30, s30, 7
    s_cmp_eq_u32 s22, 2
    s_cbranch_scc1 L_p1_ntype

    s_waitcnt vmcnt(8)
    s_barrier
    ds_read_b128 v[24:27], v20 offset:16384
    ds_read_b64_tr_b16 v[184:185], v16 offset:0
    ds_read_b64_tr_b16 v[186:187], v16 offset:1024
    ds_read_b128 v[28:31], v20 offset:18432
    ds_read_b64_tr_b16 v[188:189], v17 offset:0
    ds_read_b64_tr_b16 v[190:191], v17 offset:1024
    ds_read_b64_tr_b16 v[192:193], v18 offset:0
    ds_read_b64_tr_b16 v[194:195], v18 offset:1024
    ds_read_b64_tr_b16 v[196:197], v19 offset:0
    ds_read_b64_tr_b16 v[198:199], v19 offset:1024
    s_waitcnt lgkmcnt(0)
    ds_read_b128 v[32:35], v21 offset:16384
    ds_read_b64_tr_b16 v[200:201], v16 offset:8192
    v_mfma_f32_16x16x32_bf16 v[216:219], v[184:187], v[24:27], 0
    ds_read_b64_tr_b16 v[202:203], v16 offset:9216
    ds_read_b128 v[36:39], v21 offset:18432
    v_mfma_f32_16x16x32_bf16 v[220:223], v[184:187], v[28:31], 0
    s_add_u32 m0, s28, 98304
    s_mov_b32 s26, 737280
    buffer_load_dwordx4 v7, s[60:63], s26 offen lds
    ds_read_b64_tr_b16 v[204:205], v17 offset:8192
    ds_read_b64_tr_b16 v[206:207], v17 offset:9216
    v_mfma_f32_16x16x32_bf16 v[224:227], v[188:191], v[24:27], 0
    ds_read_b64_tr_b16 v[208:209], v18 offset:8192
    ds_read_b64_tr_b16 v[210:211], v18 offset:9216
    v_mfma_f32_16x16x32_bf16 v[228:231], v[188:191], v[28:31], 0
    s_add_u32 m0, s28, 99328
    s_mov_b32 s26, 752640
    buffer_load_dwordx4 v7, s[60:63], s26 offen lds
    ds_read_b64_tr_b16 v[212:213], v19 offset:8192
    ds_read_b64_tr_b16 v[214:215], v19 offset:9216
    v_mfma_f32_16x16x32_bf16 v[232:235], v[192:195], v[24:27], 0
    v_mfma_f32_16x16x32_bf16 v[236:239], v[192:195], v[28:31], 0
    s_add_u32 m0, s28, 114688
    s_mov_b32 s26, 384
    buffer_load_dwordx4 v5, s[56:59], s26 offen lds
    v_mfma_f32_16x16x32_bf16 v[240:243], v[196:199], v[24:27], 0
    v_mfma_f32_16x16x32_bf16 v[244:247], v[196:199], v[28:31], 0
    s_add_u32 m0, s28, 115712
    s_mov_b32 s26, 384
    buffer_load_dwordx4 v6, s[56:59], s26 offen lds
    s_waitcnt lgkmcnt(0)
    v_mfma_f32_16x16x32_bf16 v[216:219], v[200:203], v[32:35], v[216:219]
    v_mfma_f32_16x16x32_bf16 v[220:223], v[200:203], v[36:39], v[220:223]
    s_waitcnt vmcnt(8)
    s_barrier
    ds_read_b128 v[40:43], v20 offset:49152
    ds_read_b64_tr_b16 v[184:185], v16 offset:32768
    v_mfma_f32_16x16x32_bf16 v[224:227], v[204:207], v[32:35], v[224:227]
    ds_read_b64_tr_b16 v[186:187], v16 offset:33792
    ds_read_b128 v[44:47], v20 offset:51200
    v_mfma_f32_16x16x32_bf16 v[228:231], v[204:207], v[36:39], v[228:231]
    s_add_u32 m0, s28, 131072
    s_mov_b32 s26, 983040
    buffer_load_dwordx4 v7, s[60:63], s26 offen lds
    ds_read_b64_tr_b16 v[188:189], v17 offset:32768
    ds_read_b64_tr_b16 v[190:191], v17 offset:33792
    v_mfma_f32_16x16x32_bf16 v[232:235], v[208:211], v[32:35], v[232:235]
    ds_read_b64_tr_b16 v[192:193], v18 offset:32768
    ds_read_b64_tr_b16 v[194:195], v18 offset:33792
    v_mfma_f32_16x16x32_bf16 v[236:239], v[208:211], v[36:39], v[236:239]
    s_add_u32 m0, s28, 132096
    s_mov_b32 s26, 998400
    buffer_load_dwordx4 v7, s[60:63], s26 offen lds
    ds_read_b64_tr_b16 v[196:197], v19 offset:32768
    ds_read_b64_tr_b16 v[198:199], v19 offset:33792
    v_mfma_f32_16x16x32_bf16 v[240:243], v[212:215], v[32:35], v[240:243]
    v_mfma_f32_16x16x32_bf16 v[244:247], v[212:215], v[36:39], v[244:247]
    s_add_u32 m0, s28, 147456
    s_mov_b32 s26, 512
    buffer_load_dwordx4 v5, s[56:59], s26 offen lds
    s_waitcnt lgkmcnt(0)
    ds_read_b128 v[48:51], v21 offset:49152
    ds_read_b64_tr_b16 v[200:201], v16 offset:40960
    v_mfma_f32_16x16x32_bf16 v[216:219], v[184:187], v[40:43], v[216:219]
    ds_read_b64_tr_b16 v[202:203], v16 offset:41984
    ds_read_b128 v[52:55], v21 offset:51200
    v_mfma_f32_16x16x32_bf16 v[220:223], v[184:187], v[44:47], v[220:223]
    s_add_u32 m0, s28, 148480
    s_mov_b32 s26, 512
    buffer_load_dwordx4 v6, s[56:59], s26 offen lds
    ds_read_b64_tr_b16 v[204:205], v17 offset:40960
    ds_read_b64_tr_b16 v[206:207], v17 offset:41984
    v_mfma_f32_16x16x32_bf16 v[224:227], v[188:191], v[40:43], v[224:227]
    ds_read_b64_tr_b16 v[208:209], v18 offset:40960
    ds_read_b64_tr_b16 v[210:211], v18 offset:41984
    v_mfma_f32_16x16x32_bf16 v[228:231], v[188:191], v[44:47], v[228:231]
    s_add_u32 m0, s28, 0
    s_mov_b32 s26, 1228800
    buffer_load_dwordx4 v7, s[60:63], s26 offen lds
    ds_read_b64_tr_b16 v[212:213], v19 offset:40960
    ds_read_b64_tr_b16 v[214:215], v19 offset:41984
    v_mfma_f32_16x16x32_bf16 v[232:235], v[192:195], v[40:43], v[232:235]
    v_mfma_f32_16x16x32_bf16 v[236:239], v[192:195], v[44:47], v[236:239]
    s_add_u32 m0, s28, 1024
    s_mov_b32 s26, 1244160
    buffer_load_dwordx4 v7, s[60:63], s26 offen lds
    v_mfma_f32_16x16x32_bf16 v[240:243], v[196:199], v[40:43], v[240:243]
    v_mfma_f32_16x16x32_bf16 v[244:247], v[196:199], v[44:47], v[244:247]
    s_add_u32 m0, s28, 16384
    s_mov_b32 s26, 640
    buffer_load_dwordx4 v5, s[56:59], s26 offen lds
    s_waitcnt lgkmcnt(0)
    v_mfma_f32_16x16x32_bf16 v[216:219], v[200:203], v[48:51], v[216:219]
    v_mfma_f32_16x16x32_bf16 v[220:223], v[200:203], v[52:55], v[220:223]
    s_waitcnt vmcnt(11)
    s_barrier
    v_add_u32 v16, 65536, v16
    v_add_u32 v17, 65536, v17
    v_add_u32 v18, 65536, v18
    v_mfma_f32_16x16x32_bf16 v[224:227], v[204:207], v[48:51], v[224:227]
    v_add_u32 v19, 65536, v19
    v_add_u32 v20, 65536, v20
    v_add_u32 v21, 65536, v21
    v_mfma_f32_16x16x32_bf16 v[228:231], v[204:207], v[52:55], v[228:231]
    s_add_u32 m0, s28, 17408
    s_mov_b32 s26, 640
    buffer_load_dwordx4 v6, s[56:59], s26 offen lds
    ds_read_b128 v[56:59], v20 offset:16384
    ds_read_b64_tr_b16 v[184:185], v16 offset:0
    ds_read_b64_tr_b16 v[186:187], v16 offset:1024
    v_mfma_f32_16x16x32_bf16 v[232:235], v[208:211], v[48:51], v[232:235]
    ds_read_b128 v[60:63], v20 offset:18432
    ds_read_b64_tr_b16 v[188:189], v17 offset:0
    ds_read_b64_tr_b16 v[190:191], v17 offset:1024
    v_mfma_f32_16x16x32_bf16 v[236:239], v[208:211], v[52:55], v[236:239]
    s_add_u32 m0, s28, 32768
    s_mov_b32 s26, 1474560
    buffer_load_dwordx4 v7, s[60:63], s26 offen lds
    ds_read_b64_tr_b16 v[192:193], v18 offset:0
    ds_read_b64_tr_b16 v[194:195], v18 offset:1024
    ds_read_b64_tr_b16 v[196:197], v19 offset:0
    v_mfma_f32_16x16x32_bf16 v[240:243], v[212:215], v[48:51], v[240:243]
    ds_read_b64_tr_b16 v[198:199], v19 offset:1024
    v_mfma_f32_16x16x32_bf16 v[244:247], v[212:215], v[52:55], v[244:247]
    s_add_u32 m0, s28, 33792
    s_mov_b32 s26, 1489920
    buffer_load_dwordx4 v7, s[60:63], s26 offen lds
    s_waitcnt lgkmcnt(0)
    ds_read_b128 v[64:67], v21 offset:16384
    ds_read_b64_tr_b16 v[200:201], v16 offset:8192
    v_mfma_f32_16x16x32_bf16 v[216:219], v[184:187], v[56:59], v[216:219]
    ds_read_b64_tr_b16 v[202:203], v16 offset:9216
    ds_read_b128 v[68:71], v21 offset:18432
    v_mfma_f32_16x16x32_bf16 v[220:223], v[184:187], v[60:63], v[220:223]
    s_add_u32 m0, s28, 49152
    s_mov_b32 s26, 768
    buffer_load_dwordx4 v5, s[56:59], s26 offen lds
    ds_read_b64_tr_b16 v[204:205], v17 offset:8192
    ds_read_b64_tr_b16 v[206:207], v17 offset:9216
    v_mfma_f32_16x16x32_bf16 v[224:227], v[188:191], v[56:59], v[224:227]
    ds_read_b64_tr_b16 v[208:209], v18 offset:8192
    ds_read_b64_tr_b16 v[210:211], v18 offset:9216
    v_mfma_f32_16x16x32_bf16 v[228:231], v[188:191], v[60:63], v[228:231]
    s_add_u32 m0, s28, 50176
    s_mov_b32 s26, 768
    buffer_load_dwordx4 v6, s[56:59], s26 offen lds
    ds_read_b64_tr_b16 v[212:213], v19 offset:8192
    ds_read_b64_tr_b16 v[214:215], v19 offset:9216
    v_mfma_f32_16x16x32_bf16 v[232:235], v[192:195], v[56:59], v[232:235]
    v_mfma_f32_16x16x32_bf16 v[236:239], v[192:195], v[60:63], v[236:239]
    v_mfma_f32_16x16x32_bf16 v[240:243], v[196:199], v[56:59], v[240:243]
    v_mfma_f32_16x16x32_bf16 v[244:247], v[196:199], v[60:63], v[244:247]
    s_waitcnt lgkmcnt(0)
    v_mfma_f32_16x16x32_bf16 v[216:219], v[200:203], v[64:67], v[216:219]
    v_mfma_f32_16x16x32_bf16 v[220:223], v[200:203], v[68:71], v[220:223]
    s_waitcnt vmcnt(12)
    s_barrier
    ds_read_b128 v[72:75], v20 offset:49152
    ds_read_b64_tr_b16 v[184:185], v16 offset:32768
    v_mfma_f32_16x16x32_bf16 v[224:227], v[204:207], v[64:67], v[224:227]
    ds_read_b64_tr_b16 v[186:187], v16 offset:33792
    ds_read_b128 v[76:79], v20 offset:51200
    v_mfma_f32_16x16x32_bf16 v[228:231], v[204:207], v[68:71], v[228:231]
    s_add_u32 m0, s28, 65536
    s_mov_b32 s26, 1720320
    buffer_load_dwordx4 v7, s[60:63], s26 offen lds
    ds_read_b64_tr_b16 v[188:189], v17 offset:32768
    ds_read_b64_tr_b16 v[190:191], v17 offset:33792
    v_mfma_f32_16x16x32_bf16 v[232:235], v[208:211], v[64:67], v[232:235]
    ds_read_b64_tr_b16 v[192:193], v18 offset:32768
    ds_read_b64_tr_b16 v[194:195], v18 offset:33792
    v_mfma_f32_16x16x32_bf16 v[236:239], v[208:211], v[68:71], v[236:239]
    s_add_u32 m0, s28, 66560
    s_mov_b32 s26, 1735680
    buffer_load_dwordx4 v7, s[60:63], s26 offen lds
    ds_read_b64_tr_b16 v[196:197], v19 offset:32768
    ds_read_b64_tr_b16 v[198:199], v19 offset:33792
    v_mfma_f32_16x16x32_bf16 v[240:243], v[212:215], v[64:67], v[240:243]
    v_mfma_f32_16x16x32_bf16 v[244:247], v[212:215], v[68:71], v[244:247]
    s_add_u32 m0, s28, 81920
    s_mov_b32 s26, 896
    buffer_load_dwordx4 v5, s[56:59], s26 offen lds
    s_waitcnt lgkmcnt(0)
    ds_read_b128 v[80:83], v21 offset:49152
    ds_read_b64_tr_b16 v[200:201], v16 offset:40960
    v_mfma_f32_16x16x32_bf16 v[216:219], v[184:187], v[72:75], v[216:219]
    ds_read_b64_tr_b16 v[202:203], v16 offset:41984
    ds_read_b128 v[84:87], v21 offset:51200
    v_mfma_f32_16x16x32_bf16 v[220:223], v[184:187], v[76:79], v[220:223]
    s_add_u32 m0, s28, 82944
    s_mov_b32 s26, 896
    buffer_load_dwordx4 v6, s[56:59], s26 offen lds
    ds_read_b64_tr_b16 v[204:205], v17 offset:40960
    ds_read_b64_tr_b16 v[206:207], v17 offset:41984
    v_mfma_f32_16x16x32_bf16 v[224:227], v[188:191], v[72:75], v[224:227]
    ds_read_b64_tr_b16 v[208:209], v18 offset:40960
    ds_read_b64_tr_b16 v[210:211], v18 offset:41984
    v_mfma_f32_16x16x32_bf16 v[228:231], v[188:191], v[76:79], v[228:231]
    ds_read_b64_tr_b16 v[212:213], v19 offset:40960
    ds_read_b64_tr_b16 v[214:215], v19 offset:41984
    v_mfma_f32_16x16x32_bf16 v[232:235], v[192:195], v[72:75], v[232:235]
    v_mfma_f32_16x16x32_bf16 v[236:239], v[192:195], v[76:79], v[236:239]
    v_mfma_f32_16x16x32_bf16 v[240:243], v[196:199], v[72:75], v[240:243]
    v_mfma_f32_16x16x32_bf16 v[244:247], v[196:199], v[76:79], v[244:247]
    s_waitcnt lgkmcnt(0)
    v_mfma_f32_16x16x32_bf16 v[216:219], v[200:203], v[80:83], v[216:219]
    v_mfma_f32_16x16x32_bf16 v[220:223], v[200:203], v[84:87], v[220:223]
    s_waitcnt vmcnt(12)
    s_barrier
    v_add_u32 v16, 65536, v16
    v_add_u32 v17, 65536, v17
    v_add_u32 v18, 65536, v18
    v_mfma_f32_16x16x32_bf16 v[224:227], v[204:207], v[80:83], v[224:227]
    v_add_u32 v19, 65536, v19
    v_add_u32 v20, 65536, v20
    v_add_u32 v21, 65536, v21
    v_mfma_f32_16x16x32_bf16 v[228:231], v[204:207], v[84:87], v[228:231]
    s_add_u32 m0, s28, 98304
    s_mov_b32 s26, 1966080
    buffer_load_dwordx4 v7, s[60:63], s26 offen lds
    ds_read_b128 v[88:91], v20 offset:16384
    ds_read_b64_tr_b16 v[184:185], v16 offset:0
    ds_read_b64_tr_b16 v[186:187], v16 offset:1024
    v_mfma_f32_16x16x32_bf16 v[232:235], v[208:211], v[80:83], v[232:235]
    ds_read_b128 v[92:95], v20 offset:18432
    ds_read_b64_tr_b16 v[188:189], v17 offset:0
    ds_read_b64_tr_b16 v[190:191], v17 offset:1024
    v_mfma_f32_16x16x32_bf16 v[236:239], v[208:211], v[84:87], v[236:239]
    s_add_u32 m0, s28, 99328
    s_mov_b32 s26, 1981440
    buffer_load_dwordx4 v7, s[60:63], s26 offen lds
    ds_read_b64_tr_b16 v[192:193], v18 offset:0
    ds_read_b64_tr_b16 v[194:195], v18 offset:1024
    ds_read_b64_tr_b16 v[196:197], v19 offset:0
    v_mfma_f32_16x16x32_bf16 v[240:243], v[212:215], v[80:83], v[240:243]
    ds_read_b64_tr_b16 v[198:199], v19 offset:1024
    v_mfma_f32_16x16x32_bf16 v[244:247], v[212:215], v[84:87], v[244:247]
    s_add_u32 m0, s28, 114688
    s_mov_b32 s26, 1024
    buffer_load_dwordx4 v5, s[56:59], s26 offen lds
    s_waitcnt lgkmcnt(0)
    ds_read_b128 v[96:99], v21 offset:16384
    ds_read_b64_tr_b16 v[200:201], v16 offset:8192
    v_mfma_f32_16x16x32_bf16 v[216:219], v[184:187], v[88:91], v[216:219]
    ds_read_b64_tr_b16 v[202:203], v16 offset:9216
    ds_read_b128 v[100:103], v21 offset:18432
    v_mfma_f32_16x16x32_bf16 v[220:223], v[184:187], v[92:95], v[220:223]
    s_add_u32 m0, s28, 115712
    s_mov_b32 s26, 1024
    buffer_load_dwordx4 v6, s[56:59], s26 offen lds
    ds_read_b64_tr_b16 v[204:205], v17 offset:8192
    ds_read_b64_tr_b16 v[206:207], v17 offset:9216
    v_mfma_f32_16x16x32_bf16 v[224:227], v[188:191], v[88:91], v[224:227]
    ds_read_b64_tr_b16 v[208:209], v18 offset:8192
    ds_read_b64_tr_b16 v[210:211], v18 offset:9216
    v_mfma_f32_16x16x32_bf16 v[228:231], v[188:191], v[92:95], v[228:231]
    ds_read_b64_tr_b16 v[212:213], v19 offset:8192
    ds_read_b64_tr_b16 v[214:215], v19 offset:9216
    v_mfma_f32_16x16x32_bf16 v[232:235], v[192:195], v[88:91], v[232:235]
    v_mfma_f32_16x16x32_bf16 v[236:239], v[192:195], v[92:95], v[236:239]
    v_mfma_f32_16x16x32_bf16 v[240:243], v[196:199], v[88:91], v[240:243]
    v_mfma_f32_16x16x32_bf16 v[244:247], v[196:199], v[92:95], v[244:247]
    s_waitcnt lgkmcnt(0)
    v_mfma_f32_16x16x32_bf16 v[216:219], v[200:203], v[96:99], v[216:219]
    v_mfma_f32_16x16x32_bf16 v[220:223], v[200:203], v[100:103], v[220:223]
    s_waitcnt vmcnt(12)
    s_barrier
    v_add_u32 v16, 4294836224, v16
    v_add_u32 v17, 4294836224, v17
    v_add_u32 v18, 4294836224, v18
    v_mfma_f32_16x16x32_bf16 v[224:227], v[204:207], v[96:99], v[224:227]
    v_add_u32 v19, 4294836224, v19
    v_add_u32 v20, 4294836224, v20
    v_add_u32 v21, 4294836224, v21
    v_mfma_f32_16x16x32_bf16 v[228:231], v[204:207], v[100:103], v[228:231]
    s_add_u32 m0, s28, 131072
    s_mov_b32 s26, 2211840
    buffer_load_dwordx4 v7, s[60:63], s26 offen lds
    ds_read_b128 v[104:107], v20 offset:16384
    ds_read_b64_tr_b16 v[184:185], v16 offset:0
    ds_read_b64_tr_b16 v[186:187], v16 offset:1024
    v_mfma_f32_16x16x32_bf16 v[232:235], v[208:211], v[96:99], v[232:235]
    ds_read_b128 v[108:111], v20 offset:18432
    ds_read_b64_tr_b16 v[188:189], v17 offset:0
    ds_read_b64_tr_b16 v[190:191], v17 offset:1024
    v_mfma_f32_16x16x32_bf16 v[236:239], v[208:211], v[100:103], v[236:239]
    s_add_u32 m0, s28, 132096
    s_mov_b32 s26, 2227200
    buffer_load_dwordx4 v7, s[60:63], s26 offen lds
    ds_read_b64_tr_b16 v[192:193], v18 offset:0
    ds_read_b64_tr_b16 v[194:195], v18 offset:1024
    ds_read_b64_tr_b16 v[196:197], v19 offset:0
    v_mfma_f32_16x16x32_bf16 v[240:243], v[212:215], v[96:99], v[240:243]
    ds_read_b64_tr_b16 v[198:199], v19 offset:1024
    v_mfma_f32_16x16x32_bf16 v[244:247], v[212:215], v[100:103], v[244:247]
    s_add_u32 m0, s28, 147456
    s_mov_b32 s26, 1152
    buffer_load_dwordx4 v5, s[56:59], s26 offen lds
    s_waitcnt lgkmcnt(0)
    s_cmp_ge_u32 s3, 4
    s_cbranch_scc0 L_lt_2
    buffer_load_dword v23, v1, s[32:35], s44 offen
L_lt_2:
    ds_read_b128 v[112:115], v21 offset:16384
    ds_read_b64_tr_b16 v[200:201], v16 offset:8192
    v_mfma_f32_16x16x32_bf16 v[216:219], v[184:187], v[104:107], v[216:219]
    ds_read_b64_tr_b16 v[202:203], v16 offset:9216
    ds_read_b128 v[116:119], v21 offset:18432
    v_mfma_f32_16x16x32_bf16 v[220:223], v[184:187], v[108:111], v[220:223]
    s_add_u32 m0, s28, 148480
    s_mov_b32 s26, 1152
    buffer_load_dwordx4 v6, s[56:59], s26 offen lds
    ds_read_b64_tr_b16 v[204:205], v17 offset:8192
    ds_read_b64_tr_b16 v[206:207], v17 offset:9216
    v_mfma_f32_16x16x32_bf16 v[224:227], v[188:191], v[104:107], v[224:227]
    ds_read_b64_tr_b16 v[208:209], v18 offset:8192
    ds_read_b64_tr_b16 v[210:211], v18 offset:9216
    v_mfma_f32_16x16x32_bf16 v[228:231], v[188:191], v[108:111], v[228:231]
    ds_read_b64_tr_b16 v[212:213], v19 offset:8192
    ds_read_b64_tr_b16 v[214:215], v19 offset:9216
    v_mfma_f32_16x16x32_bf16 v[232:235], v[192:195], v[104:107], v[232:235]
    v_mfma_f32_16x16x32_bf16 v[236:239], v[192:195], v[108:111], v[236:239]
    v_mfma_f32_16x16x32_bf16 v[240:243], v[196:199], v[104:107], v[240:243]
    v_mfma_f32_16x16x32_bf16 v[244:247], v[196:199], v[108:111], v[244:247]
    s_waitcnt lgkmcnt(0)
    v_mfma_f32_16x16x32_bf16 v[216:219], v[200:203], v[112:115], v[216:219]
    v_mfma_f32_16x16x32_bf16 v[220:223], v[200:203], v[116:119], v[220:223]
    s_waitcnt vmcnt(12)
    s_barrier
    ds_read_b128 v[120:123], v20 offset:49152
    ds_read_b64_tr_b16 v[184:185], v16 offset:32768
    v_mfma_f32_16x16x32_bf16 v[224:227], v[204:207], v[112:115], v[224:227]
    ds_read_b64_tr_b16 v[186:187], v16 offset:33792
    ds_read_b128 v[124:127], v20 offset:51200
    v_mfma_f32_16x16x32_bf16 v[228:231], v[204:207], v[116:119], v[228:231]
    ds_read_b64_tr_b16 v[188:189], v17 offset:32768
    ds_read_b64_tr_b16 v[190:191], v17 offset:33792
    v_mfma_f32_16x16x32_bf16 v[232:235], v[208:211], v[112:115], v[232:235]
    ds_read_b64_tr_b16 v[192:193], v18 offset:32768
    ds_read_b64_tr_b16 v[194:195], v18 offset:33792
    v_mfma_f32_16x16x32_bf16 v[236:239], v[208:211], v[116:119], v[236:239]
    ds_read_b64_tr_b16 v[196:197], v19 offset:32768
    ds_read_b64_tr_b16 v[198:199], v19 offset:33792
    v_mfma_f32_16x16x32_bf16 v[240:243], v[212:215], v[112:115], v[240:243]
    v_mfma_f32_16x16x32_bf16 v[244:247], v[212:215], v[116:119], v[244:247]
    s_waitcnt lgkmcnt(0)
    ds_read_b128 v[128:131], v21 offset:49152
    ds_read_b64_tr_b16 v[200:201], v16 offset:40960
    v_mfma_f32_16x16x32_bf16 v[216:219], v[184:187], v[120:123], v[216:219]
    ds_read_b64_tr_b16 v[202:203], v16 offset:41984
    ds_read_b128 v[132:135], v21 offset:51200
    v_mfma_f32_16x16x32_bf16 v[220:223], v[184:187], v[124:127], v[220:223]
    ds_read_b64_tr_b16 v[204:205], v17 offset:40960
    ds_read_b64_tr_b16 v[206:207], v17 offset:41984
    v_mfma_f32_16x16x32_bf16 v[224:227], v[188:191], v[120:123], v[224:227]
    ds_read_b64_tr_b16 v[208:209], v18 offset:40960
    ds_read_b64_tr_b16 v[210:211], v18 offset:41984
    v_mfma_f32_16x16x32_bf16 v[228:231], v[188:191], v[124:127], v[228:231]
    ds_read_b64_tr_b16 v[212:213], v19 offset:40960
    ds_read_b64_tr_b16 v[214:215], v19 offset:41984
    v_mfma_f32_16x16x32_bf16 v[232:235], v[192:195], v[120:123], v[232:235]
    v_mfma_f32_16x16x32_bf16 v[236:239], v[192:195], v[124:127], v[236:239]
    v_mfma_f32_16x16x32_bf16 v[240:243], v[196:199], v[120:123], v[240:243]
    v_mfma_f32_16x16x32_bf16 v[244:247], v[196:199], v[124:127], v[244:247]
    s_waitcnt lgkmcnt(0)
    v_mfma_f32_16x16x32_bf16 v[216:219], v[200:203], v[128:131], v[216:219]
    v_mfma_f32_16x16x32_bf16 v[220:223], v[200:203], v[132:135], v[220:223]
    s_waitcnt vmcnt(8)
    s_barrier
    v_add_u32 v16, 65536, v16
    v_add_u32 v17, 65536, v17
    v_add_u32 v18, 65536, v18
    v_mfma_f32_16x16x32_bf16 v[224:227], v[204:207], v[128:131], v[224:227]
    v_add_u32 v19, 65536, v19
    v_add_u32 v20, 65536, v20
    v_add_u32 v21, 65536, v21
    v_mfma_f32_16x16x32_bf16 v[228:231], v[204:207], v[132:135], v[228:231]
    ds_read_b128 v[136:139], v20 offset:16384
    ds_read_b64_tr_b16 v[184:185], v16 offset:0
    ds_read_b64_tr_b16 v[186:187], v16 offset:1024
    v_mfma_f32_16x16x32_bf16 v[232:235], v[208:211], v[128:131], v[232:235]
    ds_read_b128 v[140:143], v20 offset:18432
    ds_read_b64_tr_b16 v[188:189], v17 offset:0
    ds_read_b64_tr_b16 v[190:191], v17 offset:1024
    v_mfma_f32_16x16x32_bf16 v[236:239], v[208:211], v[132:135], v[236:239]
    ds_read_b64_tr_b16 v[192:193], v18 offset:0
    ds_read_b64_tr_b16 v[194:195], v18 offset:1024
    ds_read_b64_tr_b16 v[196:197], v19 offset:0
    v_mfma_f32_16x16x32_bf16 v[240:243], v[212:215], v[128:131], v[240:243]
    ds_read_b64_tr_b16 v[198:199], v19 offset:1024
    v_mfma_f32_16x16x32_bf16 v[244:247], v[212:215], v[132:135], v[244:247]
    s_waitcnt lgkmcnt(0)
    ds_read_b128 v[144:147], v21 offset:16384
    ds_read_b64_tr_b16 v[200:201], v16 offset:8192
    v_mfma_f32_16x16x32_bf16 v[216:219], v[184:187], v[136:139], v[216:219]
    ds_read_b64_tr_b16 v[202:203], v16 offset:9216
    ds_read_b128 v[148:151], v21 offset:18432
    v_mfma_f32_16x16x32_bf16 v[220:223], v[184:187], v[140:143], v[220:223]
    ds_read_b64_tr_b16 v[204:205], v17 offset:8192
    ds_read_b64_tr_b16 v[206:207], v17 offset:9216
    v_mfma_f32_16x16x32_bf16 v[224:227], v[188:191], v[136:139], v[224:227]
    ds_read_b64_tr_b16 v[208:209], v18 offset:8192
    ds_read_b64_tr_b16 v[210:211], v18 offset:9216
    v_mfma_f32_16x16x32_bf16 v[228:231], v[188:191], v[140:143], v[228:231]
    ds_read_b64_tr_b16 v[212:213], v19 offset:8192
    ds_read_b64_tr_b16 v[214:215], v19 offset:9216
    v_mfma_f32_16x16x32_bf16 v[232:235], v[192:195], v[136:139], v[232:235]
    v_mfma_f32_16x16x32_bf16 v[236:239], v[192:195], v[140:143], v[236:239]
    v_mfma_f32_16x16x32_bf16 v[240:243], v[196:199], v[136:139], v[240:243]
    v_mfma_f32_16x16x32_bf16 v[244:247], v[196:199], v[140:143], v[244:247]
    s_lshl_b32 s25, s3, 2
    v_add_u32 v8, s25, v4
    v_min_u32 v8, 24, v8
    v_mul_u32_u24 v9, 52, v8
    v_lshrrev_b32 v9, 8, v9
    v_mul_u32_u24 v10, 5, v9
    v_sub_u32 v10, v8, v10
    s_and_b32 s25, s20, 15
    s_lshl_b32 s27, s25, 1
    s_cmp_lt_u32 s25, 8
    s_cselect_b32 s26, 64, 0
    s_add_u32 s27, s27, s26
    v_add_u32 v11, s27, v9
    s_mul_i32 s27, s25, 3
    s_cmp_ge_u32 s25, 5
    s_cselect_b32 s26, 15, -1
    s_add_u32 s26, s26, s27
    v_add_u32 v12, s26, v9
    s_cmp_ge_u32 s25, 6
    s_cselect_b32 s26, 16, 0
    s_add_u32 s26, s26, s27
    v_cmp_gt_u32 vcc, 2, v9
    v_mov_b32 v13, s26
    s_lshr_b32 s25, s20, 4
    v_cndmask_b32 v11, v12, v11, vcc
    v_cmp_eq_u32 vcc, 4, v9
    s_mul_i32 s25, s25, 5120
    s_nop 0
    v_cndmask_b32 v11, v11, v13, vcc
    v_lshrrev_b32 v12, 2, v11
    v_and_b32 v11, 3, v11
    v_mul_u32_u24 v13, 10240, v12
    v_add_u32 v13, s25, v13
    v_lshl_add_u32 v13, v10, 10, v13
    v_lshl_add_u32 v13, v11, 8, v13
    v_lshl_add_u32 v13, v3, 4, v13
    s_mul_i32 s27, s19, 204800
    s_add_u32 s27, s27, 22552576
    v_add_u32 v176, s27, v13
    s_mul_i32 s27, s20, 25600
    s_mul_i32 s26, s19, 160
    s_add_u32 s27, s27, s26
    v_lshlrev_b32 v11, 5, v10
    v_lshl_add_u32 v11, v3, 1, v11
    v_add_u32 v11, s27, v11

    v_and_b32 v12, 1, v9
    v_lshl_add_u32 v12, v12, 2, 0
    v_cmp_eq_u32 vcc, 4, v9
    v_lshrrev_b32 v13, 1, v9
    v_mov_b32 v8, 16
    v_mov_b32 v10, 0
    v_cndmask_b32 v12, v12, v8, vcc
    v_cndmask_b32 v13, v13, v10, vcc
    v_cmp_eq_u32 vcc, 0, v13
    v_mov_b32 v8, s48
    v_mov_b32 v10, s42
    v_mov_b32 v13, s49
    v_cndmask_b32 v8, v8, v10, vcc
    v_mov_b32 v10, s43
    v_cndmask_b32 v179, v13, v10, vcc
    v_mul_u32_u24 v12, 1280, v12
    v_add_u32 v12, v12, v11
    v_add_co_u32 v178, vcc, v8, v12
    s_nop 1
    v_addc_co_u32 v179, vcc, 0, v179, vcc

    global_load_ushort v168, v[178:179], off offset:0
    global_load_ushort v169, v[178:179], off offset:1280
    global_load_ushort v170, v[178:179], off offset:2560
    global_load_ushort v171, v[178:179], off offset:3840
    v_and_b32 v12, 1, v9
    v_lshl_add_u32 v12, v12, 2, 8
    v_cmp_eq_u32 vcc, 4, v9
    v_lshrrev_b32 v13, 1, v9
    v_mov_b32 v8, 16
    v_mov_b32 v10, 1
    v_cndmask_b32 v12, v12, v8, vcc
    v_cndmask_b32 v13, v13, v10, vcc
    v_cmp_eq_u32 vcc, 0, v13
    v_mov_b32 v8, s48
    v_mov_b32 v10, s42
    v_mov_b32 v13, s49
    v_cndmask_b32 v8, v8, v10, vcc
    v_mov_b32 v10, s43
    v_cndmask_b32 v181, v13, v10, vcc
    v_mul_u32_u24 v12, 1280, v12
    v_add_u32 v12, v12, v11
    v_add_co_u32 v180, vcc, v8, v12
    s_nop 1
    v_addc_co_u32 v181, vcc, 0, v181, vcc

    global_load_ushort v172, v[180:181], off offset:0
    global_load_ushort v173, v[180:181], off offset:1280
    global_load_ushort v174, v[180:181], off offset:2560
    global_load_ushort v175, v[180:181], off offset:3840
    s_waitcnt lgkmcnt(0)
    v_mfma_f32_16x16x32_bf16 v[216:219], v[200:203], v[144:147], v[216:219]
    v_mfma_f32_16x16x32_bf16 v[220:223], v[200:203], v[148:151], v[220:223]
    s_waitcnt vmcnt(12)
    s_barrier
    ds_read_b128 v[152:155], v20 offset:49152
    ds_read_b64_tr_b16 v[184:185], v16 offset:32768
    v_mfma_f32_16x16x32_bf16 v[224:227], v[204:207], v[144:147], v[224:227]
    ds_read_b64_tr_b16 v[186:187], v16 offset:33792
    ds_read_b128 v[156:159], v20 offset:51200
    v_mfma_f32_16x16x32_bf16 v[228:231], v[204:207], v[148:151], v[228:231]
    s_mov_b32 s60, s38
    s_mov_b32 s61, s39
    s_add_u32 m0, s28, 0
    s_mov_b32 s26, 0
    buffer_load_dwordx4 v7, s[60:63], s26 offen lds
    ds_read_b64_tr_b16 v[188:189], v17 offset:32768
    ds_read_b64_tr_b16 v[190:191], v17 offset:33792
    v_mfma_f32_16x16x32_bf16 v[232:235], v[208:211], v[144:147], v[232:235]
    ds_read_b64_tr_b16 v[192:193], v18 offset:32768
    ds_read_b64_tr_b16 v[194:195], v18 offset:33792
    v_mfma_f32_16x16x32_bf16 v[236:239], v[208:211], v[148:151], v[236:239]
    s_add_u32 m0, s28, 1024
    s_mov_b32 s26, 15360
    buffer_load_dwordx4 v7, s[60:63], s26 offen lds
    ds_read_b64_tr_b16 v[196:197], v19 offset:32768
    ds_read_b64_tr_b16 v[198:199], v19 offset:33792
    v_mfma_f32_16x16x32_bf16 v[240:243], v[212:215], v[144:147], v[240:243]
    v_mfma_f32_16x16x32_bf16 v[244:247], v[212:215], v[148:151], v[244:247]
    s_add_u32 m0, s28, 16384
    s_mov_b32 s26, 245760
    buffer_load_dwordx4 v7, s[60:63], s26 offen lds
    s_waitcnt lgkmcnt(0)
    ds_read_b128 v[160:163], v21 offset:49152
    ds_read_b64_tr_b16 v[200:201], v16 offset:40960
    v_mfma_f32_16x16x32_bf16 v[216:219], v[184:187], v[152:155], v[216:219]
    ds_read_b64_tr_b16 v[202:203], v16 offset:41984
    ds_read_b128 v[164:167], v21 offset:51200
    v_mfma_f32_16x16x32_bf16 v[220:223], v[184:187], v[156:159], v[220:223]
    s_add_u32 m0, s28, 17408
    s_mov_b32 s26, 261120
    buffer_load_dwordx4 v7, s[60:63], s26 offen lds
    ds_read_b64_tr_b16 v[204:205], v17 offset:40960
    ds_read_b64_tr_b16 v[206:207], v17 offset:41984
    v_mfma_f32_16x16x32_bf16 v[224:227], v[188:191], v[152:155], v[224:227]
    ds_read_b64_tr_b16 v[208:209], v18 offset:40960
    ds_read_b64_tr_b16 v[210:211], v18 offset:41984
    v_mfma_f32_16x16x32_bf16 v[228:231], v[188:191], v[156:159], v[228:231]
    ds_read_b64_tr_b16 v[212:213], v19 offset:40960
    ds_read_b64_tr_b16 v[214:215], v19 offset:41984
    v_mfma_f32_16x16x32_bf16 v[232:235], v[192:195], v[152:155], v[232:235]
    v_mfma_f32_16x16x32_bf16 v[236:239], v[192:195], v[156:159], v[236:239]
    v_mfma_f32_16x16x32_bf16 v[240:243], v[196:199], v[152:155], v[240:243]
    v_mfma_f32_16x16x32_bf16 v[244:247], v[196:199], v[156:159], v[244:247]
    s_waitcnt vmcnt(4)
    v_lshl_or_b32 v168, v169, 16, v168
    v_lshl_or_b32 v169, v171, 16, v170
    v_lshl_or_b32 v170, v173, 16, v172
    v_lshl_or_b32 v171, v175, 16, v174
    buffer_store_dwordx4 v[168:171], v176, s[8:11], 0 offen sc1
    s_waitcnt lgkmcnt(0)
    v_mfma_f32_16x16x32_bf16 v[216:219], v[200:203], v[160:163], v[216:219]
    v_mfma_f32_16x16x32_bf16 v[220:223], v[200:203], v[164:167], v[220:223]
    s_barrier
    v_add_u32 v16, 65536, v16
    v_add_u32 v17, 65536, v17
    v_add_u32 v18, 65536, v18
    v_mfma_f32_16x16x32_bf16 v[224:227], v[204:207], v[160:163], v[224:227]
    v_and_b32 v8, 31, v2
    v_add_u32 v8, s24, v8
    v_lshlrev_b32 v8, 4, v8
    v_lshrrev_b32 v9, 5, v2
    v_add_u32 v19, 65536, v19
    v_add_u32 v20, 65536, v20
    v_add_u32 v21, 65536, v21
    v_mfma_f32_16x16x32_bf16 v[228:231], v[204:207], v[164:167], v[228:231]
    v_lshl_add_u32 v5, v9, 15, v8
    s_lshl_b32 s27, s23, 12
    s_add_u32 s27, s27, s31

    s_add_u32 m0, s28, 32768
    s_mov_b32 s26, 491520
    buffer_load_dwordx4 v7, s[60:63], s26 offen lds
    ds_read_b128 v[168:171], v20 offset:16384
    ds_read_b64_tr_b16 v[184:185], v16 offset:0
    ds_read_b64_tr_b16 v[186:187], v16 offset:1024
    v_mfma_f32_16x16x32_bf16 v[232:235], v[208:211], v[160:163], v[232:235]
    ds_read_b128 v[172:175], v20 offset:18432
    ds_read_b64_tr_b16 v[188:189], v17 offset:0
    ds_read_b64_tr_b16 v[190:191], v17 offset:1024
    v_mfma_f32_16x16x32_bf16 v[236:239], v[208:211], v[164:167], v[236:239]
    s_add_u32 m0, s28, 33792
    s_mov_b32 s26, 506880
    buffer_load_dwordx4 v7, s[60:63], s26 offen lds
    ds_read_b64_tr_b16 v[192:193], v18 offset:0
    ds_read_b64_tr_b16 v[194:195], v18 offset:1024
    ds_read_b64_tr_b16 v[196:197], v19 offset:0
    v_mfma_f32_16x16x32_bf16 v[240:243], v[212:215], v[160:163], v[240:243]
    ds_read_b64_tr_b16 v[198:199], v19 offset:1024
    v_mfma_f32_16x16x32_bf16 v[244:247], v[212:215], v[164:167], v[244:247]
    s_add_u32 m0, s28, 49152
    s_mov_b32 s26, 737280
    buffer_load_dwordx4 v7, s[60:63], s26 offen lds
    s_waitcnt lgkmcnt(0)
    ds_read_b128 v[176:179], v21 offset:16384
    ds_read_b64_tr_b16 v[200:201], v16 offset:8192
    v_mfma_f32_16x16x32_bf16 v[216:219], v[184:187], v[168:171], v[216:219]
    ds_read_b64_tr_b16 v[202:203], v16 offset:9216
    ds_read_b128 v[180:183], v21 offset:18432
    v_mfma_f32_16x16x32_bf16 v[220:223], v[184:187], v[172:175], v[220:223]
    s_add_u32 m0, s28, 50176
    s_mov_b32 s26, 752640
    buffer_load_dwordx4 v7, s[60:63], s26 offen lds
    ds_read_b64_tr_b16 v[204:205], v17 offset:8192
    ds_read_b64_tr_b16 v[206:207], v17 offset:9216
    v_mfma_f32_16x16x32_bf16 v[224:227], v[188:191], v[168:171], v[224:227]
    ds_read_b64_tr_b16 v[208:209], v18 offset:8192
    ds_read_b64_tr_b16 v[210:211], v18 offset:9216
    v_mfma_f32_16x16x32_bf16 v[228:231], v[188:191], v[172:175], v[228:231]
    ds_read_b64_tr_b16 v[212:213], v19 offset:8192
    ds_read_b64_tr_b16 v[214:215], v19 offset:9216
    v_mfma_f32_16x16x32_bf16 v[232:235], v[192:195], v[168:171], v[232:235]
    v_mfma_f32_16x16x32_bf16 v[236:239], v[192:195], v[172:175], v[236:239]
    v_mfma_f32_16x16x32_bf16 v[240:243], v[196:199], v[168:171], v[240:243]
    v_mfma_f32_16x16x32_bf16 v[244:247], v[196:199], v[172:175], v[244:247]
    s_waitcnt lgkmcnt(0)
    v_mfma_f32_16x16x32_bf16 v[216:219], v[200:203], v[176:179], v[216:219]
    v_mfma_f32_16x16x32_bf16 v[220:223], v[200:203], v[180:183], v[220:223]
    s_waitcnt vmcnt(5)
    s_barrier
    v_add_u32 v16, 4294836224, v16
    v_add_u32 v17, 4294836224, v17
    v_mfma_f32_16x16x32_bf16 v[224:227], v[204:207], v[176:179], v[224:227]
    v_add_u32 v18, 4294836224, v18
    v_add_u32 v19, 4294836224, v19
    v_mfma_f32_16x16x32_bf16 v[228:231], v[204:207], v[180:183], v[228:231]
    s_add_u32 m0, s28, 65536
    s_mov_b32 s26, 983040
    buffer_load_dwordx4 v7, s[60:63], s26 offen lds
    ds_read_b64_tr_b16 v[184:185], v16 offset:0
    ds_read_b64_tr_b16 v[186:187], v16 offset:1024
    v_mfma_f32_16x16x32_bf16 v[232:235], v[208:211], v[176:179], v[232:235]
    ds_read_b64_tr_b16 v[188:189], v17 offset:0
    ds_read_b64_tr_b16 v[190:191], v17 offset:1024
    v_mfma_f32_16x16x32_bf16 v[236:239], v[208:211], v[180:183], v[236:239]
    s_add_u32 m0, s28, 66560
    s_mov_b32 s26, 998400
    buffer_load_dwordx4 v7, s[60:63], s26 offen lds
    ds_read_b64_tr_b16 v[192:193], v18 offset:0
    ds_read_b64_tr_b16 v[194:195], v18 offset:1024
    v_mfma_f32_16x16x32_bf16 v[240:243], v[212:215], v[176:179], v[240:243]
    ds_read_b64_tr_b16 v[196:197], v19 offset:0
    ds_read_b64_tr_b16 v[198:199], v19 offset:1024
    v_mfma_f32_16x16x32_bf16 v[244:247], v[212:215], v[180:183], v[244:247]
    s_add_u32 m0, s28, 81920
    s_mov_b32 s26, 1228800
    buffer_load_dwordx4 v7, s[60:63], s26 offen lds
    s_nop 2
    s_cmp_eq_u32 s22, 0
    s_cbranch_scc0 L_nsc_3
    v_mov_b32 v8, 0x3ea52b5c
    v_pk_mul_f32 v[216:217], v[216:217], v[8:9] op_sel_hi:[1,0]
    v_pk_mul_f32 v[218:219], v[218:219], v[8:9] op_sel_hi:[1,0]
    v_pk_mul_f32 v[220:221], v[220:221], v[8:9] op_sel_hi:[1,0]
    v_pk_mul_f32 v[222:223], v[222:223], v[8:9] op_sel_hi:[1,0]
    v_pk_mul_f32 v[224:225], v[224:225], v[8:9] op_sel_hi:[1,0]
    v_pk_mul_f32 v[226:227], v[226:227], v[8:9] op_sel_hi:[1,0]
    v_pk_mul_f32 v[228:229], v[228:229], v[8:9] op_sel_hi:[1,0]
    v_pk_mul_f32 v[230:231], v[230:231], v[8:9] op_sel_hi:[1,0]
    v_pk_mul_f32 v[232:233], v[232:233], v[8:9] op_sel_hi:[1,0]
    v_pk_mul_f32 v[234:235], v[234:235], v[8:9] op_sel_hi:[1,0]
    v_pk_mul_f32 v[236:237], v[236:237], v[8:9] op_sel_hi:[1,0]
    v_pk_mul_f32 v[238:239], v[238:239], v[8:9] op_sel_hi:[1,0]
    v_pk_mul_f32 v[240:241], v[240:241], v[8:9] op_sel_hi:[1,0]
    v_pk_mul_f32 v[242:243], v[242:243], v[8:9] op_sel_hi:[1,0]
    v_pk_mul_f32 v[244:245], v[244:245], v[8:9] op_sel_hi:[1,0]
    v_pk_mul_f32 v[246:247], v[246:247], v[8:9] op_sel_hi:[1,0]
L_nsc_3:
    v_cvt_pk_bf16_f32 v248, v216, v217
    v_cvt_pk_bf16_f32 v249, v218, v219
    v_cvt_pk_bf16_f32 v250, v220, v221
    v_cvt_pk_bf16_f32 v251, v222, v223
    v_cvt_pk_bf16_f32 v252, v224, v225
    v_cvt_pk_bf16_f32 v253, v226, v227
    v_cvt_pk_bf16_f32 v254, v228, v229
    v_cvt_pk_bf16_f32 v255, v230, v231
    v_permlane16_swap_b32 v248, v250
    v_permlane16_swap_b32 v249, v251
    v_cvt_pk_bf16_f32 v20, v232, v233
    v_cvt_pk_bf16_f32 v21, v234, v235
    v_cvt_pk_bf16_f32 v22, v236, v237
    v_cvt_pk_bf16_f32 v23, v238, v239
    v_permlane16_swap_b32 v252, v254
    v_permlane16_swap_b32 v253, v255
    v_cvt_pk_bf16_f32 v10, v240, v241
    v_cvt_pk_bf16_f32 v11, v242, v243
    v_cvt_pk_bf16_f32 v12, v244, v245
    v_cvt_pk_bf16_f32 v13, v246, v247
    v_permlane16_swap_b32 v20, v22
    v_permlane16_swap_b32 v21, v23
    s_nop 1
    v_permlane16_swap_b32 v10, v12
    v_permlane16_swap_b32 v11, v13
    s_waitcnt lgkmcnt(0)
    ds_read_b64_tr_b16 v[200:201], v16 offset:8192
    v_mfma_f32_16x16x32_bf16 v[216:219], v[184:187], v[24:27], 0
    ds_read_b64_tr_b16 v[202:203], v16 offset:9216
    v_mfma_f32_16x16x32_bf16 v[220:223], v[184:187], v[28:31], 0
    s_add_u32 m0, s28, 82944
    s_mov_b32 s26, 1244160
    buffer_load_dwordx4 v7, s[60:63], s26 offen lds
    ds_read_b64_tr_b16 v[204:205], v17 offset:8192
    v_mfma_f32_16x16x32_bf16 v[224:227], v[188:191], v[24:27], 0
    ds_read_b64_tr_b16 v[206:207], v17 offset:9216
    v_mfma_f32_16x16x32_bf16 v[228:231], v[188:191], v[28:31], 0
    s_add_u32 s25, s27, 7864320
    buffer_store_dwordx4 v[248:251], v5, s[8:11], s25 offen sc1
    ds_read_b64_tr_b16 v[208:209], v18 offset:8192
    v_mfma_f32_16x16x32_bf16 v[232:235], v[192:195], v[24:27], 0
    ds_read_b64_tr_b16 v[210:211], v18 offset:9216
    v_mfma_f32_16x16x32_bf16 v[236:239], v[192:195], v[28:31], 0
    ds_read_b64_tr_b16 v[212:213], v19 offset:8192
    v_mfma_f32_16x16x32_bf16 v[240:243], v[196:199], v[24:27], 0
    ds_read_b64_tr_b16 v[214:215], v19 offset:9216
    v_mfma_f32_16x16x32_bf16 v[244:247], v[196:199], v[28:31], 0
    s_add_u32 s25, s27, 7929856
    buffer_store_dwordx4 v[252:255], v5, s[8:11], s25 offen sc1
    s_waitcnt lgkmcnt(0)
    ds_read_b64_tr_b16 v[184:185], v16 offset:16384
    v_mfma_f32_16x16x32_bf16 v[216:219], v[200:203], v[32:35], v[216:219]
    ds_read_b64_tr_b16 v[186:187], v16 offset:17408
    v_mfma_f32_16x16x32_bf16 v[220:223], v[200:203], v[36:39], v[220:223]
    ds_read_b64_tr_b16 v[188:189], v17 offset:16384
    v_mfma_f32_16x16x32_bf16 v[224:227], v[204:207], v[32:35], v[224:227]
    ds_read_b64_tr_b16 v[190:191], v17 offset:17408
    v_mfma_f32_16x16x32_bf16 v[228:231], v[204:207], v[36:39], v[228:231]
    s_add_u32 s25, s27, 7995392
    buffer_store_dwordx4 v[20:23], v5, s[8:11], s25 offen sc1
    ds_read_b64_tr_b16 v[192:193], v18 offset:16384
    v_mfma_f32_16x16x32_bf16 v[232:235], v[208:211], v[32:35], v[232:235]
    ds_read_b64_tr_b16 v[194:195], v18 offset:17408
    v_mfma_f32_16x16x32_bf16 v[236:239], v[208:211], v[36:39], v[236:239]
    ds_read_b64_tr_b16 v[196:197], v19 offset:16384
    v_mfma_f32_16x16x32_bf16 v[240:243], v[212:215], v[32:35], v[240:243]
    ds_read_b64_tr_b16 v[198:199], v19 offset:17408
    v_mfma_f32_16x16x32_bf16 v[244:247], v[212:215], v[36:39], v[244:247]
    s_add_u32 s25, s27, 8060928
    buffer_store_dwordx4 v[10:13], v5, s[8:11], s25 offen sc1
    s_waitcnt lgkmcnt(0)
    ds_read_b64_tr_b16 v[200:201], v16 offset:24576
    v_mfma_f32_16x16x32_bf16 v[216:219], v[184:187], v[40:43], v[216:219]
    ds_read_b64_tr_b16 v[202:203], v16 offset:25600
    v_mfma_f32_16x16x32_bf16 v[220:223], v[184:187], v[44:47], v[220:223]
    ds_read_b64_tr_b16 v[204:205], v17 offset:24576
    v_mfma_f32_16x16x32_bf16 v[224:227], v[188:191], v[40:43], v[224:227]
    ds_read_b64_tr_b16 v[206:207], v17 offset:25600
    v_mfma_f32_16x16x32_bf16 v[228:231], v[188:191], v[44:47], v[228:231]
    v_mov_b32 v8, 0
    global_load_dword v15, v8, s[4:5] sc1
    ds_read_b64_tr_b16 v[208:209], v18 offset:24576
    v_mfma_f32_16x16x32_bf16 v[232:235], v[192:195], v[40:43], v[232:235]
    ds_read_b64_tr_b16 v[210:211], v18 offset:25600
    v_mfma_f32_16x16x32_bf16 v[236:239], v[192:195], v[44:47], v[236:239]
    ds_read_b64_tr_b16 v[212:213], v19 offset:24576
    v_mfma_f32_16x16x32_bf16 v[240:243], v[196:199], v[40:43], v[240:243]
    ds_read_b64_tr_b16 v[214:215], v19 offset:25600
    v_mfma_f32_16x16x32_bf16 v[244:247], v[196:199], v[44:47], v[244:247]
    s_waitcnt lgkmcnt(0)
    v_mfma_f32_16x16x32_bf16 v[216:219], v[200:203], v[48:51], v[216:219]
    v_mfma_f32_16x16x32_bf16 v[220:223], v[200:203], v[52:55], v[220:223]
    s_waitcnt vmcnt(9)
    s_barrier
    ds_read_b64_tr_b16 v[184:185], v16 offset:32768
    ds_read_b64_tr_b16 v[186:187], v16 offset:33792
    v_mfma_f32_16x16x32_bf16 v[224:227], v[204:207], v[48:51], v[224:227]
    ds_read_b64_tr_b16 v[188:189], v17 offset:32768
    ds_read_b64_tr_b16 v[190:191], v17 offset:33792
    v_mfma_f32_16x16x32_bf16 v[228:231], v[204:207], v[52:55], v[228:231]
    s_add_u32 m0, s28, 98304
    s_mov_b32 s26, 1474560
    buffer_load_dwordx4 v7, s[60:63], s26 offen lds
    ds_read_b64_tr_b16 v[192:193], v18 offset:32768
    ds_read_b64_tr_b16 v[194:195], v18 offset:33792
    v_mfma_f32_16x16x32_bf16 v[232:235], v[208:211], v[48:51], v[232:235]
    ds_read_b64_tr_b16 v[196:197], v19 offset:32768
    ds_read_b64_tr_b16 v[198:199], v19 offset:33792
    v_mfma_f32_16x16x32_bf16 v[236:239], v[208:211], v[52:55], v[236:239]
    s_add_u32 m0, s28, 99328
    s_mov_b32 s26, 1489920
    buffer_load_dwordx4 v7, s[60:63], s26 offen lds
    v_mfma_f32_16x16x32_bf16 v[240:243], v[212:215], v[48:51], v[240:243]
    v_mfma_f32_16x16x32_bf16 v[244:247], v[212:215], v[52:55], v[244:247]
    s_add_u32 m0, s28, 114688
    s_mov_b32 s26, 1720320
    buffer_load_dwordx4 v7, s[60:63], s26 offen lds
    s_waitcnt lgkmcnt(0)
    ds_read_b64_tr_b16 v[200:201], v16 offset:40960
    v_mfma_f32_16x16x32_bf16 v[216:219], v[184:187], v[56:59], v[216:219]
    ds_read_b64_tr_b16 v[202:203], v16 offset:41984
    v_mfma_f32_16x16x32_bf16 v[220:223], v[184:187], v[60:63], v[220:223]
    s_add_u32 m0, s28, 115712
    s_mov_b32 s26, 1735680
    buffer_load_dwordx4 v7, s[60:63], s26 offen lds
    ds_read_b64_tr_b16 v[204:205], v17 offset:40960
    v_mfma_f32_16x16x32_bf16 v[224:227], v[188:191], v[56:59], v[224:227]
    ds_read_b64_tr_b16 v[206:207], v17 offset:41984
    v_mfma_f32_16x16x32_bf16 v[228:231], v[188:191], v[60:63], v[228:231]
    ds_read_b64_tr_b16 v[208:209], v18 offset:40960
    v_mfma_f32_16x16x32_bf16 v[232:235], v[192:195], v[56:59], v[232:235]
    ds_read_b64_tr_b16 v[210:211], v18 offset:41984
    v_mfma_f32_16x16x32_bf16 v[236:239], v[192:195], v[60:63], v[236:239]
    ds_read_b64_tr_b16 v[212:213], v19 offset:40960
    v_mfma_f32_16x16x32_bf16 v[240:243], v[196:199], v[56:59], v[240:243]
    ds_read_b64_tr_b16 v[214:215], v19 offset:41984
    v_mfma_f32_16x16x32_bf16 v[244:247], v[196:199], v[60:63], v[244:247]
    s_waitcnt lgkmcnt(0)
    ds_read_b64_tr_b16 v[184:185], v16 offset:49152
    v_mfma_f32_16x16x32_bf16 v[216:219], v[200:203], v[64:67], v[216:219]
    v_and_b32 v24, 63, v0
    s_and_b32 s50, s2, 7
    s_lshr_b32 s51, s2, 3
    s_and_b32 s47, s51, 7
    ds_read_b64_tr_b16 v[186:187], v16 offset:50176
    v_mfma_f32_16x16x32_bf16 v[220:223], v[200:203], v[68:71], v[220:223]
    s_lshr_b32 s56, s51, 3
    s_lshl_b32 s46, s50, 2
    s_add_u32 s46, s46, s56
    s_lshr_b32 s20, s51, 2
    ds_read_b64_tr_b16 v[188:189], v17 offset:49152
    v_mfma_f32_16x16x32_bf16 v[224:227], v[204:207], v[64:67], v[224:227]
    s_and_b32 s51, s51, 3
    s_lshl_b32 s19, s50, 2
    s_add_u32 s19, s19, s51
    s_lshl_b32 s29, s3, 10
    ds_read_b64_tr_b16 v[190:191], v17 offset:50176
    v_mfma_f32_16x16x32_bf16 v[228:231], v[204:207], v[68:71], v[228:231]
    s_mul_i32 s21, s20, 204800
    s_add_u32 s21, s21, 22552576
    v_and_b32 v25, 31, v24
    v_lshrrev_b32 v26, 5, v24
    ds_read_b64_tr_b16 v[192:193], v18 offset:49152
    v_mfma_f32_16x16x32_bf16 v[232:235], v[208:211], v[64:67], v[232:235]
    v_lshlrev_b32 v34, 4, v24
    s_and_b32 s48, s3, 3
    s_lshr_b32 s49, s3, 2
    s_mov_b32 s32, -1
    ds_read_b64_tr_b16 v[194:195], v18 offset:50176
    v_mfma_f32_16x16x32_bf16 v[236:239], v[208:211], v[68:71], v[236:239]
    s_mov_b32 s33, 0
    s_mov_b32 s38, 0
    s_mov_b32 s39, -1
    s_mov_b32 s34, 0xfffff
    ds_read_b64_tr_b16 v[196:197], v19 offset:49152
    v_mfma_f32_16x16x32_bf16 v[240:243], v[212:215], v[64:67], v[240:243]
    s_mov_b32 s35, 0xfffff
    s_mov_b32 s36, 570425344
    s_mov_b32 s37, 570425344
    s_mul_i32 s53, s46, 81920
    ds_read_b64_tr_b16 v[198:199], v19 offset:50176
    v_mfma_f32_16x16x32_bf16 v[244:247], v[212:215], v[68:71], v[244:247]
    s_and_b32 s58, s46, 1
    s_mul_i32 s57, s46, 5
    s_lshr_b32 s57, s57, 1
    s_lshl_b32 s57, s57, 15
    s_waitcnt lgkmcnt(0)
    ds_read_b64_tr_b16 v[200:201], v16 offset:57344
    v_mfma_f32_16x16x32_bf16 v[216:219], v[184:187], v[72:75], v[216:219]
    s_lshl_b32 s55, s48, 1
    s_add_u32 s55, s55, s49
    s_lshl_b32 s54, s47, 3
    s_add_u32 s54, s54, s55
    ds_read_b64_tr_b16 v[202:203], v16 offset:58368
    v_mfma_f32_16x16x32_bf16 v[220:223], v[184:187], v[76:79], v[220:223]
    s_lshl_b32 s54, s54, 9

    v_add_u32 v30, s58, v26
    v_lshlrev_b32 v27, 4, v25
    ds_read_b64_tr_b16 v[204:205], v17 offset:57344
    v_mfma_f32_16x16x32_bf16 v[224:227], v[188:191], v[72:75], v[224:227]
    v_lshl_add_u32 v38, v30, 15, v27
    s_cmp_eq_u32 s58, 0
    s_cselect_b32 s50, 65536, 8
    v_add_u32 v27, s50, v27

    ds_read_b64_tr_b16 v[206:207], v17 offset:58368
    v_mfma_f32_16x16x32_bf16 v[228:231], v[188:191], v[76:79], v[228:231]
    s_lshl_b32 s50, s49, 14
    s_add_u32 s50, s50, s57
    s_lshl_b32 s51, s48, 10
    s_add_u32 s50, s50, s51
    ds_read_b64_tr_b16 v[208:209], v18 offset:57344
    v_mfma_f32_16x16x32_bf16 v[232:235], v[192:195], v[72:75], v[232:235]
    s_add_u32 s40, s50, 10485760
    s_add_u32 s41, s40, 32768
    s_add_u32 s42, s40, 65536
    s_mul_i32 s50, s49, 40960
    ds_read_b64_tr_b16 v[210:211], v18 offset:58368
    v_mfma_f32_16x16x32_bf16 v[236:239], v[192:195], v[76:79], v[236:239]
    s_add_u32 s50, s50, s53
    s_add_u32 s50, s50, 13107200
    s_add_u32 s43, s50, s51
    s_add_u32 s44, s43, 4096
    ds_read_b64_tr_b16 v[212:213], v19 offset:57344
    v_mfma_f32_16x16x32_bf16 v[240:243], v[196:199], v[72:75], v[240:243]
    s_min_u32 s56, s51, 1024
    s_add_u32 s45, s50, s56
    s_add_u32 s45, s45, 8192
    s_mul_i32 s52, s49, 22528
    ds_read_b64_tr_b16 v[214:215], v19 offset:58368
    v_mfma_f32_16x16x32_bf16 v[244:247], v[196:199], v[76:79], v[244:247]
    s_add_u32 s59, s52, s56
    s_add_u32 s52, s52, s51

    v_mul_u32_u24 v58, 320, v26
    s_waitcnt lgkmcnt(0)
    v_mfma_f32_16x16x32_bf16 v[216:219], v[200:203], v[80:83], v[216:219]
    v_mfma_f32_16x16x32_bf16 v[220:223], v[200:203], v[84:87], v[220:223]
    s_waitcnt vmcnt(9)
    s_waitcnt vmcnt(4)
    s_barrier
    s_cmp_eq_u32 s3, 0
    s_cbranch_scc0 L_cb_4
L_zs_5:
    v_readfirstlane_b32 s25, v15
    s_nop 3
    s_cmp_lg_u32 s25, 0
    s_cbranch_scc1 L_zd_6
    v_mov_b32 v8, 0
    global_load_dword v15, v8, s[4:5] sc1
    s_waitcnt vmcnt(0)
    s_branch L_zs_5

L_zd_6:
    v_mov_b32 v8, s30
    v_mov_b32 v9, 1
    s_mov_b64 exec, 1
    global_store_dword v8, v9, s[16:17] sc1
    s_mov_b64 exec, -1

L_cb_4:
    v_add_u32 v16, 65536, v16
    v_add_u32 v17, 65536, v17
    v_mfma_f32_16x16x32_bf16 v[224:227], v[204:207], v[80:83], v[224:227]
    v_lshl_add_u32 v58, v25, 4, v58
    v_and_b32 v32, 0x13, v25
    v_and_b32 v31, 4, v25
    v_lshl_or_b32 v32, v31, 1, v32
    v_add_u32 v18, 65536, v18
    v_add_u32 v19, 65536, v19
    v_mfma_f32_16x16x32_bf16 v[228:231], v[204:207], v[84:87], v[228:231]
    v_and_b32 v31, 8, v25
    v_lshrrev_b32 v31, 1, v31
    v_or_b32 v32, v32, v31
    v_lshlrev_b32 v32, 4, v32
    s_add_u32 m0, s28, 131072
    s_mov_b32 s26, 1966080
    buffer_load_dwordx4 v7, s[60:63], s26 offen lds
    ds_read_b64_tr_b16 v[184:185], v16 offset:0
    ds_read_b64_tr_b16 v[186:187], v16 offset:1024
    v_mfma_f32_16x16x32_bf16 v[232:235], v[208:211], v[80:83], v[232:235]
    s_mul_i32 s50, s49, 22528
    v_add_u32 v32, s50, v32
    v_lshl_add_u32 v28, v30, 12, v32
    s_cmp_eq_u32 s58, 0
    s_cselect_b32 s51, 8192, 8
    ds_read_b64_tr_b16 v[188:189], v17 offset:0
    ds_read_b64_tr_b16 v[190:191], v17 offset:1024
    v_mfma_f32_16x16x32_bf16 v[236:239], v[208:211], v[84:87], v[236:239]
    v_add_u32 v59, s51, v32
    s_add_u32 s51, s50, 12288
    v_add_u32 v29, s51, v58

    s_add_u32 m0, s28, 132096
    s_mov_b32 s26, 1981440
    buffer_load_dwordx4 v7, s[60:63], s26 offen lds
    ds_read_b64_tr_b16 v[192:193], v18 offset:0
    ds_read_b64_tr_b16 v[194:195], v18 offset:1024
    v_mfma_f32_16x16x32_bf16 v[240:243], v[212:215], v[80:83], v[240:243]
    s_lshr_b32 s50, s57, 12
    s_add_u32 s51, s50, 23
    s_lshr_b32 s50, s50, 7
    s_lshr_b32 s51, s51, 7
    ds_read_b64_tr_b16 v[196:197], v19 offset:0
    ds_read_b64_tr_b16 v[198:199], v19 offset:1024
    v_mfma_f32_16x16x32_bf16 v[244:247], v[212:215], v[84:87], v[244:247]
    s_sub_u32 s51, s51, s50
    v_bfe_u32 v31, v24, 4, 1
    v_mul_u32_u24 v31, s51, v31
    s_cmp_eq_u32 s3, 0
    s_cselect_b32 s51, 5, 0
    s_add_u32 m0, s28, 147456
    s_mov_b32 s26, 2211840
    buffer_load_dwordx4 v7, s[60:63], s26 offen lds
    s_waitcnt lgkmcnt(0)
    ds_read_b64_tr_b16 v[200:201], v16 offset:8192
    v_mfma_f32_16x16x32_bf16 v[216:219], v[184:187], v[88:91], v[216:219]
    v_add_u32 v32, 1, v26
    v_mul_u32_u24 v32, s51, v32
    v_add_u32 v31, v31, v32
    v_add_u32 v31, s50, v31
    ds_read_b64_tr_b16 v[202:203], v16 offset:9216
    v_mfma_f32_16x16x32_bf16 v[220:223], v[184:187], v[92:95], v[220:223]
    s_lshl_b32 s50, s47, 1
    s_cmp_eq_u32 s3, 0
    s_cselect_b32 s51, 15, 1
    s_cselect_b32 s50, 0, s50
    v_and_b32 v32, s51, v24
    v_add_u32 v32, s50, v32
    s_add_u32 m0, s28, 148480
    s_mov_b32 s26, 2227200
    buffer_load_dwordx4 v7, s[60:63], s26 offen lds
    ds_read_b64_tr_b16 v[204:205], v17 offset:8192
    v_mfma_f32_16x16x32_bf16 v[224:227], v[188:191], v[88:91], v[224:227]
    v_lshl_add_u32 v31, v31, 4, v32
    v_add_u32 v31, 128, v31
    v_lshlrev_b32 v36, 7, v31

    ds_read_b64_tr_b16 v[206:207], v17 offset:9216
    v_mfma_f32_16x16x32_bf16 v[228:231], v[188:191], v[92:95], v[228:231]
    ds_read_b64_tr_b16 v[208:209], v18 offset:8192
    v_mfma_f32_16x16x32_bf16 v[232:235], v[192:195], v[88:91], v[232:235]
    ds_read_b64_tr_b16 v[210:211], v18 offset:9216
    v_mfma_f32_16x16x32_bf16 v[236:239], v[192:195], v[92:95], v[236:239]
    ds_read_b64_tr_b16 v[212:213], v19 offset:8192
    v_mfma_f32_16x16x32_bf16 v[240:243], v[196:199], v[88:91], v[240:243]
    ds_read_b64_tr_b16 v[214:215], v19 offset:9216
    v_mfma_f32_16x16x32_bf16 v[244:247], v[196:199], v[92:95], v[244:247]
    s_waitcnt lgkmcnt(0)
    ds_read_b64_tr_b16 v[184:185], v16 offset:16384
    v_mfma_f32_16x16x32_bf16 v[216:219], v[200:203], v[96:99], v[216:219]
    ds_read_b64_tr_b16 v[186:187], v16 offset:17408
    v_mfma_f32_16x16x32_bf16 v[220:223], v[200:203], v[100:103], v[220:223]
    ds_read_b64_tr_b16 v[188:189], v17 offset:16384
    v_mfma_f32_16x16x32_bf16 v[224:227], v[204:207], v[96:99], v[224:227]
    ds_read_b64_tr_b16 v[190:191], v17 offset:17408
    v_mfma_f32_16x16x32_bf16 v[228:231], v[204:207], v[100:103], v[228:231]
    ds_read_b64_tr_b16 v[192:193], v18 offset:16384
    v_mfma_f32_16x16x32_bf16 v[232:235], v[208:211], v[96:99], v[232:235]
    ds_read_b64_tr_b16 v[194:195], v18 offset:17408
    v_mfma_f32_16x16x32_bf16 v[236:239], v[208:211], v[100:103], v[236:239]
    ds_read_b64_tr_b16 v[196:197], v19 offset:16384
    v_mfma_f32_16x16x32_bf16 v[240:243], v[212:215], v[96:99], v[240:243]
    ds_read_b64_tr_b16 v[198:199], v19 offset:17408
    v_mfma_f32_16x16x32_bf16 v[244:247], v[212:215], v[100:103], v[244:247]
    s_waitcnt lgkmcnt(0)
    ds_read_b64_tr_b16 v[200:201], v16 offset:24576
    v_mfma_f32_16x16x32_bf16 v[216:219], v[184:187], v[104:107], v[216:219]
    ds_read_b64_tr_b16 v[202:203], v16 offset:25600
    v_mfma_f32_16x16x32_bf16 v[220:223], v[184:187], v[108:111], v[220:223]
    ds_read_b64_tr_b16 v[204:205], v17 offset:24576
    v_mfma_f32_16x16x32_bf16 v[224:227], v[188:191], v[104:107], v[224:227]
    ds_read_b64_tr_b16 v[206:207], v17 offset:25600
    v_mfma_f32_16x16x32_bf16 v[228:231], v[188:191], v[108:111], v[228:231]
    ds_read_b64_tr_b16 v[208:209], v18 offset:24576
    v_mfma_f32_16x16x32_bf16 v[232:235], v[192:195], v[104:107], v[232:235]
    ds_read_b64_tr_b16 v[210:211], v18 offset:25600
    v_mfma_f32_16x16x32_bf16 v[236:239], v[192:195], v[108:111], v[236:239]
    ds_read_b64_tr_b16 v[212:213], v19 offset:24576
    v_mfma_f32_16x16x32_bf16 v[240:243], v[196:199], v[104:107], v[240:243]
    ds_read_b64_tr_b16 v[214:215], v19 offset:25600
    v_mfma_f32_16x16x32_bf16 v[244:247], v[196:199], v[108:111], v[244:247]
    s_waitcnt lgkmcnt(0)
    v_mfma_f32_16x16x32_bf16 v[216:219], v[200:203], v[112:115], v[216:219]
    v_mfma_f32_16x16x32_bf16 v[220:223], v[200:203], v[116:119], v[220:223]
    s_waitcnt vmcnt(4)
    s_barrier
    ds_read_b64_tr_b16 v[184:185], v16 offset:32768
    ds_read_b64_tr_b16 v[186:187], v16 offset:33792
    v_mfma_f32_16x16x32_bf16 v[224:227], v[204:207], v[112:115], v[224:227]
    ds_read_b64_tr_b16 v[188:189], v17 offset:32768
    ds_read_b64_tr_b16 v[190:191], v17 offset:33792
    v_mfma_f32_16x16x32_bf16 v[228:231], v[204:207], v[116:119], v[228:231]
    ds_read_b64_tr_b16 v[192:193], v18 offset:32768
    ds_read_b64_tr_b16 v[194:195], v18 offset:33792
    v_mfma_f32_16x16x32_bf16 v[232:235], v[208:211], v[112:115], v[232:235]
    ds_read_b64_tr_b16 v[196:197], v19 offset:32768
    ds_read_b64_tr_b16 v[198:199], v19 offset:33792
    v_mfma_f32_16x16x32_bf16 v[236:239], v[208:211], v[116:119], v[236:239]
    v_mfma_f32_16x16x32_bf16 v[240:243], v[212:215], v[112:115], v[240:243]
    v_mfma_f32_16x16x32_bf16 v[244:247], v[212:215], v[116:119], v[244:247]
    s_waitcnt lgkmcnt(0)
    ds_read_b64_tr_b16 v[200:201], v16 offset:40960
    v_mfma_f32_16x16x32_bf16 v[216:219], v[184:187], v[120:123], v[216:219]
    ds_read_b64_tr_b16 v[202:203], v16 offset:41984
    v_mfma_f32_16x16x32_bf16 v[220:223], v[184:187], v[124:127], v[220:223]
    ds_read_b64_tr_b16 v[204:205], v17 offset:40960
    v_mfma_f32_16x16x32_bf16 v[224:227], v[188:191], v[120:123], v[224:227]
    ds_read_b64_tr_b16 v[206:207], v17 offset:41984
    v_mfma_f32_16x16x32_bf16 v[228:231], v[188:191], v[124:127], v[228:231]
    ds_read_b64_tr_b16 v[208:209], v18 offset:40960
    v_mfma_f32_16x16x32_bf16 v[232:235], v[192:195], v[120:123], v[232:235]
    ds_read_b64_tr_b16 v[210:211], v18 offset:41984
    v_mfma_f32_16x16x32_bf16 v[236:239], v[192:195], v[124:127], v[236:239]
    ds_read_b64_tr_b16 v[212:213], v19 offset:40960
    v_mfma_f32_16x16x32_bf16 v[240:243], v[196:199], v[120:123], v[240:243]
    ds_read_b64_tr_b16 v[214:215], v19 offset:41984
    v_mfma_f32_16x16x32_bf16 v[244:247], v[196:199], v[124:127], v[244:247]
    s_waitcnt lgkmcnt(0)
    ds_read_b64_tr_b16 v[184:185], v16 offset:49152
    v_mfma_f32_16x16x32_bf16 v[216:219], v[200:203], v[128:131], v[216:219]
    ds_read_b64_tr_b16 v[186:187], v16 offset:50176
    v_mfma_f32_16x16x32_bf16 v[220:223], v[200:203], v[132:135], v[220:223]
    ds_read_b64_tr_b16 v[188:189], v17 offset:49152
    v_mfma_f32_16x16x32_bf16 v[224:227], v[204:207], v[128:131], v[224:227]
    ds_read_b64_tr_b16 v[190:191], v17 offset:50176
    v_mfma_f32_16x16x32_bf16 v[228:231], v[204:207], v[132:135], v[228:231]
    ds_read_b64_tr_b16 v[192:193], v18 offset:49152
    v_mfma_f32_16x16x32_bf16 v[232:235], v[208:211], v[128:131], v[232:235]
    ds_read_b64_tr_b16 v[194:195], v18 offset:50176
    v_mfma_f32_16x16x32_bf16 v[236:239], v[208:211], v[132:135], v[236:239]
    ds_read_b64_tr_b16 v[196:197], v19 offset:49152
    v_mfma_f32_16x16x32_bf16 v[240:243], v[212:215], v[128:131], v[240:243]
    ds_read_b64_tr_b16 v[198:199], v19 offset:50176
    v_mfma_f32_16x16x32_bf16 v[244:247], v[212:215], v[132:135], v[244:247]
    s_cmp_lt_u32 s3, 2
    s_cbranch_scc0 L_w01_7
    v_mov_b32 v30, v36
    global_load_dword v37, v30, s[16:17] sc1
L_w01_7:
    s_waitcnt lgkmcnt(0)
    ds_read_b64_tr_b16 v[200:201], v16 offset:57344
    v_mfma_f32_16x16x32_bf16 v[216:219], v[184:187], v[136:139], v[216:219]
    ds_read_b64_tr_b16 v[202:203], v16 offset:58368
    v_mfma_f32_16x16x32_bf16 v[220:223], v[184:187], v[140:143], v[220:223]
    ds_read_b64_tr_b16 v[204:205], v17 offset:57344
    v_mfma_f32_16x16x32_bf16 v[224:227], v[188:191], v[136:139], v[224:227]
    ds_read_b64_tr_b16 v[206:207], v17 offset:58368
    v_mfma_f32_16x16x32_bf16 v[228:231], v[188:191], v[140:143], v[228:231]
    ds_read_b64_tr_b16 v[208:209], v18 offset:57344
    v_mfma_f32_16x16x32_bf16 v[232:235], v[192:195], v[136:139], v[232:235]
    ds_read_b64_tr_b16 v[210:211], v18 offset:58368
    v_mfma_f32_16x16x32_bf16 v[236:239], v[192:195], v[140:143], v[236:239]
    ds_read_b64_tr_b16 v[212:213], v19 offset:57344
    v_mfma_f32_16x16x32_bf16 v[240:243], v[196:199], v[136:139], v[240:243]
    ds_read_b64_tr_b16 v[214:215], v19 offset:58368
    v_mfma_f32_16x16x32_bf16 v[244:247], v[196:199], v[140:143], v[244:247]
    s_waitcnt lgkmcnt(0)
    v_mfma_f32_16x16x32_bf16 v[216:219], v[200:203], v[144:147], v[216:219]
    v_mfma_f32_16x16x32_bf16 v[220:223], v[200:203], v[148:151], v[220:223]
    s_waitcnt vmcnt(0)
    s_cmp_lt_u32 s3, 2
    s_cbranch_scc0 L_w01_10
    s_waitcnt vmcnt(0)
L_pl_11:
    v_cmp_le_u32 vcc, 1, v37
    s_nop 1
    s_cmp_eq_u64 vcc, -1
    s_cbranch_scc1 L_pd_12

    s_sleep 4
    v_mov_b32 v30, v36
    global_load_dword v37, v30, s[16:17] sc1
    s_waitcnt vmcnt(0)
    s_branch L_pl_11
L_pd_12:
L_w01_10:
    s_barrier
    s_lshl_b32 s56, s47, 2
    s_add_u32 s56, s56, s48
    s_lshl_b32 s56, s56, 10

    s_add_u32 s50, s56, s57
    s_add_u32 s50, s50, 7864320
    buffer_load_dwordx4 v[40:43], v38, s[8:11], s50 offen sc1
    buffer_load_dwordx2 v[44:45], v27, s[8:11], s50 offen sc1
    s_add_u32 s56, s56, 512
    s_add_u32 s50, s56, s57
    s_add_u32 s50, s50, 7864320
    buffer_load_dwordx4 v[46:49], v38, s[8:11], s50 offen sc1
    buffer_load_dwordx2 v[50:51], v27, s[8:11], s50 offen sc1
    s_add_u32 s50, s57, 10485760
    buffer_load_dwordx4 v[52:55], v38, s[8:11], s50 offen sc1
    buffer_load_dwordx2 v[56:57], v27, s[8:11], s50 offen sc1
    s_add_u32 m0, s52, 0
    s_nop 0
    buffer_load_dwordx4 v34, s[8:11], s40 offen sc1 lds
    s_add_u32 s40, s40, 4096
    s_add_u32 m0, s52, 4096
    s_nop 0
    buffer_load_dwordx4 v34, s[8:11], s41 offen sc1 lds
    s_add_u32 s41, s41, 4096
    s_add_u32 m0, s52, 8192
    s_nop 0
    buffer_load_dwordx4 v34, s[8:11], s42 offen sc1 lds
    s_add_u32 s42, s42, 4096
    s_add_u32 m0, s52, 12288
    s_nop 0
    buffer_load_dwordx4 v34, s[8:11], s43 offen sc1 lds
    s_add_u32 s43, s43, 10240
    s_add_u32 m0, s52, 16384
    s_nop 0
    buffer_load_dwordx4 v34, s[8:11], s44 offen sc1 lds
    s_add_u32 s44, s44, 10240
    s_add_u32 m0, s59, 20480
    s_nop 0
    buffer_load_dwordx4 v34, s[8:11], s45 offen sc1 lds
    s_add_u32 s45, s45, 10240
    v_mov_b32 v60, 0
    v_mov_b32 v61, 0
    v_mov_b32 v62, 0
    v_mov_b32 v63, 0
    v_mov_b32 v64, 0
    v_mov_b32 v65, 0
    v_mov_b32 v66, 0
    v_mov_b32 v67, 0
    s_mov_b32 exec_lo, 1048576
    s_mov_b32 exec_hi, 1048576
    v_mov_b32 v60, 1065369472
    v_mov_b32 v61, 1065369472
    v_mov_b32 v62, 1065369472
    v_mov_b32 v63, 1065369472
    v_mov_b32 v64, 1065369472
    v_mov_b32 v65, 1065369472
    v_mov_b32 v66, 1065369472
    v_mov_b32 v67, 1065369472
    s_mov_b64 exec, -1
    v_add_u32 v16, 65536, v16
    v_add_u32 v17, 65536, v17
    v_mfma_f32_16x16x32_bf16 v[224:227], v[204:207], v[144:147], v[224:227]
    v_add_u32 v18, 65536, v18
    v_add_u32 v19, 65536, v19
    v_mfma_f32_16x16x32_bf16 v[228:231], v[204:207], v[148:151], v[228:231]
    ds_read_b64_tr_b16 v[184:185], v16 offset:0
    ds_read_b64_tr_b16 v[186:187], v16 offset:1024
    v_mfma_f32_16x16x32_bf16 v[232:235], v[208:211], v[144:147], v[232:235]
    ds_read_b64_tr_b16 v[188:189], v17 offset:0
    ds_read_b64_tr_b16 v[190:191], v17 offset:1024
    v_mfma_f32_16x16x32_bf16 v[236:239], v[208:211], v[148:151], v[236:239]
    ds_read_b64_tr_b16 v[192:193], v18 offset:0
    ds_read_b64_tr_b16 v[194:195], v18 offset:1024
    v_mfma_f32_16x16x32_bf16 v[240:243], v[212:215], v[144:147], v[240:243]
    ds_read_b64_tr_b16 v[196:197], v19 offset:0
    ds_read_b64_tr_b16 v[198:199], v19 offset:1024
    v_mfma_f32_16x16x32_bf16 v[244:247], v[212:215], v[148:151], v[244:247]
    s_waitcnt lgkmcnt(0)
    ds_read_b64_tr_b16 v[200:201], v16 offset:8192
    v_mfma_f32_16x16x32_bf16 v[216:219], v[184:187], v[152:155], v[216:219]
    ds_read_b64_tr_b16 v[202:203], v16 offset:9216
    v_mfma_f32_16x16x32_bf16 v[220:223], v[184:187], v[156:159], v[220:223]
    ds_read_b64_tr_b16 v[204:205], v17 offset:8192
    v_mfma_f32_16x16x32_bf16 v[224:227], v[188:191], v[152:155], v[224:227]
    ds_read_b64_tr_b16 v[206:207], v17 offset:9216
    v_mfma_f32_16x16x32_bf16 v[228:231], v[188:191], v[156:159], v[228:231]
    ds_read_b64_tr_b16 v[208:209], v18 offset:8192
    v_mfma_f32_16x16x32_bf16 v[232:235], v[192:195], v[152:155], v[232:235]
    ds_read_b64_tr_b16 v[210:211], v18 offset:9216
    v_mfma_f32_16x16x32_bf16 v[236:239], v[192:195], v[156:159], v[236:239]
    ds_read_b64_tr_b16 v[212:213], v19 offset:8192
    v_mfma_f32_16x16x32_bf16 v[240:243], v[196:199], v[152:155], v[240:243]
    ds_read_b64_tr_b16 v[214:215], v19 offset:9216
    v_mfma_f32_16x16x32_bf16 v[244:247], v[196:199], v[156:159], v[244:247]
    s_waitcnt lgkmcnt(0)
    ds_read_b64_tr_b16 v[184:185], v16 offset:16384
    v_mfma_f32_16x16x32_bf16 v[216:219], v[200:203], v[160:163], v[216:219]
    v_mov_b32 v108, 0
    v_mov_b32 v109, 0
    v_mov_b32 v110, 0
    v_mov_b32 v111, 0
    ds_read_b64_tr_b16 v[186:187], v16 offset:17408
    v_mfma_f32_16x16x32_bf16 v[220:223], v[200:203], v[164:167], v[220:223]
    v_mov_b32 v112, 0
    v_mov_b32 v113, 0
    v_mov_b32 v114, 0
    v_mov_b32 v115, 0
    ds_read_b64_tr_b16 v[188:189], v17 offset:16384
    v_mfma_f32_16x16x32_bf16 v[224:227], v[204:207], v[160:163], v[224:227]
    v_mov_b32 v116, 0
    v_mov_b32 v117, 0
    v_mov_b32 v118, 0
    v_mov_b32 v119, 0
    ds_read_b64_tr_b16 v[190:191], v17 offset:17408
    v_mfma_f32_16x16x32_bf16 v[228:231], v[204:207], v[164:167], v[228:231]
    v_mov_b32 v120, 0
    v_mov_b32 v121, 0
    v_mov_b32 v122, 0
    v_mov_b32 v123, 0
    ds_read_b64_tr_b16 v[192:193], v18 offset:16384
    v_mfma_f32_16x16x32_bf16 v[232:235], v[208:211], v[160:163], v[232:235]
    v_mov_b32 v124, 0
    v_mov_b32 v125, 0
    v_mov_b32 v126, 0
    v_mov_b32 v127, 0
    ds_read_b64_tr_b16 v[194:195], v18 offset:17408
    v_mfma_f32_16x16x32_bf16 v[236:239], v[208:211], v[164:167], v[236:239]
    v_mov_b32 v128, 0
    v_mov_b32 v129, 0
    v_mov_b32 v130, 0
    v_mov_b32 v131, 0
    ds_read_b64_tr_b16 v[196:197], v19 offset:16384
    v_mfma_f32_16x16x32_bf16 v[240:243], v[212:215], v[160:163], v[240:243]
    v_mov_b32 v132, 0
    v_mov_b32 v133, 0
    v_mov_b32 v134, 0
    v_mov_b32 v135, 0
    ds_read_b64_tr_b16 v[198:199], v19 offset:17408
    v_mfma_f32_16x16x32_bf16 v[244:247], v[212:215], v[164:167], v[244:247]
    v_mov_b32 v136, 0
    v_mov_b32 v137, 0
    v_mov_b32 v138, 0
    v_mov_b32 v139, 0
    s_waitcnt lgkmcnt(0)
    ds_read_b64_tr_b16 v[200:201], v16 offset:24576
    v_mfma_f32_16x16x32_bf16 v[216:219], v[184:187], v[168:171], v[216:219]
    v_mov_b32 v140, 0
    v_mov_b32 v141, 0
    v_mov_b32 v142, 0
    v_mov_b32 v143, 0
    ds_read_b64_tr_b16 v[202:203], v16 offset:25600
    v_mfma_f32_16x16x32_bf16 v[220:223], v[184:187], v[172:175], v[220:223]
    v_mov_b32 v144, 0
    v_mov_b32 v145, 0
    v_mov_b32 v146, 0
    v_mov_b32 v147, 0
    ds_read_b64_tr_b16 v[204:205], v17 offset:24576
    v_mfma_f32_16x16x32_bf16 v[224:227], v[188:191], v[168:171], v[224:227]
    v_mov_b32 v153, 0
    v_mov_b32 v159, 0
    ds_read_b64_tr_b16 v[206:207], v17 offset:25600
    v_mfma_f32_16x16x32_bf16 v[228:231], v[188:191], v[172:175], v[228:231]
    ds_read_b64_tr_b16 v[208:209], v18 offset:24576
    v_mfma_f32_16x16x32_bf16 v[232:235], v[192:195], v[168:171], v[232:235]
    ds_read_b64_tr_b16 v[210:211], v18 offset:25600
    v_mfma_f32_16x16x32_bf16 v[236:239], v[192:195], v[172:175], v[236:239]
    ds_read_b64_tr_b16 v[212:213], v19 offset:24576
    v_mfma_f32_16x16x32_bf16 v[240:243], v[196:199], v[168:171], v[240:243]
    ds_read_b64_tr_b16 v[214:215], v19 offset:25600
    v_mfma_f32_16x16x32_bf16 v[244:247], v[196:199], v[172:175], v[244:247]
    s_waitcnt lgkmcnt(0)
    v_mfma_f32_16x16x32_bf16 v[216:219], v[200:203], v[176:179], v[216:219]
    v_mfma_f32_16x16x32_bf16 v[220:223], v[200:203], v[180:183], v[220:223]
    v_mfma_f32_16x16x32_bf16 v[224:227], v[204:207], v[176:179], v[224:227]
    v_mfma_f32_16x16x32_bf16 v[228:231], v[204:207], v[180:183], v[228:231]
    v_mfma_f32_16x16x32_bf16 v[232:235], v[208:211], v[176:179], v[232:235]
    v_mfma_f32_16x16x32_bf16 v[236:239], v[208:211], v[180:183], v[236:239]
    v_mfma_f32_16x16x32_bf16 v[240:243], v[212:215], v[176:179], v[240:243]
    v_mfma_f32_16x16x32_bf16 v[244:247], v[212:215], v[180:183], v[244:247]
    s_nop 4
    v_cvt_pk_bf16_f32 v216, v216, v217
    v_cvt_pk_bf16_f32 v217, v218, v219
    v_cvt_pk_bf16_f32 v218, v220, v221
    v_cvt_pk_bf16_f32 v219, v222, v223
    v_cvt_pk_bf16_f32 v224, v224, v225
    v_cvt_pk_bf16_f32 v225, v226, v227
    v_cvt_pk_bf16_f32 v226, v228, v229
    v_cvt_pk_bf16_f32 v227, v230, v231
    v_permlane16_swap_b32 v216, v218
    v_permlane16_swap_b32 v217, v219
    s_add_u32 s25, s27, 0
    buffer_store_dwordx4 v[216:219], v5, s[8:11], s25 offen sc1
    v_cvt_pk_bf16_f32 v232, v232, v233
    v_cvt_pk_bf16_f32 v233, v234, v235
    v_cvt_pk_bf16_f32 v234, v236, v237
    v_cvt_pk_bf16_f32 v235, v238, v239
    v_permlane16_swap_b32 v224, v226
    v_permlane16_swap_b32 v225, v227
    s_add_u32 s25, s27, 65536
    buffer_store_dwordx4 v[224:227], v5, s[8:11], s25 offen sc1
    v_cvt_pk_bf16_f32 v240, v240, v241
    v_cvt_pk_bf16_f32 v241, v242, v243
    v_cvt_pk_bf16_f32 v242, v244, v245
    v_cvt_pk_bf16_f32 v243, v246, v247
    v_permlane16_swap_b32 v232, v234
    v_permlane16_swap_b32 v233, v235
    s_add_u32 s25, s27, 131072
    buffer_store_dwordx4 v[232:235], v5, s[8:11], s25 offen sc1
    s_nop 1
    v_permlane16_swap_b32 v240, v242
    v_permlane16_swap_b32 v241, v243
    s_add_u32 s25, s27, 196608
    buffer_store_dwordx4 v[240:243], v5, s[8:11], s25 offen sc1
    s_branch L_phase2
L_p1_ntype:
    s_waitcnt vmcnt(8)
    s_barrier
    ds_read_b128 v[24:27], v20 offset:16384
    ds_read_b64_tr_b16 v[184:185], v16 offset:0
    ds_read_b64_tr_b16 v[186:187], v16 offset:1024
    ds_read_b128 v[28:31], v20 offset:18432
    ds_read_b64_tr_b16 v[188:189], v17 offset:0
    ds_read_b64_tr_b16 v[190:191], v17 offset:1024
    ds_read_b64_tr_b16 v[192:193], v18 offset:0
    ds_read_b64_tr_b16 v[194:195], v18 offset:1024
    ds_read_b64_tr_b16 v[196:197], v19 offset:0
    ds_read_b64_tr_b16 v[198:199], v19 offset:1024
    s_waitcnt lgkmcnt(0)
    ds_read_b128 v[32:35], v21 offset:16384
    ds_read_b64_tr_b16 v[200:201], v16 offset:8192
    v_mfma_f32_16x16x32_bf16 v[216:219], v[24:27], v[184:187], 0
    ds_read_b64_tr_b16 v[202:203], v16 offset:9216
    ds_read_b128 v[36:39], v21 offset:18432
    v_mfma_f32_16x16x32_bf16 v[220:223], v[28:31], v[184:187], 0
    s_add_u32 m0, s28, 98304
    s_mov_b32 s26, 737280
    buffer_load_dwordx4 v7, s[60:63], s26 offen lds
    ds_read_b64_tr_b16 v[204:205], v17 offset:8192
    ds_read_b64_tr_b16 v[206:207], v17 offset:9216
    v_mfma_f32_16x16x32_bf16 v[224:227], v[24:27], v[188:191], 0
    ds_read_b64_tr_b16 v[208:209], v18 offset:8192
    ds_read_b64_tr_b16 v[210:211], v18 offset:9216
    v_mfma_f32_16x16x32_bf16 v[228:231], v[28:31], v[188:191], 0
    s_add_u32 m0, s28, 99328
    s_mov_b32 s26, 752640
    buffer_load_dwordx4 v7, s[60:63], s26 offen lds
    ds_read_b64_tr_b16 v[212:213], v19 offset:8192
    ds_read_b64_tr_b16 v[214:215], v19 offset:9216
    v_mfma_f32_16x16x32_bf16 v[232:235], v[24:27], v[192:195], 0
    v_mfma_f32_16x16x32_bf16 v[236:239], v[28:31], v[192:195], 0
    s_add_u32 m0, s28, 114688
    s_mov_b32 s26, 384
    buffer_load_dwordx4 v5, s[56:59], s26 offen lds
    v_mfma_f32_16x16x32_bf16 v[240:243], v[24:27], v[196:199], 0
    v_mfma_f32_16x16x32_bf16 v[244:247], v[28:31], v[196:199], 0
    s_add_u32 m0, s28, 115712
    s_mov_b32 s26, 384
    buffer_load_dwordx4 v6, s[56:59], s26 offen lds
    s_waitcnt lgkmcnt(0)
    v_mfma_f32_16x16x32_bf16 v[216:219], v[32:35], v[200:203], v[216:219]
    v_mfma_f32_16x16x32_bf16 v[220:223], v[36:39], v[200:203], v[220:223]
    s_waitcnt vmcnt(8)
    s_barrier
    ds_read_b128 v[40:43], v20 offset:49152
    ds_read_b64_tr_b16 v[184:185], v16 offset:32768
    v_mfma_f32_16x16x32_bf16 v[224:227], v[32:35], v[204:207], v[224:227]
    ds_read_b64_tr_b16 v[186:187], v16 offset:33792
    ds_read_b128 v[44:47], v20 offset:51200
    v_mfma_f32_16x16x32_bf16 v[228:231], v[36:39], v[204:207], v[228:231]
    s_add_u32 m0, s28, 131072
    s_mov_b32 s26, 983040
    buffer_load_dwordx4 v7, s[60:63], s26 offen lds
    ds_read_b64_tr_b16 v[188:189], v17 offset:32768
    ds_read_b64_tr_b16 v[190:191], v17 offset:33792
    v_mfma_f32_16x16x32_bf16 v[232:235], v[32:35], v[208:211], v[232:235]
    ds_read_b64_tr_b16 v[192:193], v18 offset:32768
    ds_read_b64_tr_b16 v[194:195], v18 offset:33792
    v_mfma_f32_16x16x32_bf16 v[236:239], v[36:39], v[208:211], v[236:239]
    s_add_u32 m0, s28, 132096
    s_mov_b32 s26, 998400
    buffer_load_dwordx4 v7, s[60:63], s26 offen lds
    ds_read_b64_tr_b16 v[196:197], v19 offset:32768
    ds_read_b64_tr_b16 v[198:199], v19 offset:33792
    v_mfma_f32_16x16x32_bf16 v[240:243], v[32:35], v[212:215], v[240:243]
    v_mfma_f32_16x16x32_bf16 v[244:247], v[36:39], v[212:215], v[244:247]
    s_add_u32 m0, s28, 147456
    s_mov_b32 s26, 512
    buffer_load_dwordx4 v5, s[56:59], s26 offen lds
    s_waitcnt lgkmcnt(0)
    ds_read_b128 v[48:51], v21 offset:49152
    ds_read_b64_tr_b16 v[200:201], v16 offset:40960
    v_mfma_f32_16x16x32_bf16 v[216:219], v[40:43], v[184:187], v[216:219]
    ds_read_b64_tr_b16 v[202:203], v16 offset:41984
    ds_read_b128 v[52:55], v21 offset:51200
    v_mfma_f32_16x16x32_bf16 v[220:223], v[44:47], v[184:187], v[220:223]
    s_add_u32 m0, s28, 148480
    s_mov_b32 s26, 512
    buffer_load_dwordx4 v6, s[56:59], s26 offen lds
    ds_read_b64_tr_b16 v[204:205], v17 offset:40960
    ds_read_b64_tr_b16 v[206:207], v17 offset:41984
    v_mfma_f32_16x16x32_bf16 v[224:227], v[40:43], v[188:191], v[224:227]
    ds_read_b64_tr_b16 v[208:209], v18 offset:40960
    ds_read_b64_tr_b16 v[210:211], v18 offset:41984
    v_mfma_f32_16x16x32_bf16 v[228:231], v[44:47], v[188:191], v[228:231]
    s_add_u32 m0, s28, 0
    s_mov_b32 s26, 1228800
    buffer_load_dwordx4 v7, s[60:63], s26 offen lds
    ds_read_b64_tr_b16 v[212:213], v19 offset:40960
    ds_read_b64_tr_b16 v[214:215], v19 offset:41984
    v_mfma_f32_16x16x32_bf16 v[232:235], v[40:43], v[192:195], v[232:235]
    v_mfma_f32_16x16x32_bf16 v[236:239], v[44:47], v[192:195], v[236:239]
    s_add_u32 m0, s28, 1024
    s_mov_b32 s26, 1244160
    buffer_load_dwordx4 v7, s[60:63], s26 offen lds
    v_mfma_f32_16x16x32_bf16 v[240:243], v[40:43], v[196:199], v[240:243]
    v_mfma_f32_16x16x32_bf16 v[244:247], v[44:47], v[196:199], v[244:247]
    s_add_u32 m0, s28, 16384
    s_mov_b32 s26, 640
    buffer_load_dwordx4 v5, s[56:59], s26 offen lds
    s_waitcnt lgkmcnt(0)
    v_mfma_f32_16x16x32_bf16 v[216:219], v[48:51], v[200:203], v[216:219]
    v_mfma_f32_16x16x32_bf16 v[220:223], v[52:55], v[200:203], v[220:223]
    s_waitcnt vmcnt(11)
    s_barrier
    v_add_u32 v16, 65536, v16
    v_add_u32 v17, 65536, v17
    v_add_u32 v18, 65536, v18
    v_mfma_f32_16x16x32_bf16 v[224:227], v[48:51], v[204:207], v[224:227]
    v_add_u32 v19, 65536, v19
    v_add_u32 v20, 65536, v20
    v_add_u32 v21, 65536, v21
    v_mfma_f32_16x16x32_bf16 v[228:231], v[52:55], v[204:207], v[228:231]
    s_add_u32 m0, s28, 17408
    s_mov_b32 s26, 640
    buffer_load_dwordx4 v6, s[56:59], s26 offen lds
    ds_read_b128 v[56:59], v20 offset:16384
    ds_read_b64_tr_b16 v[184:185], v16 offset:0
    ds_read_b64_tr_b16 v[186:187], v16 offset:1024
    v_mfma_f32_16x16x32_bf16 v[232:235], v[48:51], v[208:211], v[232:235]
    ds_read_b128 v[60:63], v20 offset:18432
    ds_read_b64_tr_b16 v[188:189], v17 offset:0
    ds_read_b64_tr_b16 v[190:191], v17 offset:1024
    v_mfma_f32_16x16x32_bf16 v[236:239], v[52:55], v[208:211], v[236:239]
    s_add_u32 m0, s28, 32768
    s_mov_b32 s26, 1474560
    buffer_load_dwordx4 v7, s[60:63], s26 offen lds
    ds_read_b64_tr_b16 v[192:193], v18 offset:0
    ds_read_b64_tr_b16 v[194:195], v18 offset:1024
    ds_read_b64_tr_b16 v[196:197], v19 offset:0
    v_mfma_f32_16x16x32_bf16 v[240:243], v[48:51], v[212:215], v[240:243]
    ds_read_b64_tr_b16 v[198:199], v19 offset:1024
    v_mfma_f32_16x16x32_bf16 v[244:247], v[52:55], v[212:215], v[244:247]
    s_add_u32 m0, s28, 33792
    s_mov_b32 s26, 1489920
    buffer_load_dwordx4 v7, s[60:63], s26 offen lds
    s_waitcnt lgkmcnt(0)
    ds_read_b128 v[64:67], v21 offset:16384
    ds_read_b64_tr_b16 v[200:201], v16 offset:8192
    v_mfma_f32_16x16x32_bf16 v[216:219], v[56:59], v[184:187], v[216:219]
    ds_read_b64_tr_b16 v[202:203], v16 offset:9216
    ds_read_b128 v[68:71], v21 offset:18432
    v_mfma_f32_16x16x32_bf16 v[220:223], v[60:63], v[184:187], v[220:223]
    s_add_u32 m0, s28, 49152
    s_mov_b32 s26, 768
    buffer_load_dwordx4 v5, s[56:59], s26 offen lds
    ds_read_b64_tr_b16 v[204:205], v17 offset:8192
    ds_read_b64_tr_b16 v[206:207], v17 offset:9216
    v_mfma_f32_16x16x32_bf16 v[224:227], v[56:59], v[188:191], v[224:227]
    ds_read_b64_tr_b16 v[208:209], v18 offset:8192
    ds_read_b64_tr_b16 v[210:211], v18 offset:9216
    v_mfma_f32_16x16x32_bf16 v[228:231], v[60:63], v[188:191], v[228:231]
    s_add_u32 m0, s28, 50176
    s_mov_b32 s26, 768
    buffer_load_dwordx4 v6, s[56:59], s26 offen lds
    ds_read_b64_tr_b16 v[212:213], v19 offset:8192
    ds_read_b64_tr_b16 v[214:215], v19 offset:9216
    v_mfma_f32_16x16x32_bf16 v[232:235], v[56:59], v[192:195], v[232:235]
    v_mfma_f32_16x16x32_bf16 v[236:239], v[60:63], v[192:195], v[236:239]
    v_mfma_f32_16x16x32_bf16 v[240:243], v[56:59], v[196:199], v[240:243]
    v_mfma_f32_16x16x32_bf16 v[244:247], v[60:63], v[196:199], v[244:247]
    s_waitcnt lgkmcnt(0)
    v_mfma_f32_16x16x32_bf16 v[216:219], v[64:67], v[200:203], v[216:219]
    v_mfma_f32_16x16x32_bf16 v[220:223], v[68:71], v[200:203], v[220:223]
    s_waitcnt vmcnt(12)
    s_barrier
    ds_read_b128 v[72:75], v20 offset:49152
    ds_read_b64_tr_b16 v[184:185], v16 offset:32768
    v_mfma_f32_16x16x32_bf16 v[224:227], v[64:67], v[204:207], v[224:227]
    ds_read_b64_tr_b16 v[186:187], v16 offset:33792
    ds_read_b128 v[76:79], v20 offset:51200
    v_mfma_f32_16x16x32_bf16 v[228:231], v[68:71], v[204:207], v[228:231]
    s_add_u32 m0, s28, 65536
    s_mov_b32 s26, 1720320
    buffer_load_dwordx4 v7, s[60:63], s26 offen lds
    ds_read_b64_tr_b16 v[188:189], v17 offset:32768
    ds_read_b64_tr_b16 v[190:191], v17 offset:33792
    v_mfma_f32_16x16x32_bf16 v[232:235], v[64:67], v[208:211], v[232:235]
    ds_read_b64_tr_b16 v[192:193], v18 offset:32768
    ds_read_b64_tr_b16 v[194:195], v18 offset:33792
    v_mfma_f32_16x16x32_bf16 v[236:239], v[68:71], v[208:211], v[236:239]
    s_add_u32 m0, s28, 66560
    s_mov_b32 s26, 1735680
    buffer_load_dwordx4 v7, s[60:63], s26 offen lds
    ds_read_b64_tr_b16 v[196:197], v19 offset:32768
    ds_read_b64_tr_b16 v[198:199], v19 offset:33792
    v_mfma_f32_16x16x32_bf16 v[240:243], v[64:67], v[212:215], v[240:243]
    v_mfma_f32_16x16x32_bf16 v[244:247], v[68:71], v[212:215], v[244:247]
    s_add_u32 m0, s28, 81920
    s_mov_b32 s26, 896
    buffer_load_dwordx4 v5, s[56:59], s26 offen lds
    s_waitcnt lgkmcnt(0)
    ds_read_b128 v[80:83], v21 offset:49152
    ds_read_b64_tr_b16 v[200:201], v16 offset:40960
    v_mfma_f32_16x16x32_bf16 v[216:219], v[72:75], v[184:187], v[216:219]
    ds_read_b64_tr_b16 v[202:203], v16 offset:41984
    ds_read_b128 v[84:87], v21 offset:51200
    v_mfma_f32_16x16x32_bf16 v[220:223], v[76:79], v[184:187], v[220:223]
    s_add_u32 m0, s28, 82944
    s_mov_b32 s26, 896
    buffer_load_dwordx4 v6, s[56:59], s26 offen lds
    ds_read_b64_tr_b16 v[204:205], v17 offset:40960
    ds_read_b64_tr_b16 v[206:207], v17 offset:41984
    v_mfma_f32_16x16x32_bf16 v[224:227], v[72:75], v[188:191], v[224:227]
    ds_read_b64_tr_b16 v[208:209], v18 offset:40960
    ds_read_b64_tr_b16 v[210:211], v18 offset:41984
    v_mfma_f32_16x16x32_bf16 v[228:231], v[76:79], v[188:191], v[228:231]
    ds_read_b64_tr_b16 v[212:213], v19 offset:40960
    ds_read_b64_tr_b16 v[214:215], v19 offset:41984
    v_mfma_f32_16x16x32_bf16 v[232:235], v[72:75], v[192:195], v[232:235]
    v_mfma_f32_16x16x32_bf16 v[236:239], v[76:79], v[192:195], v[236:239]
    v_mfma_f32_16x16x32_bf16 v[240:243], v[72:75], v[196:199], v[240:243]
    v_mfma_f32_16x16x32_bf16 v[244:247], v[76:79], v[196:199], v[244:247]
    s_waitcnt lgkmcnt(0)
    v_mfma_f32_16x16x32_bf16 v[216:219], v[80:83], v[200:203], v[216:219]
    v_mfma_f32_16x16x32_bf16 v[220:223], v[84:87], v[200:203], v[220:223]
    s_waitcnt vmcnt(12)
    s_barrier
    v_add_u32 v16, 65536, v16
    v_add_u32 v17, 65536, v17
    v_add_u32 v18, 65536, v18
    v_mfma_f32_16x16x32_bf16 v[224:227], v[80:83], v[204:207], v[224:227]
    v_add_u32 v19, 65536, v19
    v_add_u32 v20, 65536, v20
    v_add_u32 v21, 65536, v21
    v_mfma_f32_16x16x32_bf16 v[228:231], v[84:87], v[204:207], v[228:231]
    s_add_u32 m0, s28, 98304
    s_mov_b32 s26, 1966080
    buffer_load_dwordx4 v7, s[60:63], s26 offen lds
    ds_read_b128 v[88:91], v20 offset:16384
    ds_read_b64_tr_b16 v[184:185], v16 offset:0
    ds_read_b64_tr_b16 v[186:187], v16 offset:1024
    v_mfma_f32_16x16x32_bf16 v[232:235], v[80:83], v[208:211], v[232:235]
    ds_read_b128 v[92:95], v20 offset:18432
    ds_read_b64_tr_b16 v[188:189], v17 offset:0
    ds_read_b64_tr_b16 v[190:191], v17 offset:1024
    v_mfma_f32_16x16x32_bf16 v[236:239], v[84:87], v[208:211], v[236:239]
    s_add_u32 m0, s28, 99328
    s_mov_b32 s26, 1981440
    buffer_load_dwordx4 v7, s[60:63], s26 offen lds
    ds_read_b64_tr_b16 v[192:193], v18 offset:0
    ds_read_b64_tr_b16 v[194:195], v18 offset:1024
    ds_read_b64_tr_b16 v[196:197], v19 offset:0
    v_mfma_f32_16x16x32_bf16 v[240:243], v[80:83], v[212:215], v[240:243]
    ds_read_b64_tr_b16 v[198:199], v19 offset:1024
    v_mfma_f32_16x16x32_bf16 v[244:247], v[84:87], v[212:215], v[244:247]
    s_add_u32 m0, s28, 114688
    s_mov_b32 s26, 1024
    buffer_load_dwordx4 v5, s[56:59], s26 offen lds
    s_waitcnt lgkmcnt(0)
    ds_read_b128 v[96:99], v21 offset:16384
    ds_read_b64_tr_b16 v[200:201], v16 offset:8192
    v_mfma_f32_16x16x32_bf16 v[216:219], v[88:91], v[184:187], v[216:219]
    ds_read_b64_tr_b16 v[202:203], v16 offset:9216
    ds_read_b128 v[100:103], v21 offset:18432
    v_mfma_f32_16x16x32_bf16 v[220:223], v[92:95], v[184:187], v[220:223]
    s_add_u32 m0, s28, 115712
    s_mov_b32 s26, 1024
    buffer_load_dwordx4 v6, s[56:59], s26 offen lds
    ds_read_b64_tr_b16 v[204:205], v17 offset:8192
    ds_read_b64_tr_b16 v[206:207], v17 offset:9216
    v_mfma_f32_16x16x32_bf16 v[224:227], v[88:91], v[188:191], v[224:227]
    ds_read_b64_tr_b16 v[208:209], v18 offset:8192
    ds_read_b64_tr_b16 v[210:211], v18 offset:9216
    v_mfma_f32_16x16x32_bf16 v[228:231], v[92:95], v[188:191], v[228:231]
    ds_read_b64_tr_b16 v[212:213], v19 offset:8192
    ds_read_b64_tr_b16 v[214:215], v19 offset:9216
    v_mfma_f32_16x16x32_bf16 v[232:235], v[88:91], v[192:195], v[232:235]
    v_mfma_f32_16x16x32_bf16 v[236:239], v[92:95], v[192:195], v[236:239]
    v_mfma_f32_16x16x32_bf16 v[240:243], v[88:91], v[196:199], v[240:243]
    v_mfma_f32_16x16x32_bf16 v[244:247], v[92:95], v[196:199], v[244:247]
    s_waitcnt lgkmcnt(0)
    v_mfma_f32_16x16x32_bf16 v[216:219], v[96:99], v[200:203], v[216:219]
    v_mfma_f32_16x16x32_bf16 v[220:223], v[100:103], v[200:203], v[220:223]
    s_waitcnt vmcnt(12)
    s_barrier
    v_add_u32 v16, 4294836224, v16
    v_add_u32 v17, 4294836224, v17
    v_add_u32 v18, 4294836224, v18
    v_mfma_f32_16x16x32_bf16 v[224:227], v[96:99], v[204:207], v[224:227]
    v_add_u32 v19, 4294836224, v19
    v_add_u32 v20, 4294836224, v20
    v_add_u32 v21, 4294836224, v21
    v_mfma_f32_16x16x32_bf16 v[228:231], v[100:103], v[204:207], v[228:231]
    s_add_u32 m0, s28, 131072
    s_mov_b32 s26, 2211840
    buffer_load_dwordx4 v7, s[60:63], s26 offen lds
    ds_read_b128 v[104:107], v20 offset:16384
    ds_read_b64_tr_b16 v[184:185], v16 offset:0
    ds_read_b64_tr_b16 v[186:187], v16 offset:1024
    v_mfma_f32_16x16x32_bf16 v[232:235], v[96:99], v[208:211], v[232:235]
    ds_read_b128 v[108:111], v20 offset:18432
    ds_read_b64_tr_b16 v[188:189], v17 offset:0
    ds_read_b64_tr_b16 v[190:191], v17 offset:1024
    v_mfma_f32_16x16x32_bf16 v[236:239], v[100:103], v[208:211], v[236:239]
    s_add_u32 m0, s28, 132096
    s_mov_b32 s26, 2227200
    buffer_load_dwordx4 v7, s[60:63], s26 offen lds
    ds_read_b64_tr_b16 v[192:193], v18 offset:0
    ds_read_b64_tr_b16 v[194:195], v18 offset:1024
    ds_read_b64_tr_b16 v[196:197], v19 offset:0
    v_mfma_f32_16x16x32_bf16 v[240:243], v[96:99], v[212:215], v[240:243]
    ds_read_b64_tr_b16 v[198:199], v19 offset:1024
    v_mfma_f32_16x16x32_bf16 v[244:247], v[100:103], v[212:215], v[244:247]
    s_add_u32 m0, s28, 147456
    s_mov_b32 s26, 1152
    buffer_load_dwordx4 v5, s[56:59], s26 offen lds
    s_waitcnt lgkmcnt(0)
    s_cmp_ge_u32 s3, 4
    s_cbranch_scc0 L_lt_13
    buffer_load_dword v23, v1, s[32:35], s44 offen
L_lt_13:
    ds_read_b128 v[112:115], v21 offset:16384
    ds_read_b64_tr_b16 v[200:201], v16 offset:8192
    v_mfma_f32_16x16x32_bf16 v[216:219], v[104:107], v[184:187], v[216:219]
    ds_read_b64_tr_b16 v[202:203], v16 offset:9216
    ds_read_b128 v[116:119], v21 offset:18432
    v_mfma_f32_16x16x32_bf16 v[220:223], v[108:111], v[184:187], v[220:223]
    s_add_u32 m0, s28, 148480
    s_mov_b32 s26, 1152
    buffer_load_dwordx4 v6, s[56:59], s26 offen lds
    ds_read_b64_tr_b16 v[204:205], v17 offset:8192
    ds_read_b64_tr_b16 v[206:207], v17 offset:9216
    v_mfma_f32_16x16x32_bf16 v[224:227], v[104:107], v[188:191], v[224:227]
    ds_read_b64_tr_b16 v[208:209], v18 offset:8192
    ds_read_b64_tr_b16 v[210:211], v18 offset:9216
    v_mfma_f32_16x16x32_bf16 v[228:231], v[108:111], v[188:191], v[228:231]
    ds_read_b64_tr_b16 v[212:213], v19 offset:8192
    ds_read_b64_tr_b16 v[214:215], v19 offset:9216
    v_mfma_f32_16x16x32_bf16 v[232:235], v[104:107], v[192:195], v[232:235]
    v_mfma_f32_16x16x32_bf16 v[236:239], v[108:111], v[192:195], v[236:239]
    v_mfma_f32_16x16x32_bf16 v[240:243], v[104:107], v[196:199], v[240:243]
    v_mfma_f32_16x16x32_bf16 v[244:247], v[108:111], v[196:199], v[244:247]
    s_waitcnt lgkmcnt(0)
    v_mfma_f32_16x16x32_bf16 v[216:219], v[112:115], v[200:203], v[216:219]
    v_mfma_f32_16x16x32_bf16 v[220:223], v[116:119], v[200:203], v[220:223]
    s_waitcnt vmcnt(12)
    s_barrier
    ds_read_b128 v[120:123], v20 offset:49152
    ds_read_b64_tr_b16 v[184:185], v16 offset:32768
    v_mfma_f32_16x16x32_bf16 v[224:227], v[112:115], v[204:207], v[224:227]
    ds_read_b64_tr_b16 v[186:187], v16 offset:33792
    ds_read_b128 v[124:127], v20 offset:51200
    v_mfma_f32_16x16x32_bf16 v[228:231], v[116:119], v[204:207], v[228:231]
    ds_read_b64_tr_b16 v[188:189], v17 offset:32768
    ds_read_b64_tr_b16 v[190:191], v17 offset:33792
    v_mfma_f32_16x16x32_bf16 v[232:235], v[112:115], v[208:211], v[232:235]
    ds_read_b64_tr_b16 v[192:193], v18 offset:32768
    ds_read_b64_tr_b16 v[194:195], v18 offset:33792
    v_mfma_f32_16x16x32_bf16 v[236:239], v[116:119], v[208:211], v[236:239]
    ds_read_b64_tr_b16 v[196:197], v19 offset:32768
    ds_read_b64_tr_b16 v[198:199], v19 offset:33792
    v_mfma_f32_16x16x32_bf16 v[240:243], v[112:115], v[212:215], v[240:243]
    v_mfma_f32_16x16x32_bf16 v[244:247], v[116:119], v[212:215], v[244:247]
    s_waitcnt lgkmcnt(0)
    ds_read_b128 v[128:131], v21 offset:49152
    ds_read_b64_tr_b16 v[200:201], v16 offset:40960
    v_mfma_f32_16x16x32_bf16 v[216:219], v[120:123], v[184:187], v[216:219]
    ds_read_b64_tr_b16 v[202:203], v16 offset:41984
    ds_read_b128 v[132:135], v21 offset:51200
    v_mfma_f32_16x16x32_bf16 v[220:223], v[124:127], v[184:187], v[220:223]
    ds_read_b64_tr_b16 v[204:205], v17 offset:40960
    ds_read_b64_tr_b16 v[206:207], v17 offset:41984
    v_mfma_f32_16x16x32_bf16 v[224:227], v[120:123], v[188:191], v[224:227]
    ds_read_b64_tr_b16 v[208:209], v18 offset:40960
    ds_read_b64_tr_b16 v[210:211], v18 offset:41984
    v_mfma_f32_16x16x32_bf16 v[228:231], v[124:127], v[188:191], v[228:231]
    ds_read_b64_tr_b16 v[212:213], v19 offset:40960
    ds_read_b64_tr_b16 v[214:215], v19 offset:41984
    v_mfma_f32_16x16x32_bf16 v[232:235], v[120:123], v[192:195], v[232:235]
    v_mfma_f32_16x16x32_bf16 v[236:239], v[124:127], v[192:195], v[236:239]
    v_mfma_f32_16x16x32_bf16 v[240:243], v[120:123], v[196:199], v[240:243]
    v_mfma_f32_16x16x32_bf16 v[244:247], v[124:127], v[196:199], v[244:247]
    s_waitcnt lgkmcnt(0)
    v_mfma_f32_16x16x32_bf16 v[216:219], v[128:131], v[200:203], v[216:219]
    v_mfma_f32_16x16x32_bf16 v[220:223], v[132:135], v[200:203], v[220:223]
    s_waitcnt vmcnt(8)
    s_barrier
    v_add_u32 v16, 65536, v16
    v_add_u32 v17, 65536, v17
    v_add_u32 v18, 65536, v18
    v_mfma_f32_16x16x32_bf16 v[224:227], v[128:131], v[204:207], v[224:227]
    v_add_u32 v19, 65536, v19
    v_add_u32 v20, 65536, v20
    v_add_u32 v21, 65536, v21
    v_mfma_f32_16x16x32_bf16 v[228:231], v[132:135], v[204:207], v[228:231]
    ds_read_b128 v[136:139], v20 offset:16384
    ds_read_b64_tr_b16 v[184:185], v16 offset:0
    ds_read_b64_tr_b16 v[186:187], v16 offset:1024
    v_mfma_f32_16x16x32_bf16 v[232:235], v[128:131], v[208:211], v[232:235]
    ds_read_b128 v[140:143], v20 offset:18432
    ds_read_b64_tr_b16 v[188:189], v17 offset:0
    ds_read_b64_tr_b16 v[190:191], v17 offset:1024
    v_mfma_f32_16x16x32_bf16 v[236:239], v[132:135], v[208:211], v[236:239]
    ds_read_b64_tr_b16 v[192:193], v18 offset:0
    ds_read_b64_tr_b16 v[194:195], v18 offset:1024
    ds_read_b64_tr_b16 v[196:197], v19 offset:0
    v_mfma_f32_16x16x32_bf16 v[240:243], v[128:131], v[212:215], v[240:243]
    ds_read_b64_tr_b16 v[198:199], v19 offset:1024
    v_mfma_f32_16x16x32_bf16 v[244:247], v[132:135], v[212:215], v[244:247]
    s_waitcnt lgkmcnt(0)
    ds_read_b128 v[144:147], v21 offset:16384
    ds_read_b64_tr_b16 v[200:201], v16 offset:8192
    v_mfma_f32_16x16x32_bf16 v[216:219], v[136:139], v[184:187], v[216:219]
    ds_read_b64_tr_b16 v[202:203], v16 offset:9216
    ds_read_b128 v[148:151], v21 offset:18432
    v_mfma_f32_16x16x32_bf16 v[220:223], v[140:143], v[184:187], v[220:223]
    ds_read_b64_tr_b16 v[204:205], v17 offset:8192
    ds_read_b64_tr_b16 v[206:207], v17 offset:9216
    v_mfma_f32_16x16x32_bf16 v[224:227], v[136:139], v[188:191], v[224:227]
    ds_read_b64_tr_b16 v[208:209], v18 offset:8192
    ds_read_b64_tr_b16 v[210:211], v18 offset:9216
    v_mfma_f32_16x16x32_bf16 v[228:231], v[140:143], v[188:191], v[228:231]
    ds_read_b64_tr_b16 v[212:213], v19 offset:8192
    ds_read_b64_tr_b16 v[214:215], v19 offset:9216
    v_mfma_f32_16x16x32_bf16 v[232:235], v[136:139], v[192:195], v[232:235]
    v_mfma_f32_16x16x32_bf16 v[236:239], v[140:143], v[192:195], v[236:239]
    v_mfma_f32_16x16x32_bf16 v[240:243], v[136:139], v[196:199], v[240:243]
    v_mfma_f32_16x16x32_bf16 v[244:247], v[140:143], v[196:199], v[244:247]
    s_lshl_b32 s25, s3, 2
    v_add_u32 v8, s25, v4
    v_min_u32 v8, 24, v8
    v_mul_u32_u24 v9, 52, v8
    v_lshrrev_b32 v9, 8, v9
    v_mul_u32_u24 v10, 5, v9
    v_sub_u32 v10, v8, v10
    s_and_b32 s25, s20, 15
    s_lshl_b32 s27, s25, 1
    s_cmp_lt_u32 s25, 8
    s_cselect_b32 s26, 64, 0
    s_add_u32 s27, s27, s26
    v_add_u32 v11, s27, v9
    s_mul_i32 s27, s25, 3
    s_cmp_ge_u32 s25, 5
    s_cselect_b32 s26, 15, -1
    s_add_u32 s26, s26, s27
    v_add_u32 v12, s26, v9
    s_cmp_ge_u32 s25, 6
    s_cselect_b32 s26, 16, 0
    s_add_u32 s26, s26, s27
    v_cmp_gt_u32 vcc, 2, v9
    v_mov_b32 v13, s26
    s_lshr_b32 s25, s20, 4
    v_cndmask_b32 v11, v12, v11, vcc
    v_cmp_eq_u32 vcc, 4, v9
    s_mul_i32 s25, s25, 5120
    s_nop 0
    v_cndmask_b32 v11, v11, v13, vcc
    v_lshrrev_b32 v12, 2, v11
    v_and_b32 v11, 3, v11
    v_mul_u32_u24 v13, 10240, v12
    v_add_u32 v13, s25, v13
    v_lshl_add_u32 v13, v10, 10, v13
    v_lshl_add_u32 v13, v11, 8, v13
    v_lshl_add_u32 v13, v3, 4, v13
    s_mul_i32 s27, s19, 204800
    s_add_u32 s27, s27, 22552576
    v_add_u32 v176, s27, v13
    s_mul_i32 s27, s20, 25600
    s_mul_i32 s26, s19, 160
    s_add_u32 s27, s27, s26
    v_lshlrev_b32 v11, 5, v10
    v_lshl_add_u32 v11, v3, 1, v11
    v_add_u32 v11, s27, v11

    v_and_b32 v12, 1, v9
    v_lshl_add_u32 v12, v12, 2, 0
    v_cmp_eq_u32 vcc, 4, v9
    v_lshrrev_b32 v13, 1, v9
    v_mov_b32 v8, 16
    v_mov_b32 v10, 0
    v_cndmask_b32 v12, v12, v8, vcc
    v_cndmask_b32 v13, v13, v10, vcc
    v_cmp_eq_u32 vcc, 0, v13
    v_mov_b32 v8, s48
    v_mov_b32 v10, s42
    v_mov_b32 v13, s49
    v_cndmask_b32 v8, v8, v10, vcc
    v_mov_b32 v10, s43
    v_cndmask_b32 v179, v13, v10, vcc
    v_mul_u32_u24 v12, 1280, v12
    v_add_u32 v12, v12, v11
    v_add_co_u32 v178, vcc, v8, v12
    s_nop 1
    v_addc_co_u32 v179, vcc, 0, v179, vcc

    global_load_ushort v168, v[178:179], off offset:0
    global_load_ushort v169, v[178:179], off offset:1280
    global_load_ushort v170, v[178:179], off offset:2560
    global_load_ushort v171, v[178:179], off offset:3840
    v_and_b32 v12, 1, v9
    v_lshl_add_u32 v12, v12, 2, 8
    v_cmp_eq_u32 vcc, 4, v9
    v_lshrrev_b32 v13, 1, v9
    v_mov_b32 v8, 16
    v_mov_b32 v10, 1
    v_cndmask_b32 v12, v12, v8, vcc
    v_cndmask_b32 v13, v13, v10, vcc
    v_cmp_eq_u32 vcc, 0, v13
    v_mov_b32 v8, s48
    v_mov_b32 v10, s42
    v_mov_b32 v13, s49
    v_cndmask_b32 v8, v8, v10, vcc
    v_mov_b32 v10, s43
    v_cndmask_b32 v181, v13, v10, vcc
    v_mul_u32_u24 v12, 1280, v12
    v_add_u32 v12, v12, v11
    v_add_co_u32 v180, vcc, v8, v12
    s_nop 1
    v_addc_co_u32 v181, vcc, 0, v181, vcc

    global_load_ushort v172, v[180:181], off offset:0
    global_load_ushort v173, v[180:181], off offset:1280
    global_load_ushort v174, v[180:181], off offset:2560
    global_load_ushort v175, v[180:181], off offset:3840
    s_waitcnt lgkmcnt(0)
    v_mfma_f32_16x16x32_bf16 v[216:219], v[144:147], v[200:203], v[216:219]
    v_mfma_f32_16x16x32_bf16 v[220:223], v[148:151], v[200:203], v[220:223]
    s_waitcnt vmcnt(12)
    s_barrier
    ds_read_b128 v[152:155], v20 offset:49152
    ds_read_b64_tr_b16 v[184:185], v16 offset:32768
    v_mfma_f32_16x16x32_bf16 v[224:227], v[144:147], v[204:207], v[224:227]
    ds_read_b64_tr_b16 v[186:187], v16 offset:33792
    ds_read_b128 v[156:159], v20 offset:51200
    v_mfma_f32_16x16x32_bf16 v[228:231], v[148:151], v[204:207], v[228:231]
    s_mov_b32 s60, s38
    s_mov_b32 s61, s39
    s_add_u32 m0, s28, 0
    s_mov_b32 s26, 0
    buffer_load_dwordx4 v7, s[60:63], s26 offen lds
    ds_read_b64_tr_b16 v[188:189], v17 offset:32768
    ds_read_b64_tr_b16 v[190:191], v17 offset:33792
    v_mfma_f32_16x16x32_bf16 v[232:235], v[144:147], v[208:211], v[232:235]
    ds_read_b64_tr_b16 v[192:193], v18 offset:32768
    ds_read_b64_tr_b16 v[194:195], v18 offset:33792
    v_mfma_f32_16x16x32_bf16 v[236:239], v[148:151], v[208:211], v[236:239]
    s_add_u32 m0, s28, 1024
    s_mov_b32 s26, 15360
    buffer_load_dwordx4 v7, s[60:63], s26 offen lds
    ds_read_b64_tr_b16 v[196:197], v19 offset:32768
    ds_read_b64_tr_b16 v[198:199], v19 offset:33792
    v_mfma_f32_16x16x32_bf16 v[240:243], v[144:147], v[212:215], v[240:243]
    v_mfma_f32_16x16x32_bf16 v[244:247], v[148:151], v[212:215], v[244:247]
    s_add_u32 m0, s28, 16384
    s_mov_b32 s26, 245760
    buffer_load_dwordx4 v7, s[60:63], s26 offen lds
    s_waitcnt lgkmcnt(0)
    ds_read_b128 v[160:163], v21 offset:49152
    ds_read_b64_tr_b16 v[200:201], v16 offset:40960
    v_mfma_f32_16x16x32_bf16 v[216:219], v[152:155], v[184:187], v[216:219]
    ds_read_b64_tr_b16 v[202:203], v16 offset:41984
    ds_read_b128 v[164:167], v21 offset:51200
    v_mfma_f32_16x16x32_bf16 v[220:223], v[156:159], v[184:187], v[220:223]
    s_add_u32 m0, s28, 17408
    s_mov_b32 s26, 261120
    buffer_load_dwordx4 v7, s[60:63], s26 offen lds
    ds_read_b64_tr_b16 v[204:205], v17 offset:40960
    ds_read_b64_tr_b16 v[206:207], v17 offset:41984
    v_mfma_f32_16x16x32_bf16 v[224:227], v[152:155], v[188:191], v[224:227]
    ds_read_b64_tr_b16 v[208:209], v18 offset:40960
    ds_read_b64_tr_b16 v[210:211], v18 offset:41984
    v_mfma_f32_16x16x32_bf16 v[228:231], v[156:159], v[188:191], v[228:231]
    ds_read_b64_tr_b16 v[212:213], v19 offset:40960
    ds_read_b64_tr_b16 v[214:215], v19 offset:41984
    v_mfma_f32_16x16x32_bf16 v[232:235], v[152:155], v[192:195], v[232:235]
    v_mfma_f32_16x16x32_bf16 v[236:239], v[156:159], v[192:195], v[236:239]
    v_mfma_f32_16x16x32_bf16 v[240:243], v[152:155], v[196:199], v[240:243]
    v_mfma_f32_16x16x32_bf16 v[244:247], v[156:159], v[196:199], v[244:247]
    s_waitcnt vmcnt(4)
    v_lshl_or_b32 v168, v169, 16, v168
    v_lshl_or_b32 v169, v171, 16, v170
    v_lshl_or_b32 v170, v173, 16, v172
    v_lshl_or_b32 v171, v175, 16, v174
    buffer_store_dwordx4 v[168:171], v176, s[8:11], 0 offen sc1
    s_waitcnt lgkmcnt(0)
    v_mfma_f32_16x16x32_bf16 v[216:219], v[160:163], v[200:203], v[216:219]
    v_mfma_f32_16x16x32_bf16 v[220:223], v[164:167], v[200:203], v[220:223]
    s_barrier
    v_add_u32 v16, 65536, v16
    v_add_u32 v17, 65536, v17
    v_add_u32 v18, 65536, v18
    v_mfma_f32_16x16x32_bf16 v[224:227], v[160:163], v[204:207], v[224:227]
    s_lshr_b32 s27, s24, 5
    s_mul_i32 s27, s27, 1280
    s_add_u32 s27, s27, 5242880
    v_lshrrev_b32 v9, 1, v4
    v_add_u32 v19, 65536, v19
    v_add_u32 v20, 65536, v20
    v_add_u32 v21, 65536, v21
    v_mfma_f32_16x16x32_bf16 v[228:231], v[164:167], v[204:207], v[228:231]
    v_mul_u32_u24 v9, 320, v9
    v_and_b32 v10, 1, v4
    v_mul_u32_u24 v10, 640, v10
    v_add_u32 v9, v9, v10
    s_add_u32 m0, s28, 32768
    s_mov_b32 s26, 491520
    buffer_load_dwordx4 v7, s[60:63], s26 offen lds
    ds_read_b128 v[168:171], v20 offset:16384
    ds_read_b64_tr_b16 v[184:185], v16 offset:0
    ds_read_b64_tr_b16 v[186:187], v16 offset:1024
    v_mfma_f32_16x16x32_bf16 v[232:235], v[160:163], v[208:211], v[232:235]
    v_add_u32 v10, s23, v3
    v_lshl_add_u32 v9, v10, 4, v9
    v_mov_b32 v11, 81600

    ds_read_b128 v[172:175], v20 offset:18432
    ds_read_b64_tr_b16 v[188:189], v17 offset:0
    ds_read_b64_tr_b16 v[190:191], v17 offset:1024
    v_mfma_f32_16x16x32_bf16 v[236:239], v[164:167], v[208:211], v[236:239]
    v_mul_u32_u24 v8, 3277, v10
    v_lshrrev_b32 v8, 16, v8
    v_mad_u32_u24 v5, v8, v11, v9
    v_add_u32 v10, 16, v10
    s_add_u32 m0, s28, 33792
    s_mov_b32 s26, 506880
    buffer_load_dwordx4 v7, s[60:63], s26 offen lds
    ds_read_b64_tr_b16 v[192:193], v18 offset:0
    ds_read_b64_tr_b16 v[194:195], v18 offset:1024
    ds_read_b64_tr_b16 v[196:197], v19 offset:0
    v_mfma_f32_16x16x32_bf16 v[240:243], v[160:163], v[212:215], v[240:243]
    v_mul_u32_u24 v8, 3277, v10
    v_lshrrev_b32 v8, 16, v8
    v_mad_u32_u24 v6, v8, v11, v9
    v_add_u32 v10, 16, v10
    ds_read_b64_tr_b16 v[198:199], v19 offset:1024
    v_mfma_f32_16x16x32_bf16 v[244:247], v[164:167], v[212:215], v[244:247]
    v_mul_u32_u24 v8, 3277, v10
    v_lshrrev_b32 v8, 16, v8
    v_mad_u32_u24 v1, v8, v11, v9
    v_add_u32 v10, 16, v10
    s_add_u32 m0, s28, 49152
    s_mov_b32 s26, 737280
    buffer_load_dwordx4 v7, s[60:63], s26 offen lds
    s_waitcnt lgkmcnt(0)
    ds_read_b128 v[176:179], v21 offset:16384
    ds_read_b64_tr_b16 v[200:201], v16 offset:8192
    v_mfma_f32_16x16x32_bf16 v[216:219], v[168:171], v[184:187], v[216:219]
    v_mul_u32_u24 v8, 3277, v10
    v_lshrrev_b32 v8, 16, v8
    v_mad_u32_u24 v14, v8, v11, v9
    v_add_u32 v10, 16, v10
    ds_read_b64_tr_b16 v[202:203], v16 offset:9216
    ds_read_b128 v[180:183], v21 offset:18432
    v_mfma_f32_16x16x32_bf16 v[220:223], v[172:175], v[184:187], v[220:223]
    s_add_u32 m0, s28, 50176
    s_mov_b32 s26, 752640
    buffer_load_dwordx4 v7, s[60:63], s26 offen lds
    ds_read_b64_tr_b16 v[204:205], v17 offset:8192
    ds_read_b64_tr_b16 v[206:207], v17 offset:9216
    v_mfma_f32_16x16x32_bf16 v[224:227], v[168:171], v[188:191], v[224:227]
    ds_read_b64_tr_b16 v[208:209], v18 offset:8192
    ds_read_b64_tr_b16 v[210:211], v18 offset:9216
    v_mfma_f32_16x16x32_bf16 v[228:231], v[172:175], v[188:191], v[228:231]
    ds_read_b64_tr_b16 v[212:213], v19 offset:8192
    ds_read_b64_tr_b16 v[214:215], v19 offset:9216
    v_mfma_f32_16x16x32_bf16 v[232:235], v[168:171], v[192:195], v[232:235]
    v_mfma_f32_16x16x32_bf16 v[236:239], v[172:175], v[192:195], v[236:239]
    v_mfma_f32_16x16x32_bf16 v[240:243], v[168:171], v[196:199], v[240:243]
    v_mfma_f32_16x16x32_bf16 v[244:247], v[172:175], v[196:199], v[244:247]
    s_waitcnt lgkmcnt(0)
    v_mfma_f32_16x16x32_bf16 v[216:219], v[176:179], v[200:203], v[216:219]
    v_mfma_f32_16x16x32_bf16 v[220:223], v[180:183], v[200:203], v[220:223]
    s_waitcnt vmcnt(5)
    s_barrier
    v_add_u32 v16, 4294836224, v16
    v_add_u32 v17, 4294836224, v17
    v_mfma_f32_16x16x32_bf16 v[224:227], v[176:179], v[204:207], v[224:227]
    v_add_u32 v18, 4294836224, v18
    v_add_u32 v19, 4294836224, v19
    v_mfma_f32_16x16x32_bf16 v[228:231], v[180:183], v[204:207], v[228:231]
    s_add_u32 m0, s28, 65536
    s_mov_b32 s26, 983040
    buffer_load_dwordx4 v7, s[60:63], s26 offen lds
    ds_read_b64_tr_b16 v[184:185], v16 offset:0
    ds_read_b64_tr_b16 v[186:187], v16 offset:1024
    v_mfma_f32_16x16x32_bf16 v[232:235], v[176:179], v[208:211], v[232:235]
    ds_read_b64_tr_b16 v[188:189], v17 offset:0
    ds_read_b64_tr_b16 v[190:191], v17 offset:1024
    v_mfma_f32_16x16x32_bf16 v[236:239], v[180:183], v[208:211], v[236:239]
    s_add_u32 m0, s28, 66560
    s_mov_b32 s26, 998400
    buffer_load_dwordx4 v7, s[60:63], s26 offen lds
    ds_read_b64_tr_b16 v[192:193], v18 offset:0
    ds_read_b64_tr_b16 v[194:195], v18 offset:1024
    v_mfma_f32_16x16x32_bf16 v[240:243], v[176:179], v[212:215], v[240:243]
    ds_read_b64_tr_b16 v[196:197], v19 offset:0
    ds_read_b64_tr_b16 v[198:199], v19 offset:1024
    v_mfma_f32_16x16x32_bf16 v[244:247], v[180:183], v[212:215], v[244:247]
    s_add_u32 m0, s28, 81920
    s_mov_b32 s26, 1228800
    buffer_load_dwordx4 v7, s[60:63], s26 offen lds
    s_nop 2
    v_cvt_pk_bf16_f32 v248, v216, v217
    v_cvt_pk_bf16_f32 v249, v218, v219
    v_cvt_pk_bf16_f32 v250, v220, v221
    v_cvt_pk_bf16_f32 v251, v222, v223
    v_cvt_pk_bf16_f32 v252, v224, v225
    v_cvt_pk_bf16_f32 v253, v226, v227
    v_cvt_pk_bf16_f32 v254, v228, v229
    v_cvt_pk_bf16_f32 v255, v230, v231
    v_permlane16_swap_b32 v248, v250
    v_permlane16_swap_b32 v249, v251
    v_cvt_pk_bf16_f32 v20, v232, v233
    v_cvt_pk_bf16_f32 v21, v234, v235
    v_cvt_pk_bf16_f32 v22, v236, v237
    v_cvt_pk_bf16_f32 v23, v238, v239
    v_permlane16_swap_b32 v252, v254
    v_permlane16_swap_b32 v253, v255
    v_cvt_pk_bf16_f32 v10, v240, v241
    v_cvt_pk_bf16_f32 v11, v242, v243
    v_cvt_pk_bf16_f32 v12, v244, v245
    v_cvt_pk_bf16_f32 v13, v246, v247
    v_permlane16_swap_b32 v20, v22
    v_permlane16_swap_b32 v21, v23
    s_nop 1
    v_permlane16_swap_b32 v10, v12
    v_permlane16_swap_b32 v11, v13
    s_waitcnt lgkmcnt(0)
    ds_read_b64_tr_b16 v[200:201], v16 offset:8192
    v_mfma_f32_16x16x32_bf16 v[216:219], v[24:27], v[184:187], 0
    ds_read_b64_tr_b16 v[202:203], v16 offset:9216
    v_mfma_f32_16x16x32_bf16 v[220:223], v[28:31], v[184:187], 0
    s_add_u32 m0, s28, 82944
    s_mov_b32 s26, 1244160
    buffer_load_dwordx4 v7, s[60:63], s26 offen lds
    ds_read_b64_tr_b16 v[204:205], v17 offset:8192
    v_mfma_f32_16x16x32_bf16 v[224:227], v[24:27], v[188:191], 0
    ds_read_b64_tr_b16 v[206:207], v17 offset:9216
    v_mfma_f32_16x16x32_bf16 v[228:231], v[28:31], v[188:191], 0
    s_add_u32 s25, s27, 7864320
    buffer_store_dwordx4 v[248:251], v5, s[8:11], s25 offen offset:0 sc1
    ds_read_b64_tr_b16 v[208:209], v18 offset:8192
    v_mfma_f32_16x16x32_bf16 v[232:235], v[24:27], v[192:195], 0
    ds_read_b64_tr_b16 v[210:211], v18 offset:9216
    v_mfma_f32_16x16x32_bf16 v[236:239], v[28:31], v[192:195], 0
    ds_read_b64_tr_b16 v[212:213], v19 offset:8192
    v_mfma_f32_16x16x32_bf16 v[240:243], v[24:27], v[196:199], 0
    ds_read_b64_tr_b16 v[214:215], v19 offset:9216
    v_mfma_f32_16x16x32_bf16 v[244:247], v[28:31], v[196:199], 0
    s_add_u32 s25, s27, 7864320
    buffer_store_dwordx4 v[252:255], v6, s[8:11], s25 offen offset:256 sc1
    s_waitcnt lgkmcnt(0)
    ds_read_b64_tr_b16 v[184:185], v16 offset:16384
    v_mfma_f32_16x16x32_bf16 v[216:219], v[32:35], v[200:203], v[216:219]
    ds_read_b64_tr_b16 v[186:187], v16 offset:17408
    v_mfma_f32_16x16x32_bf16 v[220:223], v[36:39], v[200:203], v[220:223]
    ds_read_b64_tr_b16 v[188:189], v17 offset:16384
    v_mfma_f32_16x16x32_bf16 v[224:227], v[32:35], v[204:207], v[224:227]
    ds_read_b64_tr_b16 v[190:191], v17 offset:17408
    v_mfma_f32_16x16x32_bf16 v[228:231], v[36:39], v[204:207], v[228:231]
    s_add_u32 s25, s27, 7864320
    buffer_store_dwordx4 v[20:23], v1, s[8:11], s25 offen offset:512 sc1
    ds_read_b64_tr_b16 v[192:193], v18 offset:16384
    v_mfma_f32_16x16x32_bf16 v[232:235], v[32:35], v[208:211], v[232:235]
    ds_read_b64_tr_b16 v[194:195], v18 offset:17408
    v_mfma_f32_16x16x32_bf16 v[236:239], v[36:39], v[208:211], v[236:239]
    ds_read_b64_tr_b16 v[196:197], v19 offset:16384
    v_mfma_f32_16x16x32_bf16 v[240:243], v[32:35], v[212:215], v[240:243]
    ds_read_b64_tr_b16 v[198:199], v19 offset:17408
    v_mfma_f32_16x16x32_bf16 v[244:247], v[36:39], v[212:215], v[244:247]
    s_add_u32 s25, s27, 7864320
    buffer_store_dwordx4 v[10:13], v14, s[8:11], s25 offen offset:768 sc1
    s_waitcnt lgkmcnt(0)
    ds_read_b64_tr_b16 v[200:201], v16 offset:24576
    v_mfma_f32_16x16x32_bf16 v[216:219], v[40:43], v[184:187], v[216:219]
    ds_read_b64_tr_b16 v[202:203], v16 offset:25600
    v_mfma_f32_16x16x32_bf16 v[220:223], v[44:47], v[184:187], v[220:223]
    ds_read_b64_tr_b16 v[204:205], v17 offset:24576
    v_mfma_f32_16x16x32_bf16 v[224:227], v[40:43], v[188:191], v[224:227]
    ds_read_b64_tr_b16 v[206:207], v17 offset:25600
    v_mfma_f32_16x16x32_bf16 v[228:231], v[44:47], v[188:191], v[228:231]
    v_mov_b32 v8, 0
    global_load_dword v15, v8, s[4:5] sc1
    ds_read_b64_tr_b16 v[208:209], v18 offset:24576
    v_mfma_f32_16x16x32_bf16 v[232:235], v[40:43], v[192:195], v[232:235]
    ds_read_b64_tr_b16 v[210:211], v18 offset:25600
    v_mfma_f32_16x16x32_bf16 v[236:239], v[44:47], v[192:195], v[236:239]
    ds_read_b64_tr_b16 v[212:213], v19 offset:24576
    v_mfma_f32_16x16x32_bf16 v[240:243], v[40:43], v[196:199], v[240:243]
    ds_read_b64_tr_b16 v[214:215], v19 offset:25600
    v_mfma_f32_16x16x32_bf16 v[244:247], v[44:47], v[196:199], v[244:247]
    s_waitcnt lgkmcnt(0)
    v_mfma_f32_16x16x32_bf16 v[216:219], v[48:51], v[200:203], v[216:219]
    v_mfma_f32_16x16x32_bf16 v[220:223], v[52:55], v[200:203], v[220:223]
    s_waitcnt vmcnt(9)
    s_barrier
    ds_read_b64_tr_b16 v[184:185], v16 offset:32768
    ds_read_b64_tr_b16 v[186:187], v16 offset:33792
    v_mfma_f32_16x16x32_bf16 v[224:227], v[48:51], v[204:207], v[224:227]
    ds_read_b64_tr_b16 v[188:189], v17 offset:32768
    ds_read_b64_tr_b16 v[190:191], v17 offset:33792
    v_mfma_f32_16x16x32_bf16 v[228:231], v[52:55], v[204:207], v[228:231]
    s_add_u32 m0, s28, 98304
    s_mov_b32 s26, 1474560
    buffer_load_dwordx4 v7, s[60:63], s26 offen lds
    ds_read_b64_tr_b16 v[192:193], v18 offset:32768
    ds_read_b64_tr_b16 v[194:195], v18 offset:33792
    v_mfma_f32_16x16x32_bf16 v[232:235], v[48:51], v[208:211], v[232:235]
    ds_read_b64_tr_b16 v[196:197], v19 offset:32768
    ds_read_b64_tr_b16 v[198:199], v19 offset:33792
    v_mfma_f32_16x16x32_bf16 v[236:239], v[52:55], v[208:211], v[236:239]
    s_add_u32 m0, s28, 99328
    s_mov_b32 s26, 1489920
    buffer_load_dwordx4 v7, s[60:63], s26 offen lds
    v_mfma_f32_16x16x32_bf16 v[240:243], v[48:51], v[212:215], v[240:243]
    v_mfma_f32_16x16x32_bf16 v[244:247], v[52:55], v[212:215], v[244:247]
    s_add_u32 m0, s28, 114688
    s_mov_b32 s26, 1720320
    buffer_load_dwordx4 v7, s[60:63], s26 offen lds
    s_waitcnt lgkmcnt(0)
    ds_read_b64_tr_b16 v[200:201], v16 offset:40960
    v_mfma_f32_16x16x32_bf16 v[216:219], v[56:59], v[184:187], v[216:219]
    ds_read_b64_tr_b16 v[202:203], v16 offset:41984
    v_mfma_f32_16x16x32_bf16 v[220:223], v[60:63], v[184:187], v[220:223]
    s_add_u32 m0, s28, 115712
    s_mov_b32 s26, 1735680
    buffer_load_dwordx4 v7, s[60:63], s26 offen lds
    ds_read_b64_tr_b16 v[204:205], v17 offset:40960
    v_mfma_f32_16x16x32_bf16 v[224:227], v[56:59], v[188:191], v[224:227]
    ds_read_b64_tr_b16 v[206:207], v17 offset:41984
    v_mfma_f32_16x16x32_bf16 v[228:231], v[60:63], v[188:191], v[228:231]
    ds_read_b64_tr_b16 v[208:209], v18 offset:40960
    v_mfma_f32_16x16x32_bf16 v[232:235], v[56:59], v[192:195], v[232:235]
    ds_read_b64_tr_b16 v[210:211], v18 offset:41984
    v_mfma_f32_16x16x32_bf16 v[236:239], v[60:63], v[192:195], v[236:239]
    ds_read_b64_tr_b16 v[212:213], v19 offset:40960
    v_mfma_f32_16x16x32_bf16 v[240:243], v[56:59], v[196:199], v[240:243]
    ds_read_b64_tr_b16 v[214:215], v19 offset:41984
    v_mfma_f32_16x16x32_bf16 v[244:247], v[60:63], v[196:199], v[244:247]
    s_waitcnt lgkmcnt(0)
    ds_read_b64_tr_b16 v[184:185], v16 offset:49152
    v_mfma_f32_16x16x32_bf16 v[216:219], v[64:67], v[200:203], v[216:219]
    v_and_b32 v24, 63, v0
    s_and_b32 s50, s2, 7
    s_lshr_b32 s51, s2, 3
    s_and_b32 s47, s51, 7
    ds_read_b64_tr_b16 v[186:187], v16 offset:50176
    v_mfma_f32_16x16x32_bf16 v[220:223], v[68:71], v[200:203], v[220:223]
    s_lshr_b32 s56, s51, 3
    s_lshl_b32 s46, s50, 2
    s_add_u32 s46, s46, s56
    s_lshr_b32 s20, s51, 2
    ds_read_b64_tr_b16 v[188:189], v17 offset:49152
    v_mfma_f32_16x16x32_bf16 v[224:227], v[64:67], v[204:207], v[224:227]
    s_and_b32 s51, s51, 3
    s_lshl_b32 s19, s50, 2
    s_add_u32 s19, s19, s51
    s_lshl_b32 s29, s3, 10
    ds_read_b64_tr_b16 v[190:191], v17 offset:50176
    v_mfma_f32_16x16x32_bf16 v[228:231], v[68:71], v[204:207], v[228:231]
    s_mul_i32 s21, s20, 204800
    s_add_u32 s21, s21, 22552576
    v_and_b32 v25, 31, v24
    v_lshrrev_b32 v26, 5, v24
    ds_read_b64_tr_b16 v[192:193], v18 offset:49152
    v_mfma_f32_16x16x32_bf16 v[232:235], v[64:67], v[208:211], v[232:235]
    v_lshlrev_b32 v34, 4, v24
    s_and_b32 s48, s3, 3
    s_lshr_b32 s49, s3, 2
    s_mov_b32 s32, -1
    ds_read_b64_tr_b16 v[194:195], v18 offset:50176
    v_mfma_f32_16x16x32_bf16 v[236:239], v[68:71], v[208:211], v[236:239]
    s_mov_b32 s33, 0
    s_mov_b32 s38, 0
    s_mov_b32 s39, -1
    s_mov_b32 s34, 0xfffff
    ds_read_b64_tr_b16 v[196:197], v19 offset:49152
    v_mfma_f32_16x16x32_bf16 v[240:243], v[64:67], v[212:215], v[240:243]
    s_mov_b32 s35, 0xfffff
    s_mov_b32 s36, 570425344
    s_mov_b32 s37, 570425344
    s_mul_i32 s53, s46, 81920
    ds_read_b64_tr_b16 v[198:199], v19 offset:50176
    v_mfma_f32_16x16x32_bf16 v[244:247], v[68:71], v[212:215], v[244:247]
    s_and_b32 s58, s46, 1
    s_mul_i32 s57, s46, 5
    s_lshr_b32 s57, s57, 1
    s_lshl_b32 s57, s57, 15
    s_waitcnt lgkmcnt(0)
    ds_read_b64_tr_b16 v[200:201], v16 offset:57344
    v_mfma_f32_16x16x32_bf16 v[216:219], v[72:75], v[184:187], v[216:219]
    s_lshl_b32 s55, s48, 1
    s_add_u32 s55, s55, s49
    s_lshl_b32 s54, s47, 3
    s_add_u32 s54, s54, s55
    ds_read_b64_tr_b16 v[202:203], v16 offset:58368
    v_mfma_f32_16x16x32_bf16 v[220:223], v[76:79], v[184:187], v[220:223]
    s_lshl_b32 s54, s54, 9

    v_add_u32 v30, s58, v26
    v_lshlrev_b32 v27, 4, v25
    ds_read_b64_tr_b16 v[204:205], v17 offset:57344
    v_mfma_f32_16x16x32_bf16 v[224:227], v[72:75], v[188:191], v[224:227]
    v_lshl_add_u32 v38, v30, 15, v27
    s_cmp_eq_u32 s58, 0
    s_cselect_b32 s50, 65536, 8
    v_add_u32 v27, s50, v27

    ds_read_b64_tr_b16 v[206:207], v17 offset:58368
    v_mfma_f32_16x16x32_bf16 v[228:231], v[76:79], v[188:191], v[228:231]
    s_lshl_b32 s50, s49, 14
    s_add_u32 s50, s50, s57
    s_lshl_b32 s51, s48, 10
    s_add_u32 s50, s50, s51
    ds_read_b64_tr_b16 v[208:209], v18 offset:57344
    v_mfma_f32_16x16x32_bf16 v[232:235], v[72:75], v[192:195], v[232:235]
    s_add_u32 s40, s50, 10485760
    s_add_u32 s41, s40, 32768
    s_add_u32 s42, s40, 65536
    s_mul_i32 s50, s49, 40960
    ds_read_b64_tr_b16 v[210:211], v18 offset:58368
    v_mfma_f32_16x16x32_bf16 v[236:239], v[76:79], v[192:195], v[236:239]
    s_add_u32 s50, s50, s53
    s_add_u32 s50, s50, 13107200
    s_add_u32 s43, s50, s51
    s_add_u32 s44, s43, 4096
    ds_read_b64_tr_b16 v[212:213], v19 offset:57344
    v_mfma_f32_16x16x32_bf16 v[240:243], v[72:75], v[196:199], v[240:243]
    s_min_u32 s56, s51, 1024
    s_add_u32 s45, s50, s56
    s_add_u32 s45, s45, 8192
    s_mul_i32 s52, s49, 22528
    ds_read_b64_tr_b16 v[214:215], v19 offset:58368
    v_mfma_f32_16x16x32_bf16 v[244:247], v[76:79], v[196:199], v[244:247]
    s_add_u32 s59, s52, s56
    s_add_u32 s52, s52, s51

    v_mul_u32_u24 v58, 320, v26
    s_waitcnt lgkmcnt(0)
    v_mfma_f32_16x16x32_bf16 v[216:219], v[80:83], v[200:203], v[216:219]
    v_mfma_f32_16x16x32_bf16 v[220:223], v[84:87], v[200:203], v[220:223]
    s_waitcnt vmcnt(9)
    s_waitcnt vmcnt(4)
    s_barrier
    s_cmp_eq_u32 s3, 0
    s_cbranch_scc0 L_cb_14
L_zs_15:
    v_readfirstlane_b32 s25, v15
    s_nop 3
    s_cmp_lg_u32 s25, 0
    s_cbranch_scc1 L_zd_16
    v_mov_b32 v8, 0
    global_load_dword v15, v8, s[4:5] sc1
    s_waitcnt vmcnt(0)
    s_branch L_zs_15

L_zd_16:
    v_mov_b32 v8, s30
    v_mov_b32 v9, 1
    s_mov_b64 exec, 1
    global_store_dword v8, v9, s[16:17] sc1
    s_mov_b64 exec, -1

L_cb_14:
    v_add_u32 v16, 65536, v16
    v_add_u32 v17, 65536, v17
    v_mfma_f32_16x16x32_bf16 v[224:227], v[80:83], v[204:207], v[224:227]
    v_lshl_add_u32 v58, v25, 4, v58
    v_and_b32 v32, 0x13, v25
    v_and_b32 v31, 4, v25
    v_lshl_or_b32 v32, v31, 1, v32
    v_add_u32 v18, 65536, v18
    v_add_u32 v19, 65536, v19
    v_mfma_f32_16x16x32_bf16 v[228:231], v[84:87], v[204:207], v[228:231]
    v_and_b32 v31, 8, v25
    v_lshrrev_b32 v31, 1, v31
    v_or_b32 v32, v32, v31
    v_lshlrev_b32 v32, 4, v32
    s_add_u32 m0, s28, 131072
    s_mov_b32 s26, 1966080
    buffer_load_dwordx4 v7, s[60:63], s26 offen lds
    ds_read_b64_tr_b16 v[184:185], v16 offset:0
    ds_read_b64_tr_b16 v[186:187], v16 offset:1024
    v_mfma_f32_16x16x32_bf16 v[232:235], v[80:83], v[208:211], v[232:235]
    s_mul_i32 s50, s49, 22528
    v_add_u32 v32, s50, v32
    v_lshl_add_u32 v28, v30, 12, v32
    s_cmp_eq_u32 s58, 0
    s_cselect_b32 s51, 8192, 8
    ds_read_b64_tr_b16 v[188:189], v17 offset:0
    ds_read_b64_tr_b16 v[190:191], v17 offset:1024
    v_mfma_f32_16x16x32_bf16 v[236:239], v[84:87], v[208:211], v[236:239]
    v_add_u32 v59, s51, v32
    s_add_u32 s51, s50, 12288
    v_add_u32 v29, s51, v58

    s_add_u32 m0, s28, 132096
    s_mov_b32 s26, 1981440
    buffer_load_dwordx4 v7, s[60:63], s26 offen lds
    ds_read_b64_tr_b16 v[192:193], v18 offset:0
    ds_read_b64_tr_b16 v[194:195], v18 offset:1024
    v_mfma_f32_16x16x32_bf16 v[240:243], v[80:83], v[212:215], v[240:243]
    s_lshr_b32 s50, s57, 12
    s_add_u32 s51, s50, 23
    s_lshr_b32 s50, s50, 7
    s_lshr_b32 s51, s51, 7
    ds_read_b64_tr_b16 v[196:197], v19 offset:0
    ds_read_b64_tr_b16 v[198:199], v19 offset:1024
    v_mfma_f32_16x16x32_bf16 v[244:247], v[84:87], v[212:215], v[244:247]
    s_sub_u32 s51, s51, s50
    v_bfe_u32 v31, v24, 4, 1
    v_mul_u32_u24 v31, s51, v31
    s_cmp_eq_u32 s3, 0
    s_cselect_b32 s51, 5, 0
    s_add_u32 m0, s28, 147456
    s_mov_b32 s26, 2211840
    buffer_load_dwordx4 v7, s[60:63], s26 offen lds
    s_waitcnt lgkmcnt(0)
    ds_read_b64_tr_b16 v[200:201], v16 offset:8192
    v_mfma_f32_16x16x32_bf16 v[216:219], v[88:91], v[184:187], v[216:219]
    v_add_u32 v32, 1, v26
    v_mul_u32_u24 v32, s51, v32
    v_add_u32 v31, v31, v32
    v_add_u32 v31, s50, v31
    ds_read_b64_tr_b16 v[202:203], v16 offset:9216
    v_mfma_f32_16x16x32_bf16 v[220:223], v[92:95], v[184:187], v[220:223]
    s_lshl_b32 s50, s47, 1
    s_cmp_eq_u32 s3, 0
    s_cselect_b32 s51, 15, 1
    s_cselect_b32 s50, 0, s50
    v_and_b32 v32, s51, v24
    v_add_u32 v32, s50, v32
    s_add_u32 m0, s28, 148480
    s_mov_b32 s26, 2227200
    buffer_load_dwordx4 v7, s[60:63], s26 offen lds
    ds_read_b64_tr_b16 v[204:205], v17 offset:8192
    v_mfma_f32_16x16x32_bf16 v[224:227], v[88:91], v[188:191], v[224:227]
    v_lshl_add_u32 v31, v31, 4, v32
    v_add_u32 v31, 128, v31
    v_lshlrev_b32 v36, 7, v31

    ds_read_b64_tr_b16 v[206:207], v17 offset:9216
    v_mfma_f32_16x16x32_bf16 v[228:231], v[92:95], v[188:191], v[228:231]
    ds_read_b64_tr_b16 v[208:209], v18 offset:8192
    v_mfma_f32_16x16x32_bf16 v[232:235], v[88:91], v[192:195], v[232:235]
    ds_read_b64_tr_b16 v[210:211], v18 offset:9216
    v_mfma_f32_16x16x32_bf16 v[236:239], v[92:95], v[192:195], v[236:239]
    ds_read_b64_tr_b16 v[212:213], v19 offset:8192
    v_mfma_f32_16x16x32_bf16 v[240:243], v[88:91], v[196:199], v[240:243]
    ds_read_b64_tr_b16 v[214:215], v19 offset:9216
    v_mfma_f32_16x16x32_bf16 v[244:247], v[92:95], v[196:199], v[244:247]
    s_waitcnt lgkmcnt(0)
    ds_read_b64_tr_b16 v[184:185], v16 offset:16384
    v_mfma_f32_16x16x32_bf16 v[216:219], v[96:99], v[200:203], v[216:219]
    ds_read_b64_tr_b16 v[186:187], v16 offset:17408
    v_mfma_f32_16x16x32_bf16 v[220:223], v[100:103], v[200:203], v[220:223]
    ds_read_b64_tr_b16 v[188:189], v17 offset:16384
    v_mfma_f32_16x16x32_bf16 v[224:227], v[96:99], v[204:207], v[224:227]
    ds_read_b64_tr_b16 v[190:191], v17 offset:17408
    v_mfma_f32_16x16x32_bf16 v[228:231], v[100:103], v[204:207], v[228:231]
    ds_read_b64_tr_b16 v[192:193], v18 offset:16384
    v_mfma_f32_16x16x32_bf16 v[232:235], v[96:99], v[208:211], v[232:235]
    ds_read_b64_tr_b16 v[194:195], v18 offset:17408
    v_mfma_f32_16x16x32_bf16 v[236:239], v[100:103], v[208:211], v[236:239]
    ds_read_b64_tr_b16 v[196:197], v19 offset:16384
    v_mfma_f32_16x16x32_bf16 v[240:243], v[96:99], v[212:215], v[240:243]
    ds_read_b64_tr_b16 v[198:199], v19 offset:17408
    v_mfma_f32_16x16x32_bf16 v[244:247], v[100:103], v[212:215], v[244:247]
    s_waitcnt lgkmcnt(0)
    ds_read_b64_tr_b16 v[200:201], v16 offset:24576
    v_mfma_f32_16x16x32_bf16 v[216:219], v[104:107], v[184:187], v[216:219]
    ds_read_b64_tr_b16 v[202:203], v16 offset:25600
    v_mfma_f32_16x16x32_bf16 v[220:223], v[108:111], v[184:187], v[220:223]
    ds_read_b64_tr_b16 v[204:205], v17 offset:24576
    v_mfma_f32_16x16x32_bf16 v[224:227], v[104:107], v[188:191], v[224:227]
    ds_read_b64_tr_b16 v[206:207], v17 offset:25600
    v_mfma_f32_16x16x32_bf16 v[228:231], v[108:111], v[188:191], v[228:231]
    ds_read_b64_tr_b16 v[208:209], v18 offset:24576
    v_mfma_f32_16x16x32_bf16 v[232:235], v[104:107], v[192:195], v[232:235]
    ds_read_b64_tr_b16 v[210:211], v18 offset:25600
    v_mfma_f32_16x16x32_bf16 v[236:239], v[108:111], v[192:195], v[236:239]
    ds_read_b64_tr_b16 v[212:213], v19 offset:24576
    v_mfma_f32_16x16x32_bf16 v[240:243], v[104:107], v[196:199], v[240:243]
    ds_read_b64_tr_b16 v[214:215], v19 offset:25600
    v_mfma_f32_16x16x32_bf16 v[244:247], v[108:111], v[196:199], v[244:247]
    s_waitcnt lgkmcnt(0)
    v_mfma_f32_16x16x32_bf16 v[216:219], v[112:115], v[200:203], v[216:219]
    v_mfma_f32_16x16x32_bf16 v[220:223], v[116:119], v[200:203], v[220:223]
    s_waitcnt vmcnt(4)
    s_barrier
    ds_read_b64_tr_b16 v[184:185], v16 offset:32768
    ds_read_b64_tr_b16 v[186:187], v16 offset:33792
    v_mfma_f32_16x16x32_bf16 v[224:227], v[112:115], v[204:207], v[224:227]
    ds_read_b64_tr_b16 v[188:189], v17 offset:32768
    ds_read_b64_tr_b16 v[190:191], v17 offset:33792
    v_mfma_f32_16x16x32_bf16 v[228:231], v[116:119], v[204:207], v[228:231]
    ds_read_b64_tr_b16 v[192:193], v18 offset:32768
    ds_read_b64_tr_b16 v[194:195], v18 offset:33792
    v_mfma_f32_16x16x32_bf16 v[232:235], v[112:115], v[208:211], v[232:235]
    ds_read_b64_tr_b16 v[196:197], v19 offset:32768
    ds_read_b64_tr_b16 v[198:199], v19 offset:33792
    v_mfma_f32_16x16x32_bf16 v[236:239], v[116:119], v[208:211], v[236:239]
    v_mfma_f32_16x16x32_bf16 v[240:243], v[112:115], v[212:215], v[240:243]
    v_mfma_f32_16x16x32_bf16 v[244:247], v[116:119], v[212:215], v[244:247]
    s_waitcnt lgkmcnt(0)
    ds_read_b64_tr_b16 v[200:201], v16 offset:40960
    v_mfma_f32_16x16x32_bf16 v[216:219], v[120:123], v[184:187], v[216:219]
    ds_read_b64_tr_b16 v[202:203], v16 offset:41984
    v_mfma_f32_16x16x32_bf16 v[220:223], v[124:127], v[184:187], v[220:223]
    ds_read_b64_tr_b16 v[204:205], v17 offset:40960
    v_mfma_f32_16x16x32_bf16 v[224:227], v[120:123], v[188:191], v[224:227]
    ds_read_b64_tr_b16 v[206:207], v17 offset:41984
    v_mfma_f32_16x16x32_bf16 v[228:231], v[124:127], v[188:191], v[228:231]
    ds_read_b64_tr_b16 v[208:209], v18 offset:40960
    v_mfma_f32_16x16x32_bf16 v[232:235], v[120:123], v[192:195], v[232:235]
    ds_read_b64_tr_b16 v[210:211], v18 offset:41984
    v_mfma_f32_16x16x32_bf16 v[236:239], v[124:127], v[192:195], v[236:239]
    ds_read_b64_tr_b16 v[212:213], v19 offset:40960
    v_mfma_f32_16x16x32_bf16 v[240:243], v[120:123], v[196:199], v[240:243]
    ds_read_b64_tr_b16 v[214:215], v19 offset:41984
    v_mfma_f32_16x16x32_bf16 v[244:247], v[124:127], v[196:199], v[244:247]
    s_waitcnt lgkmcnt(0)
    ds_read_b64_tr_b16 v[184:185], v16 offset:49152
    v_mfma_f32_16x16x32_bf16 v[216:219], v[128:131], v[200:203], v[216:219]
    ds_read_b64_tr_b16 v[186:187], v16 offset:50176
    v_mfma_f32_16x16x32_bf16 v[220:223], v[132:135], v[200:203], v[220:223]
    ds_read_b64_tr_b16 v[188:189], v17 offset:49152
    v_mfma_f32_16x16x32_bf16 v[224:227], v[128:131], v[204:207], v[224:227]
    ds_read_b64_tr_b16 v[190:191], v17 offset:50176
    v_mfma_f32_16x16x32_bf16 v[228:231], v[132:135], v[204:207], v[228:231]
    ds_read_b64_tr_b16 v[192:193], v18 offset:49152
    v_mfma_f32_16x16x32_bf16 v[232:235], v[128:131], v[208:211], v[232:235]
    ds_read_b64_tr_b16 v[194:195], v18 offset:50176
    v_mfma_f32_16x16x32_bf16 v[236:239], v[132:135], v[208:211], v[236:239]
    ds_read_b64_tr_b16 v[196:197], v19 offset:49152
    v_mfma_f32_16x16x32_bf16 v[240:243], v[128:131], v[212:215], v[240:243]
    ds_read_b64_tr_b16 v[198:199], v19 offset:50176
    v_mfma_f32_16x16x32_bf16 v[244:247], v[132:135], v[212:215], v[244:247]
    s_cmp_lt_u32 s3, 2
    s_cbranch_scc0 L_w01_17
    v_mov_b32 v30, v36
    global_load_dword v37, v30, s[16:17] sc1
L_w01_17:
    s_waitcnt lgkmcnt(0)
    ds_read_b64_tr_b16 v[200:201], v16 offset:57344
    v_mfma_f32_16x16x32_bf16 v[216:219], v[136:139], v[184:187], v[216:219]
    ds_read_b64_tr_b16 v[202:203], v16 offset:58368
    v_mfma_f32_16x16x32_bf16 v[220:223], v[140:143], v[184:187], v[220:223]
    ds_read_b64_tr_b16 v[204:205], v17 offset:57344
    v_mfma_f32_16x16x32_bf16 v[224:227], v[136:139], v[188:191], v[224:227]
    ds_read_b64_tr_b16 v[206:207], v17 offset:58368
    v_mfma_f32_16x16x32_bf16 v[228:231], v[140:143], v[188:191], v[228:231]
    ds_read_b64_tr_b16 v[208:209], v18 offset:57344
    v_mfma_f32_16x16x32_bf16 v[232:235], v[136:139], v[192:195], v[232:235]
    ds_read_b64_tr_b16 v[210:211], v18 offset:58368
    v_mfma_f32_16x16x32_bf16 v[236:239], v[140:143], v[192:195], v[236:239]
    ds_read_b64_tr_b16 v[212:213], v19 offset:57344
    v_mfma_f32_16x16x32_bf16 v[240:243], v[136:139], v[196:199], v[240:243]
    ds_read_b64_tr_b16 v[214:215], v19 offset:58368
    v_mfma_f32_16x16x32_bf16 v[244:247], v[140:143], v[196:199], v[244:247]
    s_waitcnt lgkmcnt(0)
    v_mfma_f32_16x16x32_bf16 v[216:219], v[144:147], v[200:203], v[216:219]
    v_mfma_f32_16x16x32_bf16 v[220:223], v[148:151], v[200:203], v[220:223]
    s_waitcnt vmcnt(0)
    s_cmp_lt_u32 s3, 2
    s_cbranch_scc0 L_w01_20
    s_waitcnt vmcnt(0)
L_pl_21:
    v_cmp_le_u32 vcc, 1, v37
    s_nop 1
    s_cmp_eq_u64 vcc, -1
    s_cbranch_scc1 L_pd_22

    s_sleep 4
    v_mov_b32 v30, v36
    global_load_dword v37, v30, s[16:17] sc1
    s_waitcnt vmcnt(0)
    s_branch L_pl_21
L_pd_22:
L_w01_20:
    s_barrier
    s_lshl_b32 s56, s47, 2
    s_add_u32 s56, s56, s48
    s_lshl_b32 s56, s56, 10

    s_add_u32 s50, s56, s57
    s_add_u32 s50, s50, 7864320
    buffer_load_dwordx4 v[40:43], v38, s[8:11], s50 offen sc1
    buffer_load_dwordx2 v[44:45], v27, s[8:11], s50 offen sc1
    s_add_u32 s56, s56, 512
    s_add_u32 s50, s56, s57
    s_add_u32 s50, s50, 7864320
    buffer_load_dwordx4 v[46:49], v38, s[8:11], s50 offen sc1
    buffer_load_dwordx2 v[50:51], v27, s[8:11], s50 offen sc1
    s_add_u32 s50, s57, 10485760
    buffer_load_dwordx4 v[52:55], v38, s[8:11], s50 offen sc1
    buffer_load_dwordx2 v[56:57], v27, s[8:11], s50 offen sc1
    s_add_u32 m0, s52, 0
    s_nop 0
    buffer_load_dwordx4 v34, s[8:11], s40 offen sc1 lds
    s_add_u32 s40, s40, 4096
    s_add_u32 m0, s52, 4096
    s_nop 0
    buffer_load_dwordx4 v34, s[8:11], s41 offen sc1 lds
    s_add_u32 s41, s41, 4096
    s_add_u32 m0, s52, 8192
    s_nop 0
    buffer_load_dwordx4 v34, s[8:11], s42 offen sc1 lds
    s_add_u32 s42, s42, 4096
    s_add_u32 m0, s52, 12288
    s_nop 0
    buffer_load_dwordx4 v34, s[8:11], s43 offen sc1 lds
    s_add_u32 s43, s43, 10240
    s_add_u32 m0, s52, 16384
    s_nop 0
    buffer_load_dwordx4 v34, s[8:11], s44 offen sc1 lds
    s_add_u32 s44, s44, 10240
    s_add_u32 m0, s59, 20480
    s_nop 0
    buffer_load_dwordx4 v34, s[8:11], s45 offen sc1 lds
    s_add_u32 s45, s45, 10240
    v_mov_b32 v60, 0
    v_mov_b32 v61, 0
    v_mov_b32 v62, 0
    v_mov_b32 v63, 0
    v_mov_b32 v64, 0
    v_mov_b32 v65, 0
    v_mov_b32 v66, 0
    v_mov_b32 v67, 0
    s_mov_b32 exec_lo, 1048576
    s_mov_b32 exec_hi, 1048576
    v_mov_b32 v60, 1065369472
    v_mov_b32 v61, 1065369472
    v_mov_b32 v62, 1065369472
    v_mov_b32 v63, 1065369472
    v_mov_b32 v64, 1065369472
    v_mov_b32 v65, 1065369472
    v_mov_b32 v66, 1065369472
    v_mov_b32 v67, 1065369472
    s_mov_b64 exec, -1
    v_add_u32 v16, 65536, v16
    v_add_u32 v17, 65536, v17
    v_mfma_f32_16x16x32_bf16 v[224:227], v[144:147], v[204:207], v[224:227]
    v_add_u32 v18, 65536, v18
    v_add_u32 v19, 65536, v19
    v_mfma_f32_16x16x32_bf16 v[228:231], v[148:151], v[204:207], v[228:231]
    ds_read_b64_tr_b16 v[184:185], v16 offset:0
    ds_read_b64_tr_b16 v[186:187], v16 offset:1024
    v_mfma_f32_16x16x32_bf16 v[232:235], v[144:147], v[208:211], v[232:235]
    ds_read_b64_tr_b16 v[188:189], v17 offset:0
    ds_read_b64_tr_b16 v[190:191], v17 offset:1024
    v_mfma_f32_16x16x32_bf16 v[236:239], v[148:151], v[208:211], v[236:239]
    ds_read_b64_tr_b16 v[192:193], v18 offset:0
    ds_read_b64_tr_b16 v[194:195], v18 offset:1024
    v_mfma_f32_16x16x32_bf16 v[240:243], v[144:147], v[212:215], v[240:243]
    ds_read_b64_tr_b16 v[196:197], v19 offset:0
    ds_read_b64_tr_b16 v[198:199], v19 offset:1024
    v_mfma_f32_16x16x32_bf16 v[244:247], v[148:151], v[212:215], v[244:247]
    s_waitcnt lgkmcnt(0)
    ds_read_b64_tr_b16 v[200:201], v16 offset:8192
    v_mfma_f32_16x16x32_bf16 v[216:219], v[152:155], v[184:187], v[216:219]
    ds_read_b64_tr_b16 v[202:203], v16 offset:9216
    v_mfma_f32_16x16x32_bf16 v[220:223], v[156:159], v[184:187], v[220:223]
    ds_read_b64_tr_b16 v[204:205], v17 offset:8192
    v_mfma_f32_16x16x32_bf16 v[224:227], v[152:155], v[188:191], v[224:227]
    ds_read_b64_tr_b16 v[206:207], v17 offset:9216
    v_mfma_f32_16x16x32_bf16 v[228:231], v[156:159], v[188:191], v[228:231]
    ds_read_b64_tr_b16 v[208:209], v18 offset:8192
    v_mfma_f32_16x16x32_bf16 v[232:235], v[152:155], v[192:195], v[232:235]
    ds_read_b64_tr_b16 v[210:211], v18 offset:9216
    v_mfma_f32_16x16x32_bf16 v[236:239], v[156:159], v[192:195], v[236:239]
    ds_read_b64_tr_b16 v[212:213], v19 offset:8192
    v_mfma_f32_16x16x32_bf16 v[240:243], v[152:155], v[196:199], v[240:243]
    ds_read_b64_tr_b16 v[214:215], v19 offset:9216
    v_mfma_f32_16x16x32_bf16 v[244:247], v[156:159], v[196:199], v[244:247]
    s_waitcnt lgkmcnt(0)
    ds_read_b64_tr_b16 v[184:185], v16 offset:16384
    v_mfma_f32_16x16x32_bf16 v[216:219], v[160:163], v[200:203], v[216:219]
    v_mov_b32 v108, 0
    v_mov_b32 v109, 0
    v_mov_b32 v110, 0
    v_mov_b32 v111, 0
    ds_read_b64_tr_b16 v[186:187], v16 offset:17408
    v_mfma_f32_16x16x32_bf16 v[220:223], v[164:167], v[200:203], v[220:223]
    v_mov_b32 v112, 0
    v_mov_b32 v113, 0
    v_mov_b32 v114, 0
    v_mov_b32 v115, 0
    ds_read_b64_tr_b16 v[188:189], v17 offset:16384
    v_mfma_f32_16x16x32_bf16 v[224:227], v[160:163], v[204:207], v[224:227]
    v_mov_b32 v116, 0
    v_mov_b32 v117, 0
    v_mov_b32 v118, 0
    v_mov_b32 v119, 0
    ds_read_b64_tr_b16 v[190:191], v17 offset:17408
    v_mfma_f32_16x16x32_bf16 v[228:231], v[164:167], v[204:207], v[228:231]
    v_mov_b32 v120, 0
    v_mov_b32 v121, 0
    v_mov_b32 v122, 0
    v_mov_b32 v123, 0
    ds_read_b64_tr_b16 v[192:193], v18 offset:16384
    v_mfma_f32_16x16x32_bf16 v[232:235], v[160:163], v[208:211], v[232:235]
    v_mov_b32 v124, 0
    v_mov_b32 v125, 0
    v_mov_b32 v126, 0
    v_mov_b32 v127, 0
    ds_read_b64_tr_b16 v[194:195], v18 offset:17408
    v_mfma_f32_16x16x32_bf16 v[236:239], v[164:167], v[208:211], v[236:239]
    v_mov_b32 v128, 0
    v_mov_b32 v129, 0
    v_mov_b32 v130, 0
    v_mov_b32 v131, 0
    ds_read_b64_tr_b16 v[196:197], v19 offset:16384
    v_mfma_f32_16x16x32_bf16 v[240:243], v[160:163], v[212:215], v[240:243]
    v_mov_b32 v132, 0
    v_mov_b32 v133, 0
    v_mov_b32 v134, 0
    v_mov_b32 v135, 0
    ds_read_b64_tr_b16 v[198:199], v19 offset:17408
    v_mfma_f32_16x16x32_bf16 v[244:247], v[164:167], v[212:215], v[244:247]
    v_mov_b32 v136, 0
    v_mov_b32 v137, 0
    v_mov_b32 v138, 0
    v_mov_b32 v139, 0
    s_waitcnt lgkmcnt(0)
    ds_read_b64_tr_b16 v[200:201], v16 offset:24576
    v_mfma_f32_16x16x32_bf16 v[216:219], v[168:171], v[184:187], v[216:219]
    v_mov_b32 v140, 0
    v_mov_b32 v141, 0
    v_mov_b32 v142, 0
    v_mov_b32 v143, 0
    ds_read_b64_tr_b16 v[202:203], v16 offset:25600
    v_mfma_f32_16x16x32_bf16 v[220:223], v[172:175], v[184:187], v[220:223]
    v_mov_b32 v144, 0
    v_mov_b32 v145, 0
    v_mov_b32 v146, 0
    v_mov_b32 v147, 0
    ds_read_b64_tr_b16 v[204:205], v17 offset:24576
    v_mfma_f32_16x16x32_bf16 v[224:227], v[168:171], v[188:191], v[224:227]
    v_mov_b32 v153, 0
    v_mov_b32 v159, 0
    ds_read_b64_tr_b16 v[206:207], v17 offset:25600
    v_mfma_f32_16x16x32_bf16 v[228:231], v[172:175], v[188:191], v[228:231]
    ds_read_b64_tr_b16 v[208:209], v18 offset:24576
    v_mfma_f32_16x16x32_bf16 v[232:235], v[168:171], v[192:195], v[232:235]
    ds_read_b64_tr_b16 v[210:211], v18 offset:25600
    v_mfma_f32_16x16x32_bf16 v[236:239], v[172:175], v[192:195], v[236:239]
    ds_read_b64_tr_b16 v[212:213], v19 offset:24576
    v_mfma_f32_16x16x32_bf16 v[240:243], v[168:171], v[196:199], v[240:243]
    ds_read_b64_tr_b16 v[214:215], v19 offset:25600
    v_mfma_f32_16x16x32_bf16 v[244:247], v[172:175], v[196:199], v[244:247]
    s_waitcnt lgkmcnt(0)
    v_mfma_f32_16x16x32_bf16 v[216:219], v[176:179], v[200:203], v[216:219]
    v_mfma_f32_16x16x32_bf16 v[220:223], v[180:183], v[200:203], v[220:223]
    v_mfma_f32_16x16x32_bf16 v[224:227], v[176:179], v[204:207], v[224:227]
    v_mfma_f32_16x16x32_bf16 v[228:231], v[180:183], v[204:207], v[228:231]
    v_mfma_f32_16x16x32_bf16 v[232:235], v[176:179], v[208:211], v[232:235]
    v_mfma_f32_16x16x32_bf16 v[236:239], v[180:183], v[208:211], v[236:239]
    v_mfma_f32_16x16x32_bf16 v[240:243], v[176:179], v[212:215], v[240:243]
    v_mfma_f32_16x16x32_bf16 v[244:247], v[180:183], v[212:215], v[244:247]
    s_nop 4
    v_cvt_pk_bf16_f32 v216, v216, v217
    v_cvt_pk_bf16_f32 v217, v218, v219
    v_cvt_pk_bf16_f32 v218, v220, v221
    v_cvt_pk_bf16_f32 v219, v222, v223
    v_cvt_pk_bf16_f32 v224, v224, v225
    v_cvt_pk_bf16_f32 v225, v226, v227
    v_cvt_pk_bf16_f32 v226, v228, v229
    v_cvt_pk_bf16_f32 v227, v230, v231
    v_permlane16_swap_b32 v216, v218
    v_permlane16_swap_b32 v217, v219
    s_add_u32 s25, s27, 0
    buffer_store_dwordx4 v[216:219], v5, s[8:11], s25 offen offset:0 sc1
    v_cvt_pk_bf16_f32 v232, v232, v233
    v_cvt_pk_bf16_f32 v233, v234, v235
    v_cvt_pk_bf16_f32 v234, v236, v237
    v_cvt_pk_bf16_f32 v235, v238, v239
    v_permlane16_swap_b32 v224, v226
    v_permlane16_swap_b32 v225, v227
    s_add_u32 s25, s27, 0
    buffer_store_dwordx4 v[224:227], v6, s[8:11], s25 offen offset:256 sc1
    v_cvt_pk_bf16_f32 v240, v240, v241
    v_cvt_pk_bf16_f32 v241, v242, v243
    v_cvt_pk_bf16_f32 v242, v244, v245
    v_cvt_pk_bf16_f32 v243, v246, v247
    v_permlane16_swap_b32 v232, v234
    v_permlane16_swap_b32 v233, v235
    s_add_u32 s25, s27, 0
    buffer_store_dwordx4 v[232:235], v1, s[8:11], s25 offen offset:512 sc1
    s_nop 1
    v_permlane16_swap_b32 v240, v242
    v_permlane16_swap_b32 v241, v243
    s_add_u32 s25, s27, 0
    buffer_store_dwordx4 v[240:243], v14, s[8:11], s25 offen offset:768 sc1
    s_branch L_phase2
L_p1_gate:
    s_cmp_ge_u32 s3, 4
    s_cbranch_scc0 L_lt_23
    buffer_load_dword v23, v1, s[32:35], s44 offen
L_lt_23:
    s_cmp_eq_u32 s21, 0
    s_cbranch_scc0 L_nz_24
    s_cmp_eq_u32 s3, 7
    s_cbranch_scc0 L_nz_24
    v_lshlrev_b32 v8, 7, v2
    v_mov_b32 v9, 0
    v_mov_b32 v10, 0
    v_mov_b32 v11, 0
    v_mov_b32 v12, 0
    v_mov_b32 v13, 0
    global_store_dwordx4 v8, v[10:13], s[16:17] sc1
    v_add_u32 v8, 8192, v8
    global_store_dwordx4 v8, v[10:13], s[16:17] sc1
    v_add_u32 v8, 8192, v8
    global_store_dwordx4 v8, v[10:13], s[16:17] sc1
    v_add_u32 v8, 8192, v8
    global_store_dwordx4 v8, v[10:13], s[16:17] sc1
    v_add_u32 v8, 8192, v8
    global_store_dwordx4 v8, v[10:13], s[16:17] sc1
    v_add_u32 v8, 8192, v8
    global_store_dwordx4 v8, v[10:13], s[16:17] sc1
    s_waitcnt vmcnt(0)
    v_mov_b32 v8, 1
    s_mov_b64 exec, 1
    global_store_dword v9, v8, s[4:5] sc1
    s_mov_b64 exec, -1

L_nz_24:
    s_lshl_b32 s25, s3, 2
    v_add_u32 v8, s25, v4
    v_min_u32 v8, 24, v8
    v_mul_u32_u24 v9, 52, v8
    v_lshrrev_b32 v9, 8, v9
    v_mul_u32_u24 v10, 5, v9
    v_sub_u32 v10, v8, v10
    s_and_b32 s25, s20, 15
    s_lshl_b32 s27, s25, 1
    s_cmp_lt_u32 s25, 8
    s_cselect_b32 s26, 64, 0
    s_add_u32 s27, s27, s26
    v_add_u32 v11, s27, v9
    s_mul_i32 s27, s25, 3
    s_cmp_ge_u32 s25, 5
    s_cselect_b32 s26, 15, -1
    s_add_u32 s26, s26, s27
    v_add_u32 v12, s26, v9
    s_cmp_ge_u32 s25, 6
    s_cselect_b32 s26, 16, 0
    s_add_u32 s26, s26, s27
    v_cmp_gt_u32 vcc, 2, v9
    v_mov_b32 v13, s26
    s_lshr_b32 s25, s20, 4
    v_cndmask_b32 v11, v12, v11, vcc
    v_cmp_eq_u32 vcc, 4, v9
    s_mul_i32 s25, s25, 5120
    s_nop 0
    v_cndmask_b32 v11, v11, v13, vcc
    v_lshrrev_b32 v12, 2, v11
    v_and_b32 v11, 3, v11
    v_mul_u32_u24 v13, 10240, v12
    v_add_u32 v13, s25, v13
    v_lshl_add_u32 v13, v10, 10, v13
    v_lshl_add_u32 v13, v11, 8, v13
    v_lshl_add_u32 v13, v3, 4, v13
    s_mul_i32 s27, s19, 204800
    s_add_u32 s27, s27, 22552576
    v_add_u32 v240, s27, v13
    s_mul_i32 s27, s20, 25600
    s_mul_i32 s26, s19, 160
    s_add_u32 s27, s27, s26
    v_lshlrev_b32 v11, 5, v10
    v_lshl_add_u32 v11, v3, 1, v11
    v_add_u32 v11, s27, v11

    v_and_b32 v12, 1, v9
    v_lshl_add_u32 v12, v12, 2, 0
    v_cmp_eq_u32 vcc, 4, v9
    v_lshrrev_b32 v13, 1, v9
    v_mov_b32 v8, 16
    v_mov_b32 v10, 0
    v_cndmask_b32 v12, v12, v8, vcc
    v_cndmask_b32 v13, v13, v10, vcc
    v_cmp_eq_u32 vcc, 0, v13
    v_mov_b32 v8, s48
    v_mov_b32 v10, s42
    v_mov_b32 v13, s49
    v_cndmask_b32 v8, v8, v10, vcc
    v_mov_b32 v10, s43
    v_cndmask_b32 v243, v13, v10, vcc
    v_mul_u32_u24 v12, 1280, v12
    v_add_u32 v12, v12, v11
    v_add_co_u32 v242, vcc, v8, v12
    s_nop 1
    v_addc_co_u32 v243, vcc, 0, v243, vcc

    global_load_ushort v232, v[242:243], off offset:0
    global_load_ushort v233, v[242:243], off offset:1280
    global_load_ushort v234, v[242:243], off offset:2560
    global_load_ushort v235, v[242:243], off offset:3840
    v_and_b32 v12, 1, v9
    v_lshl_add_u32 v12, v12, 2, 8
    v_cmp_eq_u32 vcc, 4, v9
    v_lshrrev_b32 v13, 1, v9
    v_mov_b32 v8, 16
    v_mov_b32 v10, 1
    v_cndmask_b32 v12, v12, v8, vcc
    v_cndmask_b32 v13, v13, v10, vcc
    v_cmp_eq_u32 vcc, 0, v13
    v_mov_b32 v8, s48
    v_mov_b32 v10, s42
    v_mov_b32 v13, s49
    v_cndmask_b32 v8, v8, v10, vcc
    v_mov_b32 v10, s43
    v_cndmask_b32 v245, v13, v10, vcc
    v_mul_u32_u24 v12, 1280, v12
    v_add_u32 v12, v12, v11
    v_add_co_u32 v244, vcc, v8, v12
    s_nop 1
    v_addc_co_u32 v245, vcc, 0, v245, vcc

    global_load_ushort v236, v[244:245], off offset:0
    global_load_ushort v237, v[244:245], off offset:1280
    global_load_ushort v238, v[244:245], off offset:2560
    global_load_ushort v239, v[244:245], off offset:3840
    s_mov_b32 s60, s50
    s_mov_b32 s61, s51
    s_mov_b32 s62, 1280
    s_mov_b32 s63, 0x00020000
    s_mov_b32 s32, s40
    s_mov_b32 s33, s41
    s_mov_b32 s34, 25600
    s_mov_b32 s35, 0x00020000
    s_lshl_b32 s25, s3, 4
    s_add_u32 s24, s24, s25
    v_add_u32 v5, s24, v3
    v_lshlrev_b32 v7, 2, v5
    v_mul_u32_u24 v5, 1280, v5
    v_lshl_add_u32 v5, v4, 4, v5
    v_lshlrev_b32 v6, 4, v4
    s_cmp_ge_u32 s3, 2
    s_cbranch_scc1 L_p1_nophi

    v_and_b32 v8, 31, v2
    v_lshrrev_b32 v9, 5, v2
    v_subrev_u32 v10, 2, v8
    v_max_i32 v10, 17, v10
    v_min_i32 v10, v10, v8
    v_min_i32 v10, 19, v10
    v_lshlrev_b32 v10, 1, v10
    v_mul_u32_u24 v11, 320, v9
    v_add_u32 v10, v10, v11
    s_lshl_b32 s25, s21, 1
    s_add_u32 s25, s25, s3
    s_mul_i32 s26, s25, 800
    s_mul_i32 s27, s3, 160
    s_add_u32 s27, s27, s26
    s_mul_i32 s31, s3, 640
    s_sub_u32 s26, s26, s31

    v_mov_b32 v204, 0
    v_mov_b32 v205, 0
    v_mov_b32 v206, 0
    v_mov_b32 v207, 0
    buffer_load_ushort v196, v10, s[32:35], s27 offen offset:0
    buffer_load_ushort v197, v10, s[32:35], s27 offen offset:40
    buffer_load_ushort v198, v10, s[32:35], s27 offen offset:80
    buffer_load_ushort v199, v10, s[32:35], s27 offen offset:120
    buffer_load_ushort v200, v10, s[32:35], s27 offen offset:160
    buffer_load_ushort v201, v10, s[32:35], s27 offen offset:200
    buffer_load_ushort v202, v10, s[32:35], s27 offen offset:240
    buffer_load_ushort v203, v10, s[32:35], s27 offen offset:280
    s_mov_b32 exec_hi, 0
    buffer_load_ushort v204, v10, s[32:35], s26 offen offset:640
    buffer_load_ushort v205, v10, s[32:35], s26 offen offset:680
    buffer_load_ushort v206, v10, s[32:35], s26 offen offset:720
    buffer_load_ushort v207, v10, s[32:35], s26 offen offset:760
    s_mov_b64 exec, -1
    s_waitcnt vmcnt(0)
    v_lshlrev_b32 v196, 16, v196
    v_mul_f32 v196, 0x3fb8aa3b, v196
    v_lshlrev_b32 v197, 16, v197
    v_mul_f32 v197, 0x3fb8aa3b, v197
    v_lshlrev_b32 v198, 16, v198
    v_mul_f32 v198, 0x3fb8aa3b, v198
    v_lshlrev_b32 v199, 16, v199
    v_mul_f32 v199, 0x3fb8aa3b, v199
    v_lshlrev_b32 v200, 16, v200
    v_mul_f32 v200, 0x3fb8aa3b, v200
    v_lshlrev_b32 v201, 16, v201
    v_mul_f32 v201, 0x3fb8aa3b, v201
    v_lshlrev_b32 v202, 16, v202
    v_mul_f32 v202, 0x3fb8aa3b, v202
    v_lshlrev_b32 v203, 16, v203
    v_mul_f32 v203, 0x3fb8aa3b, v203
    v_lshlrev_b32 v204, 16, v204
    v_mul_f32 v204, 0x3fb8aa3b, v204
    v_lshlrev_b32 v205, 16, v205
    v_mul_f32 v205, 0x3fb8aa3b, v205
    v_lshlrev_b32 v206, 16, v206
    v_mul_f32 v206, 0x3fb8aa3b, v206
    v_lshlrev_b32 v207, 16, v207
    v_mul_f32 v207, 0x3fb8aa3b, v207
    v_cvt_pk_bf16_f32 v196, v196, v197
    v_cvt_pk_bf16_f32 v197, v198, v199
    v_cvt_pk_bf16_f32 v198, v200, v201
    v_cvt_pk_bf16_f32 v199, v202, v203
    v_cvt_pk_bf16_f32 v200, v204, v205
    v_cvt_pk_bf16_f32 v201, v206, v207
    s_mul_i32 s26, s25, 1536
    s_add_u32 s26, s26, 24190976
    v_lshlrev_b32 v8, 4, v2
    v_lshlrev_b32 v9, 3, v2
    buffer_store_dwordx4 v[196:199], v8, s[8:11], s26 offen sc1
    buffer_store_dwordx2 v[200:201], v9, s[8:11], s26 offen offset:1024 sc1

L_p1_nophi:
    buffer_load_dwordx4 v[16:19], v5, s[56:59], 0 offen offset:0
    buffer_load_dwordx4 v[20:23], v6, s[60:63], 0 offen offset:0
    buffer_load_dwordx4 v[24:27], v5, s[56:59], 0 offen offset:64
    buffer_load_dwordx4 v[28:31], v6, s[60:63], 0 offen offset:64
    buffer_load_dwordx4 v[32:35], v5, s[56:59], 0 offen offset:128
    buffer_load_dwordx4 v[36:39], v6, s[60:63], 0 offen offset:128
    buffer_load_dwordx4 v[40:43], v5, s[56:59], 0 offen offset:192
    buffer_load_dwordx4 v[44:47], v6, s[60:63], 0 offen offset:192
    buffer_load_dwordx4 v[48:51], v5, s[56:59], 0 offen offset:256
    buffer_load_dwordx4 v[52:55], v6, s[60:63], 0 offen offset:256
    buffer_load_dwordx4 v[56:59], v5, s[56:59], 0 offen offset:320
    buffer_load_dwordx4 v[60:63], v6, s[60:63], 0 offen offset:320
    buffer_load_dwordx4 v[64:67], v5, s[56:59], 0 offen offset:384
    buffer_load_dwordx4 v[68:71], v6, s[60:63], 0 offen offset:384
    buffer_load_dwordx4 v[72:75], v5, s[56:59], 0 offen offset:448
    buffer_load_dwordx4 v[76:79], v6, s[60:63], 0 offen offset:448
    buffer_load_dwordx4 v[80:83], v5, s[56:59], 0 offen offset:512
    buffer_load_dwordx4 v[84:87], v6, s[60:63], 0 offen offset:512
    buffer_load_dwordx4 v[88:91], v5, s[56:59], 0 offen offset:576
    buffer_load_dwordx4 v[92:95], v6, s[60:63], 0 offen offset:576
    buffer_load_dwordx4 v[96:99], v5, s[56:59], 0 offen offset:640
    buffer_load_dwordx4 v[100:103], v6, s[60:63], 0 offen offset:640
    buffer_load_dwordx4 v[104:107], v5, s[56:59], 0 offen offset:704
    buffer_load_dwordx4 v[108:111], v6, s[60:63], 0 offen offset:704
    buffer_load_dwordx4 v[112:115], v5, s[56:59], 0 offen offset:768
    buffer_load_dwordx4 v[116:119], v6, s[60:63], 0 offen offset:768
    buffer_load_dwordx4 v[120:123], v5, s[56:59], 0 offen offset:832
    buffer_load_dwordx4 v[124:127], v6, s[60:63], 0 offen offset:832
    buffer_load_dwordx4 v[128:131], v5, s[56:59], 0 offen offset:896
    buffer_load_dwordx4 v[132:135], v6, s[60:63], 0 offen offset:896
    buffer_load_dwordx4 v[136:139], v5, s[56:59], 0 offen offset:960
    buffer_load_dwordx4 v[140:143], v6, s[60:63], 0 offen offset:960
    buffer_load_dwordx4 v[144:147], v5, s[56:59], 0 offen offset:1024
    buffer_load_dwordx4 v[148:151], v6, s[60:63], 0 offen offset:1024
    buffer_load_dwordx4 v[152:155], v5, s[56:59], 0 offen offset:1088
    buffer_load_dwordx4 v[156:159], v6, s[60:63], 0 offen offset:1088
    buffer_load_dwordx4 v[160:163], v5, s[56:59], 0 offen offset:1152
    buffer_load_dwordx4 v[164:167], v6, s[60:63], 0 offen offset:1152
    buffer_load_dwordx4 v[168:171], v5, s[56:59], 0 offen offset:1216
    buffer_load_dwordx4 v[172:175], v6, s[60:63], 0 offen offset:1216
    s_waitcnt vmcnt(38)
    v_mfma_f32_16x16x32_bf16 v[8:11], v[20:23], v[16:19], 0
    s_waitcnt vmcnt(36)
    v_mfma_f32_16x16x32_bf16 v[8:11], v[28:31], v[24:27], v[8:11]
    s_waitcnt vmcnt(34)
    v_mfma_f32_16x16x32_bf16 v[8:11], v[36:39], v[32:35], v[8:11]
    s_waitcnt vmcnt(32)
    v_mfma_f32_16x16x32_bf16 v[8:11], v[44:47], v[40:43], v[8:11]
    s_waitcnt vmcnt(30)
    v_mfma_f32_16x16x32_bf16 v[8:11], v[52:55], v[48:51], v[8:11]
    s_waitcnt vmcnt(28)
    v_mfma_f32_16x16x32_bf16 v[8:11], v[60:63], v[56:59], v[8:11]
    s_waitcnt vmcnt(26)
    v_mfma_f32_16x16x32_bf16 v[8:11], v[68:71], v[64:67], v[8:11]
    s_waitcnt vmcnt(24)
    v_mfma_f32_16x16x32_bf16 v[8:11], v[76:79], v[72:75], v[8:11]
    s_waitcnt vmcnt(22)
    v_mfma_f32_16x16x32_bf16 v[8:11], v[84:87], v[80:83], v[8:11]
    s_waitcnt vmcnt(20)
    v_mfma_f32_16x16x32_bf16 v[8:11], v[92:95], v[88:91], v[8:11]
    s_waitcnt vmcnt(18)
    v_mfma_f32_16x16x32_bf16 v[8:11], v[100:103], v[96:99], v[8:11]
    s_waitcnt vmcnt(16)
    v_mfma_f32_16x16x32_bf16 v[8:11], v[108:111], v[104:107], v[8:11]
    s_waitcnt vmcnt(14)
    v_mfma_f32_16x16x32_bf16 v[8:11], v[116:119], v[112:115], v[8:11]
    s_waitcnt vmcnt(12)
    v_mfma_f32_16x16x32_bf16 v[8:11], v[124:127], v[120:123], v[8:11]
    s_waitcnt vmcnt(10)
    v_mfma_f32_16x16x32_bf16 v[8:11], v[132:135], v[128:131], v[8:11]
    s_waitcnt vmcnt(8)
    v_mfma_f32_16x16x32_bf16 v[8:11], v[140:143], v[136:139], v[8:11]
    s_waitcnt vmcnt(6)
    v_mfma_f32_16x16x32_bf16 v[8:11], v[148:151], v[144:147], v[8:11]
    s_waitcnt vmcnt(4)
    v_mfma_f32_16x16x32_bf16 v[8:11], v[156:159], v[152:155], v[8:11]
    s_waitcnt vmcnt(2)
    v_mfma_f32_16x16x32_bf16 v[8:11], v[164:167], v[160:163], v[8:11]
    s_waitcnt vmcnt(0)
    v_mfma_f32_16x16x32_bf16 v[8:11], v[172:175], v[168:171], v[8:11]
    v_lshl_or_b32 v232, v233, 16, v232
    v_lshl_or_b32 v233, v235, 16, v234
    v_lshl_or_b32 v234, v237, 16, v236
    v_lshl_or_b32 v235, v239, 16, v238
    buffer_store_dwordx4 v[232:235], v240, s[8:11], 0 offen sc1
    s_nop 7
    v_cvt_pk_bf16_f32 v8, v8, v8
    v_lshlrev_b32 v8, 16, v8
    v_mul_f32 v8, 0xbfb8aa3b, v8
    v_exp_f32 v8, v8
    s_nop 0
    v_add_f32 v8, 1.0, v8
    v_rcp_f32 v8, v8
    s_nop 0
    v_cvt_pk_bf16_f32 v8, v8, v8
    v_lshlrev_b32 v8, 16, v8
    s_mov_b32 s25, 15728640
    s_mov_b64 exec, 0xffff
    buffer_store_dword v8, v7, s[8:11], s25 offen sc1
    s_mov_b64 exec, -1

    s_cmp_lt_u32 s3, 2
    s_cbranch_scc0 L_gz_25

    v_mov_b32 v8, 0
    global_load_dword v15, v8, s[4:5] sc1
    s_waitcnt vmcnt(0)
L_zs_26:
    v_readfirstlane_b32 s25, v15
    s_nop 3
    s_cmp_lg_u32 s25, 0
    s_cbranch_scc1 L_zd_27
    v_mov_b32 v8, 0
    global_load_dword v15, v8, s[4:5] sc1
    s_waitcnt vmcnt(0)
    s_branch L_zs_26

L_zd_27:
L_gz_25:
    s_waitcnt vmcnt(0)
    v_and_b32 v24, 63, v0
    s_and_b32 s50, s2, 7
    s_lshr_b32 s51, s2, 3
    s_and_b32 s47, s51, 7
    s_lshr_b32 s56, s51, 3
    s_lshl_b32 s46, s50, 2
    s_add_u32 s46, s46, s56
    s_lshr_b32 s20, s51, 2
    s_and_b32 s51, s51, 3
    s_lshl_b32 s19, s50, 2
    s_add_u32 s19, s19, s51
    s_lshl_b32 s29, s3, 10
    s_mul_i32 s21, s20, 204800
    s_add_u32 s21, s21, 22552576
    v_and_b32 v25, 31, v24
    v_lshrrev_b32 v26, 5, v24
    v_lshlrev_b32 v34, 4, v24
    s_and_b32 s48, s3, 3
    s_lshr_b32 s49, s3, 2
    s_mov_b32 s32, -1
    s_mov_b32 s33, 0
    s_mov_b32 s38, 0
    s_mov_b32 s39, -1
    s_mov_b32 s34, 0xfffff
    s_mov_b32 s35, 0xfffff
    s_mov_b32 s36, 570425344
    s_mov_b32 s37, 570425344
    s_mul_i32 s53, s46, 81920
    s_and_b32 s58, s46, 1
    s_mul_i32 s57, s46, 5
    s_lshr_b32 s57, s57, 1
    s_lshl_b32 s57, s57, 15
    s_lshl_b32 s55, s48, 1
    s_add_u32 s55, s55, s49
    s_lshl_b32 s54, s47, 3
    s_add_u32 s54, s54, s55
    s_lshl_b32 s54, s54, 9

    v_add_u32 v30, s58, v26
    v_lshlrev_b32 v27, 4, v25
    v_lshl_add_u32 v38, v30, 15, v27
    s_cmp_eq_u32 s58, 0
    s_cselect_b32 s50, 65536, 8
    v_add_u32 v27, s50, v27

    s_lshl_b32 s50, s49, 14
    s_add_u32 s50, s50, s57
    s_lshl_b32 s51, s48, 10
    s_add_u32 s50, s50, s51
    s_add_u32 s40, s50, 10485760
    s_add_u32 s41, s40, 32768
    s_add_u32 s42, s40, 65536
    s_mul_i32 s50, s49, 40960
    s_add_u32 s50, s50, s53
    s_add_u32 s50, s50, 13107200
    s_add_u32 s43, s50, s51
    s_add_u32 s44, s43, 4096
    s_min_u32 s56, s51, 1024
    s_add_u32 s45, s50, s56
    s_add_u32 s45, s45, 8192
    s_mul_i32 s52, s49, 22528
    s_add_u32 s59, s52, s56
    s_add_u32 s52, s52, s51

    v_mul_u32_u24 v58, 320, v26
    v_lshl_add_u32 v58, v25, 4, v58
    v_and_b32 v32, 0x13, v25
    v_and_b32 v31, 4, v25
    v_lshl_or_b32 v32, v31, 1, v32
    v_and_b32 v31, 8, v25
    v_lshrrev_b32 v31, 1, v31
    v_or_b32 v32, v32, v31
    v_lshlrev_b32 v32, 4, v32
    s_mul_i32 s50, s49, 22528
    v_add_u32 v32, s50, v32
    v_lshl_add_u32 v28, v30, 12, v32
    s_cmp_eq_u32 s58, 0
    s_cselect_b32 s51, 8192, 8
    v_add_u32 v59, s51, v32
    s_add_u32 s51, s50, 12288
    v_add_u32 v29, s51, v58

    s_lshr_b32 s50, s57, 12
    s_add_u32 s51, s50, 23
    s_lshr_b32 s50, s50, 7
    s_lshr_b32 s51, s51, 7
    s_sub_u32 s51, s51, s50
    v_bfe_u32 v31, v24, 4, 1
    v_mul_u32_u24 v31, s51, v31
    s_cmp_eq_u32 s3, 0
    s_cselect_b32 s51, 5, 0
    v_add_u32 v32, 1, v26
    v_mul_u32_u24 v32, s51, v32
    v_add_u32 v31, v31, v32
    v_add_u32 v31, s50, v31
    s_lshl_b32 s50, s47, 1
    s_cmp_eq_u32 s3, 0
    s_cselect_b32 s51, 15, 1
    s_cselect_b32 s50, 0, s50
    v_and_b32 v32, s51, v24
    v_add_u32 v32, s50, v32
    v_lshl_add_u32 v31, v31, 4, v32
    v_add_u32 v31, 128, v31
    v_lshlrev_b32 v36, 7, v31

    s_cmp_lt_u32 s3, 2
    s_cbranch_scc0 L_w01_28
    v_mov_b32 v30, v36
    global_load_dword v37, v30, s[16:17] sc1
L_w01_28:
    s_cmp_lt_u32 s3, 2
    s_cbranch_scc0 L_w01_31
    s_waitcnt vmcnt(0)
L_pl_32:
    v_cmp_le_u32 vcc, 1, v37
    s_nop 1
    s_cmp_eq_u64 vcc, -1
    s_cbranch_scc1 L_pd_33

    s_sleep 4
    v_mov_b32 v30, v36
    global_load_dword v37, v30, s[16:17] sc1
    s_waitcnt vmcnt(0)
    s_branch L_pl_32
L_pd_33:
L_w01_31:
    s_barrier
    s_lshl_b32 s56, s47, 2
    s_add_u32 s56, s56, s48
    s_lshl_b32 s56, s56, 10

    s_add_u32 s50, s56, s57
    s_add_u32 s50, s50, 7864320
    buffer_load_dwordx4 v[40:43], v38, s[8:11], s50 offen sc1
    buffer_load_dwordx2 v[44:45], v27, s[8:11], s50 offen sc1
    s_add_u32 s56, s56, 512
    s_add_u32 s50, s56, s57
    s_add_u32 s50, s50, 7864320
    buffer_load_dwordx4 v[46:49], v38, s[8:11], s50 offen sc1
    buffer_load_dwordx2 v[50:51], v27, s[8:11], s50 offen sc1
    s_add_u32 s50, s57, 10485760
    buffer_load_dwordx4 v[52:55], v38, s[8:11], s50 offen sc1
    buffer_load_dwordx2 v[56:57], v27, s[8:11], s50 offen sc1
    s_add_u32 m0, s52, 0
    s_nop 0
    buffer_load_dwordx4 v34, s[8:11], s40 offen sc1 lds
    s_add_u32 s40, s40, 4096
    s_add_u32 m0, s52, 4096
    s_nop 0
    buffer_load_dwordx4 v34, s[8:11], s41 offen sc1 lds
    s_add_u32 s41, s41, 4096
    s_add_u32 m0, s52, 8192
    s_nop 0
    buffer_load_dwordx4 v34, s[8:11], s42 offen sc1 lds
    s_add_u32 s42, s42, 4096
    s_add_u32 m0, s52, 12288
    s_nop 0
    buffer_load_dwordx4 v34, s[8:11], s43 offen sc1 lds
    s_add_u32 s43, s43, 10240
    s_add_u32 m0, s52, 16384
    s_nop 0
    buffer_load_dwordx4 v34, s[8:11], s44 offen sc1 lds
    s_add_u32 s44, s44, 10240
    s_add_u32 m0, s59, 20480
    s_nop 0
    buffer_load_dwordx4 v34, s[8:11], s45 offen sc1 lds
    s_add_u32 s45, s45, 10240
    v_mov_b32 v60, 0
    v_mov_b32 v61, 0
    v_mov_b32 v62, 0
    v_mov_b32 v63, 0
    v_mov_b32 v64, 0
    v_mov_b32 v65, 0
    v_mov_b32 v66, 0
    v_mov_b32 v67, 0
    s_mov_b32 exec_lo, 1048576
    s_mov_b32 exec_hi, 1048576
    v_mov_b32 v60, 1065369472
    v_mov_b32 v61, 1065369472
    v_mov_b32 v62, 1065369472
    v_mov_b32 v63, 1065369472
    v_mov_b32 v64, 1065369472
    v_mov_b32 v65, 1065369472
    v_mov_b32 v66, 1065369472
    v_mov_b32 v67, 1065369472
    s_mov_b64 exec, -1
    v_mov_b32 v108, 0
    v_mov_b32 v109, 0
    v_mov_b32 v110, 0
    v_mov_b32 v111, 0
    v_mov_b32 v112, 0
    v_mov_b32 v113, 0
    v_mov_b32 v114, 0
    v_mov_b32 v115, 0
    v_mov_b32 v116, 0
    v_mov_b32 v117, 0
    v_mov_b32 v118, 0
    v_mov_b32 v119, 0
    v_mov_b32 v120, 0
    v_mov_b32 v121, 0
    v_mov_b32 v122, 0
    v_mov_b32 v123, 0
    v_mov_b32 v124, 0
    v_mov_b32 v125, 0
    v_mov_b32 v126, 0
    v_mov_b32 v127, 0
    v_mov_b32 v128, 0
    v_mov_b32 v129, 0
    v_mov_b32 v130, 0
    v_mov_b32 v131, 0
    v_mov_b32 v132, 0
    v_mov_b32 v133, 0
    v_mov_b32 v134, 0
    v_mov_b32 v135, 0
    v_mov_b32 v136, 0
    v_mov_b32 v137, 0
    v_mov_b32 v138, 0
    v_mov_b32 v139, 0
    v_mov_b32 v140, 0
    v_mov_b32 v141, 0
    v_mov_b32 v142, 0
    v_mov_b32 v143, 0
    v_mov_b32 v144, 0
    v_mov_b32 v145, 0
    v_mov_b32 v146, 0
    v_mov_b32 v147, 0
    v_mov_b32 v153, 0
    v_mov_b32 v159, 0
    s_waitcnt vmcnt(0)
L_phase2:
    s_waitcnt vmcnt(10)
    s_mov_b64 exec, s[38:39]
    v_mov_b32 v44, 0
    v_mov_b32 v45, 0
    v_mov_b32 v50, 0
    v_mov_b32 v51, 0
    s_mov_b64 exec, -1
    s_nop 0

    v_mfma_f32_32x32x16_bf16 v[68:83], v[52:55], v[40:43], 0
    v_mfma_f32_32x32x8_bf16 v[68:83], v[56:57], v[44:45], v[68:83]
    v_mfma_f32_32x32x16_bf16 v[84:99], v[52:55], v[46:49], 0
    v_mfma_f32_32x32x8_bf16 v[84:99], v[56:57], v[50:51], v[84:99]
    v_mov_b32 v56, 1065369472
    v_mov_b32 v57, 0x00003f80
    s_nop 7
    v_max3_f32 v30, v68, v69, v70
    v_max3_f32 v30, v30, v71, v72
    v_max3_f32 v30, v30, v73, v74
    v_max3_f32 v30, v30, v75, v76
    v_max3_f32 v30, v30, v77, v78
    v_max3_f32 v30, v30, v79, v80
    v_max3_f32 v30, v30, v81, v82
    v_max_f32 v30, v30, v83
    v_mov_b32 v31, v30
    s_nop 1
    v_permlane32_swap_b32 v30, v31
    s_nop 0
    v_max_f32 v30, v30, v31
    v_sub_f32 v30, 0, v30
    v_and_b32 v31, 0xffff0000, v30
    v_sub_f32 v30, v30, v31
    v_and_b32 v32, 0xffff0000, v30
    v_sub_f32 v30, v30, v32
    s_mov_b64 exec, s[38:39]
    v_lshrrev_b32 v31, 16, v31
    v_or_b32 v44, v31, v32
    v_lshrrev_b32 v45, 16, v30
    s_mov_b64 exec, -1
    v_max3_f32 v30, v84, v85, v86
    v_max3_f32 v30, v30, v87, v88
    v_max3_f32 v30, v30, v89, v90
    v_max3_f32 v30, v30, v91, v92
    v_max3_f32 v30, v30, v93, v94
    v_max3_f32 v30, v30, v95, v96
    v_max3_f32 v30, v30, v97, v98
    v_max_f32 v30, v30, v99
    v_mov_b32 v31, v30
    s_nop 1
    v_permlane32_swap_b32 v30, v31
    s_nop 0
    v_max_f32 v30, v30, v31
    v_sub_f32 v30, 0, v30
    v_and_b32 v31, 0xffff0000, v30
    v_sub_f32 v30, v30, v31
    v_and_b32 v32, 0xffff0000, v30
    v_sub_f32 v30, v30, v32
    s_mov_b64 exec, s[38:39]
    v_lshrrev_b32 v31, 16, v31
    v_or_b32 v50, v31, v32
    v_lshrrev_b32 v51, 16, v30
    s_mov_b64 exec, -1
    s_cmp_ge_u32 s3, 2
    s_cbranch_scc1 L_vi_34
    v_mov_b32 v192, 1065369472
    v_mov_b32 v193, 1065369472
    v_mov_b32 v194, 1065369472
    v_mov_b32 v195, 1065369472
    v_mov_b32 v196, 1065369472
    v_mov_b32 v197, 1065369472
    v_mov_b32 v198, 1065369472
    v_mov_b32 v199, 1065369472
    v_mov_b32 v200, 1065369472
    v_mov_b32 v201, 1065369472
    v_mov_b32 v202, 1065369472
    v_mov_b32 v203, 1065369472
    v_mov_b32 v204, 1065369472
    v_mov_b32 v205, 1065369472
    v_mov_b32 v206, 1065369472
    v_mov_b32 v207, 1065369472
    v_mov_b32 v208, 1065369472
    v_mov_b32 v209, 1065369472
    v_mov_b32 v210, 1065369472
    v_mov_b32 v211, 1065369472
    v_mov_b32 v212, 1065369472
    v_mov_b32 v213, 1065369472
    v_mov_b32 v214, 1065369472
    v_mov_b32 v215, 1065369472
    v_mov_b32 v216, 1065369472
    v_mov_b32 v217, 1065369472
    v_mov_b32 v218, 1065369472
    v_mov_b32 v219, 1065369472
    v_mov_b32 v220, 1065369472
    v_mov_b32 v221, 1065369472
    v_mov_b32 v222, 1065369472
    v_mov_b32 v223, 1065369472
    v_mov_b32 v224, 1065369472
    v_mov_b32 v225, 1065369472
    v_mov_b32 v226, 1065369472
    v_mov_b32 v227, 1065369472
    v_mov_b32 v228, 1065369472
    v_mov_b32 v229, 1065369472
    v_mov_b32 v230, 1065369472
    v_mov_b32 v231, 1065369472
    v_mov_b32 v232, 1065369472
    v_mov_b32 v233, 1065369472
    v_mov_b32 v234, 1065369472
    v_mov_b32 v235, 1065369472
    v_mov_b32 v236, 1065369472
    v_mov_b32 v237, 1065369472
    v_mov_b32 v238, 1065369472
    v_mov_b32 v239, 1065369472
    v_mov_b32 v240, 1065369472
    v_mov_b32 v241, 1065369472
    v_mov_b32 v242, 1065369472
    v_mov_b32 v243, 1065369472
    v_mov_b32 v244, 1065369472
    v_mov_b32 v245, 1065369472
    v_mov_b32 v246, 1065369472
    v_mov_b32 v247, 1065369472
    v_mov_b32 v248, 1065369472
    v_mov_b32 v249, 1065369472
    v_mov_b32 v250, 1065369472
    v_mov_b32 v251, 1065369472
    v_mov_b32 v252, 1065369472
    v_mov_b32 v253, 1065369472
    v_mov_b32 v254, 1065369472
    v_mov_b32 v255, 1065369472
L_vi_34:
    s_waitcnt vmcnt(4)
    s_barrier
    s_setprio 3
    ds_read_b128 v[52:55], v28 offset:0
    s_mov_b64 exec, s[32:33]
    ds_read_b64 v[56:57], v59 offset:0
    s_mov_b64 exec, -1
    s_waitcnt lgkmcnt(0)
    v_mfma_f32_32x32x16_bf16 v[68:83], v[52:55], v[40:43], 0
    v_mfma_f32_32x32x8_bf16 v[68:83], v[56:57], v[44:45], v[68:83]
    s_nop 10

    v_mfma_f32_32x32x16_bf16 v[84:99], v[52:55], v[46:49], 0
    v_exp_f32 v68, v68
    v_exp_f32 v69, v69
    v_exp_f32 v70, v70
    v_exp_f32 v71, v71
    v_exp_f32 v72, v72
    v_mfma_f32_32x32x8_bf16 v[84:99], v[56:57], v[50:51], v[84:99]
    ds_read_b128 v[52:55], v28 offset:512
    s_mov_b64 exec, s[32:33]
    ds_read_b64 v[56:57], v59 offset:512
    s_mov_b64 exec, -1
    v_cvt_pk_bf16_f32 v100, v68, v69
    v_cvt_pk_bf16_f32 v101, v70, v71
    v_exp_f32 v73, v73
    v_exp_f32 v74, v74
    v_exp_f32 v75, v75
    v_exp_f32 v76, v76
    v_mfma_f32_32x32x16_bf16 v[132:147], v[60:63], v[108:111], v[132:147]
    s_add_u32 m0, s52, 45056
    s_nop 0
    buffer_load_dwordx4 v34, s[8:11], s40 offen sc1 lds
    s_add_u32 s40, s40, 4096
    v_cvt_pk_bf16_f32 v102, v72, v73
    v_cvt_pk_bf16_f32 v103, v74, v75
    v_exp_f32 v77, v77
    v_exp_f32 v78, v78
    v_exp_f32 v79, v79
    v_exp_f32 v80, v80
    v_mfma_f32_32x32x16_bf16 v[132:147], v[64:67], v[112:115], v[132:147]
    s_mov_b64 exec, s[34:35]
    ds_read_b128 v[60:63], v29 offset:0
    ds_read_b128 v[64:67], v29 offset:640
    s_mov_b64 exec, -1
    v_cvt_pk_bf16_f32 v104, v76, v77
    v_cvt_pk_bf16_f32 v105, v78, v79
    v_exp_f32 v81, v81
    v_exp_f32 v82, v82
    v_exp_f32 v83, v83
    v_cvt_pk_bf16_f32 v106, v80, v81
    v_cvt_pk_bf16_f32 v107, v82, v83
    s_waitcnt lgkmcnt(2)
    v_mfma_f32_32x32x16_bf16 v[68:83], v[52:55], v[40:43], 0
    v_exp_f32 v84, v84
    v_exp_f32 v85, v85
    v_exp_f32 v86, v86
    v_exp_f32 v87, v87
    v_exp_f32 v88, v88
    v_mfma_f32_32x32x8_bf16 v[68:83], v[56:57], v[44:45], v[68:83]
    v_cvt_pk_bf16_f32 v108, v84, v85
    v_cvt_pk_bf16_f32 v109, v86, v87
    v_exp_f32 v89, v89
    v_exp_f32 v90, v90
    v_exp_f32 v91, v91
    v_exp_f32 v92, v92
    s_waitcnt lgkmcnt(0)
    v_mfma_f32_32x32x16_bf16 v[116:131], v[60:63], v[100:103], v[116:131]
    s_waitcnt vmcnt(1)
    s_lshl_b32 s50, s18, 2
    s_lshr_b32 s51, s3, 1
    s_add_u32 s50, s50, s51
    s_add_u32 s50, s50, 64
    s_lshl_b32 s50, s50, 7
    v_mov_b32 v30, s50
    v_mov_b32 v31, 1
    s_mov_b64 exec, 1
    global_atomic_add v30, v31, s[16:17]
    s_mov_b64 exec, -1

    s_add_u32 m0, s52, 49152
    s_nop 0
    buffer_load_dwordx4 v34, s[8:11], s41 offen sc1 lds
    s_add_u32 s41, s41, 4096
    v_cvt_pk_bf16_f32 v110, v88, v89
    v_cvt_pk_bf16_f32 v111, v90, v91
    v_exp_f32 v93, v93
    v_exp_f32 v94, v94
    v_exp_f32 v95, v95
    v_exp_f32 v96, v96
    v_mfma_f32_32x32x16_bf16 v[116:131], v[64:67], v[104:107], v[116:131]
    v_cvt_pk_bf16_f32 v112, v92, v93
    v_cvt_pk_bf16_f32 v113, v94, v95
    v_exp_f32 v97, v97
    v_exp_f32 v98, v98
    v_exp_f32 v99, v99
    v_cvt_pk_bf16_f32 v114, v96, v97
    v_cvt_pk_bf16_f32 v115, v98, v99
    v_mfma_f32_32x32x16_bf16 v[84:99], v[52:55], v[46:49], 0
    v_exp_f32 v68, v68
    v_exp_f32 v69, v69
    v_exp_f32 v70, v70
    v_exp_f32 v71, v71
    v_exp_f32 v72, v72
    v_mfma_f32_32x32x8_bf16 v[84:99], v[56:57], v[50:51], v[84:99]
    ds_read_b128 v[52:55], v28 offset:1024
    s_mov_b64 exec, s[32:33]
    ds_read_b64 v[56:57], v59 offset:1024
    s_mov_b64 exec, -1
    v_cvt_pk_bf16_f32 v100, v68, v69
    v_cvt_pk_bf16_f32 v101, v70, v71
    v_exp_f32 v73, v73
    v_exp_f32 v74, v74
    v_exp_f32 v75, v75
    v_exp_f32 v76, v76
    v_mfma_f32_32x32x16_bf16 v[132:147], v[60:63], v[108:111], v[132:147]
    s_add_u32 m0, s52, 53248
    s_nop 0
    buffer_load_dwordx4 v34, s[8:11], s42 offen sc1 lds
    s_add_u32 s42, s42, 4096
    v_cvt_pk_bf16_f32 v102, v72, v73
    v_cvt_pk_bf16_f32 v103, v74, v75
    v_exp_f32 v77, v77
    v_exp_f32 v78, v78
    v_exp_f32 v79, v79
    v_exp_f32 v80, v80
    v_mfma_f32_32x32x16_bf16 v[132:147], v[64:67], v[112:115], v[132:147]
    s_mov_b64 exec, s[34:35]
    ds_read_b128 v[60:63], v29 offset:1280
    ds_read_b128 v[64:67], v29 offset:1920
    s_mov_b64 exec, -1
    v_cvt_pk_bf16_f32 v104, v76, v77
    v_cvt_pk_bf16_f32 v105, v78, v79
    v_exp_f32 v81, v81
    v_exp_f32 v82, v82
    v_exp_f32 v83, v83
    v_cvt_pk_bf16_f32 v106, v80, v81
    v_cvt_pk_bf16_f32 v107, v82, v83
    s_waitcnt lgkmcnt(2)
    v_mfma_f32_32x32x16_bf16 v[68:83], v[52:55], v[40:43], 0
    v_exp_f32 v84, v84
    v_exp_f32 v85, v85
    v_exp_f32 v86, v86
    v_exp_f32 v87, v87
    v_exp_f32 v88, v88
    v_mfma_f32_32x32x8_bf16 v[68:83], v[56:57], v[44:45], v[68:83]
    v_cvt_pk_bf16_f32 v108, v84, v85
    v_cvt_pk_bf16_f32 v109, v86, v87
    v_exp_f32 v89, v89
    v_exp_f32 v90, v90
    v_exp_f32 v91, v91
    v_exp_f32 v92, v92
    s_waitcnt lgkmcnt(0)
    v_mfma_f32_32x32x16_bf16 v[116:131], v[60:63], v[100:103], v[116:131]
    s_add_u32 m0, s52, 57344
    s_nop 0
    buffer_load_dwordx4 v34, s[8:11], s43 offen sc1 lds
    s_add_u32 s43, s43, 10240
    v_cvt_pk_bf16_f32 v110, v88, v89
    v_cvt_pk_bf16_f32 v111, v90, v91
    v_exp_f32 v93, v93
    v_exp_f32 v94, v94
    v_exp_f32 v95, v95
    v_exp_f32 v96, v96
    v_mfma_f32_32x32x16_bf16 v[116:131], v[64:67], v[104:107], v[116:131]
    v_cvt_pk_bf16_f32 v112, v92, v93
    v_cvt_pk_bf16_f32 v113, v94, v95
    v_exp_f32 v97, v97
    v_exp_f32 v98, v98
    v_exp_f32 v99, v99
    v_cvt_pk_bf16_f32 v114, v96, v97
    v_cvt_pk_bf16_f32 v115, v98, v99
    v_mfma_f32_32x32x16_bf16 v[84:99], v[52:55], v[46:49], 0
    v_exp_f32 v68, v68
    v_exp_f32 v69, v69
    v_exp_f32 v70, v70
    v_exp_f32 v71, v71
    v_exp_f32 v72, v72
    v_mfma_f32_32x32x8_bf16 v[84:99], v[56:57], v[50:51], v[84:99]
    ds_read_b128 v[52:55], v28 offset:1536
    s_mov_b64 exec, s[32:33]
    ds_read_b64 v[56:57], v59 offset:1536
    s_mov_b64 exec, -1
    v_cvt_pk_bf16_f32 v100, v68, v69
    v_cvt_pk_bf16_f32 v101, v70, v71
    v_exp_f32 v73, v73
    v_exp_f32 v74, v74
    v_exp_f32 v75, v75
    v_exp_f32 v76, v76
    v_mfma_f32_32x32x16_bf16 v[132:147], v[60:63], v[108:111], v[132:147]
    s_add_u32 m0, s52, 61440
    s_nop 0
    buffer_load_dwordx4 v34, s[8:11], s44 offen sc1 lds
    s_add_u32 s44, s44, 10240
    v_cvt_pk_bf16_f32 v102, v72, v73
    v_cvt_pk_bf16_f32 v103, v74, v75
    v_exp_f32 v77, v77
    v_exp_f32 v78, v78
    v_exp_f32 v79, v79
    v_exp_f32 v80, v80
    v_mfma_f32_32x32x16_bf16 v[132:147], v[64:67], v[112:115], v[132:147]
    s_mov_b64 exec, s[34:35]
    ds_read_b128 v[60:63], v29 offset:2560
    ds_read_b128 v[64:67], v29 offset:3200
    s_mov_b64 exec, -1
    v_cvt_pk_bf16_f32 v104, v76, v77
    v_cvt_pk_bf16_f32 v105, v78, v79
    v_exp_f32 v81, v81
    v_exp_f32 v82, v82
    v_exp_f32 v83, v83
    v_cvt_pk_bf16_f32 v106, v80, v81
    v_cvt_pk_bf16_f32 v107, v82, v83
    s_waitcnt lgkmcnt(2)
    v_mfma_f32_32x32x16_bf16 v[68:83], v[52:55], v[40:43], 0
    v_exp_f32 v84, v84
    v_exp_f32 v85, v85
    v_exp_f32 v86, v86
    v_exp_f32 v87, v87
    v_exp_f32 v88, v88
    v_mfma_f32_32x32x8_bf16 v[68:83], v[56:57], v[44:45], v[68:83]
    v_cvt_pk_bf16_f32 v108, v84, v85
    v_cvt_pk_bf16_f32 v109, v86, v87
    v_exp_f32 v89, v89
    v_exp_f32 v90, v90
    v_exp_f32 v91, v91
    v_exp_f32 v92, v92
    s_waitcnt lgkmcnt(0)
    v_mfma_f32_32x32x16_bf16 v[116:131], v[60:63], v[100:103], v[116:131]
    s_add_u32 m0, s59, 65536
    s_nop 0
    buffer_load_dwordx4 v34, s[8:11], s45 offen sc1 lds
    s_add_u32 s45, s45, 10240
    v_cvt_pk_bf16_f32 v110, v88, v89
    v_cvt_pk_bf16_f32 v111, v90, v91
    v_exp_f32 v93, v93
    v_exp_f32 v94, v94
    v_exp_f32 v95, v95
    v_exp_f32 v96, v96
    v_mfma_f32_32x32x16_bf16 v[116:131], v[64:67], v[104:107], v[116:131]
    v_cvt_pk_bf16_f32 v112, v92, v93
    v_cvt_pk_bf16_f32 v113, v94, v95
    v_exp_f32 v97, v97
    v_exp_f32 v98, v98
    v_exp_f32 v99, v99
    v_cvt_pk_bf16_f32 v114, v96, v97
    v_cvt_pk_bf16_f32 v115, v98, v99
    s_setprio 2
    v_mfma_f32_32x32x16_bf16 v[84:99], v[52:55], v[46:49], 0
    v_exp_f32 v68, v68
    v_exp_f32 v69, v69
    v_exp_f32 v70, v70
    v_exp_f32 v71, v71
    v_exp_f32 v72, v72
    v_mfma_f32_32x32x8_bf16 v[84:99], v[56:57], v[50:51], v[84:99]
    ds_read_b128 v[52:55], v28 offset:2048
    s_mov_b64 exec, s[32:33]
    ds_read_b64 v[56:57], v59 offset:2048
    s_mov_b64 exec, -1
    v_cvt_pk_bf16_f32 v100, v68, v69
    v_cvt_pk_bf16_f32 v101, v70, v71
    v_exp_f32 v73, v73
    v_exp_f32 v74, v74
    v_exp_f32 v75, v75
    v_exp_f32 v76, v76
    v_mfma_f32_32x32x16_bf16 v[132:147], v[60:63], v[108:111], v[132:147]
    s_add_u32 m0, s52, 90112
    s_nop 0
    buffer_load_dwordx4 v34, s[8:11], s40 offen sc1 lds
    s_add_u32 s40, s40, 4096
    v_cvt_pk_bf16_f32 v102, v72, v73
    v_cvt_pk_bf16_f32 v103, v74, v75
    v_exp_f32 v77, v77
    v_exp_f32 v78, v78
    v_exp_f32 v79, v79
    v_exp_f32 v80, v80
    v_mfma_f32_32x32x16_bf16 v[132:147], v[64:67], v[112:115], v[132:147]
    s_mov_b64 exec, s[34:35]
    ds_read_b128 v[60:63], v29 offset:3840
    ds_read_b128 v[64:67], v29 offset:4480
    s_mov_b64 exec, -1
    v_cvt_pk_bf16_f32 v104, v76, v77
    v_cvt_pk_bf16_f32 v105, v78, v79
    v_exp_f32 v81, v81
    v_exp_f32 v82, v82
    v_exp_f32 v83, v83
    v_cvt_pk_bf16_f32 v106, v80, v81
    v_cvt_pk_bf16_f32 v107, v82, v83
    s_waitcnt lgkmcnt(2)
    v_mfma_f32_32x32x16_bf16 v[68:83], v[52:55], v[40:43], 0
    v_exp_f32 v84, v84
    v_exp_f32 v85, v85
    v_exp_f32 v86, v86
    v_exp_f32 v87, v87
    v_exp_f32 v88, v88
    v_mfma_f32_32x32x8_bf16 v[68:83], v[56:57], v[44:45], v[68:83]
    v_cvt_pk_bf16_f32 v108, v84, v85
    v_cvt_pk_bf16_f32 v109, v86, v87
    v_exp_f32 v89, v89
    v_exp_f32 v90, v90
    v_exp_f32 v91, v91
    v_exp_f32 v92, v92
    s_waitcnt lgkmcnt(0)
    v_mfma_f32_32x32x16_bf16 v[116:131], v[60:63], v[100:103], v[116:131]
    s_add_u32 m0, s52, 94208
    s_nop 0
    buffer_load_dwordx4 v34, s[8:11], s41 offen sc1 lds
    s_add_u32 s41, s41, 4096
    v_cvt_pk_bf16_f32 v110, v88, v89
    v_cvt_pk_bf16_f32 v111, v90, v91
    v_exp_f32 v93, v93
    v_exp_f32 v94, v94
    v_exp_f32 v95, v95
    v_exp_f32 v96, v96
    v_mfma_f32_32x32x16_bf16 v[116:131], v[64:67], v[104:107], v[116:131]
    v_cvt_pk_bf16_f32 v112, v92, v93
    v_cvt_pk_bf16_f32 v113, v94, v95
    v_exp_f32 v97, v97
    v_exp_f32 v98, v98
    v_exp_f32 v99, v99
    v_cvt_pk_bf16_f32 v114, v96, v97
    v_cvt_pk_bf16_f32 v115, v98, v99
    v_mfma_f32_32x32x16_bf16 v[84:99], v[52:55], v[46:49], 0
    v_exp_f32 v68, v68
    v_exp_f32 v69, v69
    v_exp_f32 v70, v70
    v_exp_f32 v71, v71
    v_exp_f32 v72, v72
    v_mfma_f32_32x32x8_bf16 v[84:99], v[56:57], v[50:51], v[84:99]
    ds_read_b128 v[52:55], v28 offset:2560
    s_mov_b64 exec, s[32:33]
    ds_read_b64 v[56:57], v59 offset:2560
    s_mov_b64 exec, -1
    v_cvt_pk_bf16_f32 v100, v68, v69
    v_cvt_pk_bf16_f32 v101, v70, v71
    v_exp_f32 v73, v73
    v_exp_f32 v74, v74
    v_exp_f32 v75, v75
    v_exp_f32 v76, v76
    v_mfma_f32_32x32x16_bf16 v[132:147], v[60:63], v[108:111], v[132:147]
    s_add_u32 m0, s52, 98304
    s_nop 0
    buffer_load_dwordx4 v34, s[8:11], s42 offen sc1 lds
    s_add_u32 s42, s42, 4096
    v_cvt_pk_bf16_f32 v102, v72, v73
    v_cvt_pk_bf16_f32 v103, v74, v75
    v_exp_f32 v77, v77
    v_exp_f32 v78, v78
    v_exp_f32 v79, v79
    v_exp_f32 v80, v80
    v_mfma_f32_32x32x16_bf16 v[132:147], v[64:67], v[112:115], v[132:147]
    s_mov_b64 exec, s[34:35]
    ds_read_b128 v[60:63], v29 offset:5120
    ds_read_b128 v[64:67], v29 offset:5760
    s_mov_b64 exec, -1
    v_cvt_pk_bf16_f32 v104, v76, v77
    v_cvt_pk_bf16_f32 v105, v78, v79
    v_exp_f32 v81, v81
    v_exp_f32 v82, v82
    v_exp_f32 v83, v83
    v_cvt_pk_bf16_f32 v106, v80, v81
    v_cvt_pk_bf16_f32 v107, v82, v83
    s_waitcnt lgkmcnt(2)
    v_mfma_f32_32x32x16_bf16 v[68:83], v[52:55], v[40:43], 0
    v_exp_f32 v84, v84
    v_exp_f32 v85, v85
    v_exp_f32 v86, v86
    v_exp_f32 v87, v87
    v_exp_f32 v88, v88
    v_mfma_f32_32x32x8_bf16 v[68:83], v[56:57], v[44:45], v[68:83]
    v_cvt_pk_bf16_f32 v108, v84, v85
    v_cvt_pk_bf16_f32 v109, v86, v87
    v_exp_f32 v89, v89
    v_exp_f32 v90, v90
    v_exp_f32 v91, v91
    v_exp_f32 v92, v92
    s_waitcnt lgkmcnt(0)
    v_mfma_f32_32x32x16_bf16 v[116:131], v[60:63], v[100:103], v[116:131]
    s_add_u32 m0, s52, 102400
    s_nop 0
    buffer_load_dwordx4 v34, s[8:11], s43 offen sc1 lds
    s_add_u32 s43, s43, 10240
    v_cvt_pk_bf16_f32 v110, v88, v89
    v_cvt_pk_bf16_f32 v111, v90, v91
    v_exp_f32 v93, v93
    v_exp_f32 v94, v94
    v_exp_f32 v95, v95
    v_exp_f32 v96, v96
    v_mfma_f32_32x32x16_bf16 v[116:131], v[64:67], v[104:107], v[116:131]
    v_cvt_pk_bf16_f32 v112, v92, v93
    v_cvt_pk_bf16_f32 v113, v94, v95
    v_exp_f32 v97, v97
    v_exp_f32 v98, v98
    v_exp_f32 v99, v99
    v_cvt_pk_bf16_f32 v114, v96, v97
    v_cvt_pk_bf16_f32 v115, v98, v99
    s_setprio 1
    v_mfma_f32_32x32x16_bf16 v[84:99], v[52:55], v[46:49], 0
    v_exp_f32 v68, v68
    v_exp_f32 v69, v69
    v_exp_f32 v70, v70
    v_exp_f32 v71, v71
    v_exp_f32 v72, v72
    v_mfma_f32_32x32x8_bf16 v[84:99], v[56:57], v[50:51], v[84:99]
    ds_read_b128 v[52:55], v28 offset:3072
    s_mov_b64 exec, s[32:33]
    ds_read_b64 v[56:57], v59 offset:3072
    s_mov_b64 exec, -1
    v_cvt_pk_bf16_f32 v100, v68, v69
    v_cvt_pk_bf16_f32 v101, v70, v71
    v_exp_f32 v73, v73
    v_exp_f32 v74, v74
    v_exp_f32 v75, v75
    v_exp_f32 v76, v76
    v_mfma_f32_32x32x16_bf16 v[132:147], v[60:63], v[108:111], v[132:147]
    s_add_u32 m0, s52, 106496
    s_nop 0
    buffer_load_dwordx4 v34, s[8:11], s44 offen sc1 lds
    s_add_u32 s44, s44, 10240
    v_cvt_pk_bf16_f32 v102, v72, v73
    v_cvt_pk_bf16_f32 v103, v74, v75
    v_exp_f32 v77, v77
    v_exp_f32 v78, v78
    v_exp_f32 v79, v79
    v_exp_f32 v80, v80
    v_mfma_f32_32x32x16_bf16 v[132:147], v[64:67], v[112:115], v[132:147]
    s_mov_b64 exec, s[34:35]
    ds_read_b128 v[60:63], v29 offset:6400
    ds_read_b128 v[64:67], v29 offset:7040
    s_mov_b64 exec, -1
    v_cvt_pk_bf16_f32 v104, v76, v77
    v_cvt_pk_bf16_f32 v105, v78, v79
    v_exp_f32 v81, v81
    v_exp_f32 v82, v82
    v_exp_f32 v83, v83
    v_cvt_pk_bf16_f32 v106, v80, v81
    v_cvt_pk_bf16_f32 v107, v82, v83
    s_waitcnt lgkmcnt(2)
    v_mfma_f32_32x32x16_bf16 v[68:83], v[52:55], v[40:43], 0
    v_exp_f32 v84, v84
    v_exp_f32 v85, v85
    v_exp_f32 v86, v86
    v_exp_f32 v87, v87
    v_exp_f32 v88, v88
    v_mfma_f32_32x32x8_bf16 v[68:83], v[56:57], v[44:45], v[68:83]
    v_cvt_pk_bf16_f32 v108, v84, v85
    v_cvt_pk_bf16_f32 v109, v86, v87
    v_exp_f32 v89, v89
    v_exp_f32 v90, v90
    v_exp_f32 v91, v91
    v_exp_f32 v92, v92
    s_waitcnt lgkmcnt(0)
    v_mfma_f32_32x32x16_bf16 v[116:131], v[60:63], v[100:103], v[116:131]
    s_add_u32 m0, s59, 110592
    s_nop 0
    buffer_load_dwordx4 v34, s[8:11], s45 offen sc1 lds
    s_add_u32 s45, s45, 10240
    v_cvt_pk_bf16_f32 v110, v88, v89
    v_cvt_pk_bf16_f32 v111, v90, v91
    v_exp_f32 v93, v93
    v_exp_f32 v94, v94
    v_exp_f32 v95, v95
    v_exp_f32 v96, v96
    v_mfma_f32_32x32x16_bf16 v[116:131], v[64:67], v[104:107], v[116:131]
    v_cvt_pk_bf16_f32 v112, v92, v93
    v_cvt_pk_bf16_f32 v113, v94, v95
    v_exp_f32 v97, v97
    v_exp_f32 v98, v98
    v_exp_f32 v99, v99
    v_cvt_pk_bf16_f32 v114, v96, v97
    v_cvt_pk_bf16_f32 v115, v98, v99
    v_mfma_f32_32x32x16_bf16 v[84:99], v[52:55], v[46:49], 0
    v_exp_f32 v68, v68
    v_exp_f32 v69, v69
    v_exp_f32 v70, v70
    v_exp_f32 v71, v71
    v_exp_f32 v72, v72
    v_mfma_f32_32x32x8_bf16 v[84:99], v[56:57], v[50:51], v[84:99]
    ds_read_b128 v[52:55], v28 offset:3584
    s_mov_b64 exec, s[32:33]
    ds_read_b64 v[56:57], v59 offset:3584
    s_mov_b64 exec, -1
    v_cvt_pk_bf16_f32 v100, v68, v69
    v_cvt_pk_bf16_f32 v101, v70, v71
    v_exp_f32 v73, v73
    v_exp_f32 v74, v74
    v_exp_f32 v75, v75
    v_exp_f32 v76, v76
    v_mfma_f32_32x32x16_bf16 v[132:147], v[60:63], v[108:111], v[132:147]
    s_cmp_eq_u32 s3, 0
    s_cbranch_scc0 L_w0_35
    v_lshlrev_b32 v30, 7, v24
    v_add_u32 v30, 8192, v30
    global_load_dword v37, v30, s[16:17] sc1
L_w0_35:
    v_cvt_pk_bf16_f32 v102, v72, v73
    v_cvt_pk_bf16_f32 v103, v74, v75
    v_exp_f32 v77, v77
    v_exp_f32 v78, v78
    v_exp_f32 v79, v79
    v_exp_f32 v80, v80
    v_mfma_f32_32x32x16_bf16 v[132:147], v[64:67], v[112:115], v[132:147]
    s_mov_b64 exec, s[34:35]
    ds_read_b128 v[60:63], v29 offset:7680
    ds_read_b128 v[64:67], v29 offset:8320
    s_mov_b64 exec, -1
    v_cvt_pk_bf16_f32 v104, v76, v77
    v_cvt_pk_bf16_f32 v105, v78, v79
    v_exp_f32 v81, v81
    v_exp_f32 v82, v82
    v_exp_f32 v83, v83
    v_cvt_pk_bf16_f32 v106, v80, v81
    v_cvt_pk_bf16_f32 v107, v82, v83
    s_setprio 0
    s_waitcnt lgkmcnt(2)
    v_mfma_f32_32x32x16_bf16 v[68:83], v[52:55], v[40:43], 0
    v_exp_f32 v84, v84
    v_exp_f32 v85, v85
    v_exp_f32 v86, v86
    v_exp_f32 v87, v87
    v_exp_f32 v88, v88
    v_mfma_f32_32x32x8_bf16 v[68:83], v[56:57], v[44:45], v[68:83]
    v_cvt_pk_bf16_f32 v108, v84, v85
    v_cvt_pk_bf16_f32 v109, v86, v87
    v_exp_f32 v89, v89
    v_exp_f32 v90, v90
    v_exp_f32 v91, v91
    v_exp_f32 v92, v92
    s_waitcnt lgkmcnt(0)
    v_mfma_f32_32x32x16_bf16 v[116:131], v[60:63], v[100:103], v[116:131]
    v_cvt_pk_bf16_f32 v110, v88, v89
    v_cvt_pk_bf16_f32 v111, v90, v91
    v_exp_f32 v93, v93
    v_exp_f32 v94, v94
    v_exp_f32 v95, v95
    v_exp_f32 v96, v96
    v_mfma_f32_32x32x16_bf16 v[116:131], v[64:67], v[104:107], v[116:131]
    v_cvt_pk_bf16_f32 v112, v92, v93
    v_cvt_pk_bf16_f32 v113, v94, v95
    v_exp_f32 v97, v97
    v_exp_f32 v98, v98
    v_exp_f32 v99, v99
    v_cvt_pk_bf16_f32 v114, v96, v97
    v_cvt_pk_bf16_f32 v115, v98, v99
    v_mfma_f32_32x32x16_bf16 v[84:99], v[52:55], v[46:49], 0
    v_exp_f32 v68, v68
    v_exp_f32 v69, v69
    v_exp_f32 v70, v70
    v_exp_f32 v71, v71
    v_exp_f32 v72, v72
    v_mfma_f32_32x32x8_bf16 v[84:99], v[56:57], v[50:51], v[84:99]
    s_waitcnt vmcnt(0)
    s_cmp_eq_u32 s3, 0
    s_cbranch_scc0 L_w0_38
L_pl_39:
    v_cmp_le_u32 vcc, 32, v37
    s_nop 1
    s_cmp_eq_u64 vcc, -1
    s_cbranch_scc1 L_pd_40

    s_sleep 4
    v_lshlrev_b32 v30, 7, v24
    v_add_u32 v30, 8192, v30
    global_load_dword v37, v30, s[16:17] sc1
    s_waitcnt vmcnt(0)
    s_branch L_pl_39
L_pd_40:
L_w0_38:
    s_barrier
    s_setprio 3
    v_add_u32 v28, 45056, v28
    v_add_u32 v59, 45056, v59
    ds_read_b128 v[52:55], v28 offset:0
    s_mov_b64 exec, s[32:33]
    ds_read_b64 v[56:57], v59 offset:0
    s_mov_b64 exec, -1
    v_cvt_pk_bf16_f32 v100, v68, v69
    v_cvt_pk_bf16_f32 v101, v70, v71
    v_exp_f32 v73, v73
    v_exp_f32 v74, v74
    v_exp_f32 v75, v75
    v_exp_f32 v76, v76
    v_mfma_f32_32x32x16_bf16 v[132:147], v[60:63], v[108:111], v[132:147]
    v_cvt_pk_bf16_f32 v102, v72, v73
    v_cvt_pk_bf16_f32 v103, v74, v75
    v_exp_f32 v77, v77
    v_exp_f32 v78, v78
    v_exp_f32 v79, v79
    v_exp_f32 v80, v80
    v_mfma_f32_32x32x16_bf16 v[132:147], v[64:67], v[112:115], v[132:147]
    s_mov_b64 exec, s[34:35]
    ds_read_b128 v[60:63], v29 offset:8960
    ds_read_b128 v[64:67], v29 offset:9600
    s_mov_b64 exec, -1
    v_cvt_pk_bf16_f32 v104, v76, v77
    v_cvt_pk_bf16_f32 v105, v78, v79
    v_exp_f32 v81, v81
    v_exp_f32 v82, v82
    v_exp_f32 v83, v83
    v_cvt_pk_bf16_f32 v106, v80, v81
    v_cvt_pk_bf16_f32 v107, v82, v83
    s_waitcnt lgkmcnt(2)
    v_mfma_f32_32x32x16_bf16 v[68:83], v[52:55], v[40:43], 0
    v_exp_f32 v84, v84
    v_exp_f32 v85, v85
    v_exp_f32 v86, v86
    v_exp_f32 v87, v87
    v_exp_f32 v88, v88
    v_mfma_f32_32x32x8_bf16 v[68:83], v[56:57], v[44:45], v[68:83]
    v_cvt_pk_bf16_f32 v108, v84, v85
    v_cvt_pk_bf16_f32 v109, v86, v87
    v_exp_f32 v89, v89
    v_exp_f32 v90, v90
    v_exp_f32 v91, v91
    v_exp_f32 v92, v92
    s_waitcnt lgkmcnt(0)
    v_mfma_f32_32x32x16_bf16 v[116:131], v[60:63], v[100:103], v[116:131]
    s_mul_i32 s50, s46, 1536
    s_add_u32 s50, s50, 24190976
    v_lshrrev_b32 v30, 1, v34
    buffer_load_dwordx4 v[2:5], v34, s[8:11], s50 offen sc1
    buffer_load_dwordx2 v[6:7], v30, s[8:11], s50 offen offset:1024 sc1

    v_cvt_pk_bf16_f32 v110, v88, v89
    v_cvt_pk_bf16_f32 v111, v90, v91
    v_exp_f32 v93, v93
    v_exp_f32 v94, v94
    v_exp_f32 v95, v95
    v_exp_f32 v96, v96
    v_mfma_f32_32x32x16_bf16 v[116:131], v[64:67], v[104:107], v[116:131]
    v_cvt_pk_bf16_f32 v112, v92, v93
    v_cvt_pk_bf16_f32 v113, v94, v95
    v_exp_f32 v97, v97
    v_exp_f32 v98, v98
    v_exp_f32 v99, v99
    v_cvt_pk_bf16_f32 v114, v96, v97
    v_cvt_pk_bf16_f32 v115, v98, v99
    v_add_u32 v29, 45056, v29
    v_mfma_f32_32x32x16_bf16 v[84:99], v[52:55], v[46:49], 0
    v_exp_f32 v68, v68
    v_exp_f32 v69, v69
    v_exp_f32 v70, v70
    v_exp_f32 v71, v71
    v_exp_f32 v72, v72
    v_mfma_f32_32x32x8_bf16 v[84:99], v[56:57], v[50:51], v[84:99]
    ds_read_b128 v[52:55], v28 offset:512
    s_mov_b64 exec, s[32:33]
    ds_read_b64 v[56:57], v59 offset:512
    s_mov_b64 exec, -1
    v_cvt_pk_bf16_f32 v100, v68, v69
    v_cvt_pk_bf16_f32 v101, v70, v71
    v_exp_f32 v73, v73
    v_exp_f32 v74, v74
    v_exp_f32 v75, v75
    v_exp_f32 v76, v76
    v_mfma_f32_32x32x16_bf16 v[132:147], v[60:63], v[108:111], v[132:147]
    s_add_u32 s50, s54, s57
    s_add_u32 s50, s50, 2621440
    buffer_load_dwordx4 v[8:11], v38, s[8:11], s50 offen sc1
    buffer_load_dwordx2 v[12:13], v27, s[8:11], s50 offen sc1
    v_cvt_pk_bf16_f32 v102, v72, v73
    v_cvt_pk_bf16_f32 v103, v74, v75
    v_exp_f32 v77, v77
    v_exp_f32 v78, v78
    v_exp_f32 v79, v79
    v_exp_f32 v80, v80
    v_mfma_f32_32x32x16_bf16 v[132:147], v[64:67], v[112:115], v[132:147]
    s_mov_b64 exec, s[34:35]
    ds_read_b128 v[60:63], v29 offset:0
    ds_read_b128 v[64:67], v29 offset:640
    s_mov_b64 exec, -1
    v_cvt_pk_bf16_f32 v104, v76, v77
    v_cvt_pk_bf16_f32 v105, v78, v79
    v_exp_f32 v81, v81
    v_exp_f32 v82, v82
    v_exp_f32 v83, v83
    v_cvt_pk_bf16_f32 v106, v80, v81
    v_cvt_pk_bf16_f32 v107, v82, v83
    s_waitcnt lgkmcnt(2)
    v_mfma_f32_32x32x16_bf16 v[68:83], v[52:55], v[40:43], 0
    v_exp_f32 v84, v84
    v_exp_f32 v85, v85
    v_exp_f32 v86, v86
    v_exp_f32 v87, v87
    v_exp_f32 v88, v88
    v_mfma_f32_32x32x8_bf16 v[68:83], v[56:57], v[44:45], v[68:83]
    v_cvt_pk_bf16_f32 v108, v84, v85
    v_cvt_pk_bf16_f32 v109, v86, v87
    v_exp_f32 v89, v89
    v_exp_f32 v90, v90
    v_exp_f32 v91, v91
    v_exp_f32 v92, v92
    s_waitcnt lgkmcnt(0)
    v_mfma_f32_32x32x16_bf16 v[116:131], v[60:63], v[100:103], v[116:131]
    s_add_u32 s50, s54, s57
    s_add_u32 s50, s50, 0
    buffer_load_dwordx4 v[14:17], v38, s[8:11], s50 offen sc1
    buffer_load_dwordx2 v[18:19], v27, s[8:11], s50 offen sc1
    v_cvt_pk_bf16_f32 v110, v88, v89
    v_cvt_pk_bf16_f32 v111, v90, v91
    v_exp_f32 v93, v93
    v_exp_f32 v94, v94
    v_exp_f32 v95, v95
    v_exp_f32 v96, v96
    v_mfma_f32_32x32x16_bf16 v[116:131], v[64:67], v[104:107], v[116:131]
    v_cvt_pk_bf16_f32 v112, v92, v93
    v_cvt_pk_bf16_f32 v113, v94, v95
    v_exp_f32 v97, v97
    v_exp_f32 v98, v98
    v_exp_f32 v99, v99
    v_cvt_pk_bf16_f32 v114, v96, v97
    v_cvt_pk_bf16_f32 v115, v98, v99
    v_mfma_f32_32x32x16_bf16 v[84:99], v[52:55], v[46:49], 0
    v_exp_f32 v68, v68
    v_exp_f32 v69, v69
    v_exp_f32 v70, v70
    v_exp_f32 v71, v71
    v_exp_f32 v72, v72
    v_mfma_f32_32x32x8_bf16 v[84:99], v[56:57], v[50:51], v[84:99]
    ds_read_b128 v[52:55], v28 offset:1024
    s_mov_b64 exec, s[32:33]
    ds_read_b64 v[56:57], v59 offset:1024
    s_mov_b64 exec, -1
    v_cvt_pk_bf16_f32 v100, v68, v69
    v_cvt_pk_bf16_f32 v101, v70, v71
    v_exp_f32 v73, v73
    v_exp_f32 v74, v74
    v_exp_f32 v75, v75
    v_exp_f32 v76, v76
    v_mfma_f32_32x32x16_bf16 v[132:147], v[60:63], v[108:111], v[132:147]
    v_lshlrev_b32 v30, 2, v25
    s_lshr_b32 s50, s54, 2
    s_add_u32 s50, s50, 15728640
    buffer_load_dword v35, v30, s[8:11], s50 offen sc1

    v_cvt_pk_bf16_f32 v102, v72, v73
    v_cvt_pk_bf16_f32 v103, v74, v75
    v_exp_f32 v77, v77
    v_exp_f32 v78, v78
    v_exp_f32 v79, v79
    v_exp_f32 v80, v80
    v_mfma_f32_32x32x16_bf16 v[132:147], v[64:67], v[112:115], v[132:147]
    s_mov_b64 exec, s[34:35]
    ds_read_b128 v[60:63], v29 offset:1280
    ds_read_b128 v[64:67], v29 offset:1920
    s_mov_b64 exec, -1
    v_cvt_pk_bf16_f32 v104, v76, v77
    v_cvt_pk_bf16_f32 v105, v78, v79
    v_exp_f32 v81, v81
    v_exp_f32 v82, v82
    v_exp_f32 v83, v83
    v_cvt_pk_bf16_f32 v106, v80, v81
    v_cvt_pk_bf16_f32 v107, v82, v83
    s_waitcnt lgkmcnt(2)
    v_mfma_f32_32x32x16_bf16 v[68:83], v[52:55], v[40:43], 0
    v_exp_f32 v84, v84
    v_exp_f32 v85, v85
    v_exp_f32 v86, v86
    v_exp_f32 v87, v87
    v_exp_f32 v88, v88
    v_mfma_f32_32x32x8_bf16 v[68:83], v[56:57], v[44:45], v[68:83]
    v_cvt_pk_bf16_f32 v108, v84, v85
    v_cvt_pk_bf16_f32 v109, v86, v87
    v_exp_f32 v89, v89
    v_exp_f32 v90, v90
    v_exp_f32 v91, v91
    v_exp_f32 v92, v92
    s_waitcnt lgkmcnt(0)
    v_mfma_f32_32x32x16_bf16 v[116:131], v[60:63], v[100:103], v[116:131]
    v_cvt_pk_bf16_f32 v110, v88, v89
    v_cvt_pk_bf16_f32 v111, v90, v91
    v_exp_f32 v93, v93
    v_exp_f32 v94, v94
    v_exp_f32 v95, v95
    v_exp_f32 v96, v96
    v_mfma_f32_32x32x16_bf16 v[116:131], v[64:67], v[104:107], v[116:131]
    v_cvt_pk_bf16_f32 v112, v92, v93
    v_cvt_pk_bf16_f32 v113, v94, v95
    v_exp_f32 v97, v97
    v_exp_f32 v98, v98
    v_exp_f32 v99, v99
    v_cvt_pk_bf16_f32 v114, v96, v97
    v_cvt_pk_bf16_f32 v115, v98, v99
    v_mfma_f32_32x32x16_bf16 v[84:99], v[52:55], v[46:49], 0
    v_exp_f32 v68, v68
    v_exp_f32 v69, v69
    v_exp_f32 v70, v70
    v_exp_f32 v71, v71
    v_exp_f32 v72, v72
    v_mfma_f32_32x32x8_bf16 v[84:99], v[56:57], v[50:51], v[84:99]
    ds_read_b128 v[52:55], v28 offset:1536
    s_mov_b64 exec, s[32:33]
    ds_read_b64 v[56:57], v59 offset:1536
    s_mov_b64 exec, -1
    v_cvt_pk_bf16_f32 v100, v68, v69
    v_cvt_pk_bf16_f32 v101, v70, v71
    v_exp_f32 v73, v73
    v_exp_f32 v74, v74
    v_exp_f32 v75, v75
    v_exp_f32 v76, v76
    v_mfma_f32_32x32x16_bf16 v[132:147], v[60:63], v[108:111], v[132:147]
    s_cmp_ge_u32 s3, 2
    s_cbranch_scc1 L_va_41
    s_mul_i32 s50, s47, 10240
    s_add_u32 s50, s50, s53
    s_add_u32 s50, s50, 5242880
    s_mov_b64 exec, s[34:35]
    buffer_load_dwordx4 v[192:195], v58, s[8:11], s50 offen sc1
    buffer_load_dwordx4 v[196:199], v58, s[8:11], s50 offen offset:640 sc1
    s_mov_b64 exec, -1

L_va_41:
    v_cvt_pk_bf16_f32 v102, v72, v73
    v_cvt_pk_bf16_f32 v103, v74, v75
    v_exp_f32 v77, v77
    v_exp_f32 v78, v78
    v_exp_f32 v79, v79
    v_exp_f32 v80, v80
    v_mfma_f32_32x32x16_bf16 v[132:147], v[64:67], v[112:115], v[132:147]
    s_mov_b64 exec, s[34:35]
    ds_read_b128 v[60:63], v29 offset:2560
    ds_read_b128 v[64:67], v29 offset:3200
    s_mov_b64 exec, -1
    v_cvt_pk_bf16_f32 v104, v76, v77
    v_cvt_pk_bf16_f32 v105, v78, v79
    v_exp_f32 v81, v81
    v_exp_f32 v82, v82
    v_exp_f32 v83, v83
    v_cvt_pk_bf16_f32 v106, v80, v81
    v_cvt_pk_bf16_f32 v107, v82, v83
    s_waitcnt lgkmcnt(2)
    v_mfma_f32_32x32x16_bf16 v[68:83], v[52:55], v[40:43], 0
    v_exp_f32 v84, v84
    v_exp_f32 v85, v85
    v_exp_f32 v86, v86
    v_exp_f32 v87, v87
    v_exp_f32 v88, v88
    v_mfma_f32_32x32x8_bf16 v[68:83], v[56:57], v[44:45], v[68:83]
    v_cvt_pk_bf16_f32 v108, v84, v85
    v_cvt_pk_bf16_f32 v109, v86, v87
    v_exp_f32 v89, v89
    v_exp_f32 v90, v90
    v_exp_f32 v91, v91
    v_exp_f32 v92, v92
    s_waitcnt lgkmcnt(0)
    v_mfma_f32_32x32x16_bf16 v[116:131], v[60:63], v[100:103], v[116:131]
    s_cmp_ge_u32 s3, 2
    s_cbranch_scc1 L_va_42
    s_mul_i32 s50, s47, 10240
    s_add_u32 s50, s50, s53
    s_add_u32 s50, s50, 5244160
    s_mov_b64 exec, s[34:35]
    buffer_load_dwordx4 v[200:203], v58, s[8:11], s50 offen sc1
    buffer_load_dwordx4 v[204:207], v58, s[8:11], s50 offen offset:640 sc1
    s_mov_b64 exec, -1

L_va_42:
    v_cvt_pk_bf16_f32 v110, v88, v89
    v_cvt_pk_bf16_f32 v111, v90, v91
    v_exp_f32 v93, v93
    v_exp_f32 v94, v94
    v_exp_f32 v95, v95
    v_exp_f32 v96, v96
    v_mfma_f32_32x32x16_bf16 v[116:131], v[64:67], v[104:107], v[116:131]
    v_cvt_pk_bf16_f32 v112, v92, v93
    v_cvt_pk_bf16_f32 v113, v94, v95
    v_exp_f32 v97, v97
    v_exp_f32 v98, v98
    v_exp_f32 v99, v99
    v_cvt_pk_bf16_f32 v114, v96, v97
    v_cvt_pk_bf16_f32 v115, v98, v99
    s_setprio 2
    v_mfma_f32_32x32x16_bf16 v[84:99], v[52:55], v[46:49], 0
    v_exp_f32 v68, v68
    v_exp_f32 v69, v69
    v_exp_f32 v70, v70
    v_exp_f32 v71, v71
    v_exp_f32 v72, v72
    v_mfma_f32_32x32x8_bf16 v[84:99], v[56:57], v[50:51], v[84:99]
    ds_read_b128 v[52:55], v28 offset:2048
    s_mov_b64 exec, s[32:33]
    ds_read_b64 v[56:57], v59 offset:2048
    s_mov_b64 exec, -1
    v_cvt_pk_bf16_f32 v100, v68, v69
    v_cvt_pk_bf16_f32 v101, v70, v71
    v_exp_f32 v73, v73
    v_exp_f32 v74, v74
    v_exp_f32 v75, v75
    v_exp_f32 v76, v76
    v_mfma_f32_32x32x16_bf16 v[132:147], v[60:63], v[108:111], v[132:147]
    s_cmp_ge_u32 s3, 2
    s_cbranch_scc1 L_va_43
    s_mul_i32 s50, s47, 10240
    s_add_u32 s50, s50, s53
    s_add_u32 s50, s50, 5245440
    s_mov_b64 exec, s[34:35]
    buffer_load_dwordx4 v[208:211], v58, s[8:11], s50 offen sc1
    buffer_load_dwordx4 v[212:215], v58, s[8:11], s50 offen offset:640 sc1
    s_mov_b64 exec, -1

L_va_43:
    v_cvt_pk_bf16_f32 v102, v72, v73
    v_cvt_pk_bf16_f32 v103, v74, v75
    v_exp_f32 v77, v77
    v_exp_f32 v78, v78
    v_exp_f32 v79, v79
    v_exp_f32 v80, v80
    v_mfma_f32_32x32x16_bf16 v[132:147], v[64:67], v[112:115], v[132:147]
    s_mov_b64 exec, s[34:35]
    ds_read_b128 v[60:63], v29 offset:3840
    ds_read_b128 v[64:67], v29 offset:4480
    s_mov_b64 exec, -1
    v_cvt_pk_bf16_f32 v104, v76, v77
    v_cvt_pk_bf16_f32 v105, v78, v79
    v_exp_f32 v81, v81
    v_exp_f32 v82, v82
    v_exp_f32 v83, v83
    v_cvt_pk_bf16_f32 v106, v80, v81
    v_cvt_pk_bf16_f32 v107, v82, v83
    s_waitcnt lgkmcnt(2)
    v_mfma_f32_32x32x16_bf16 v[68:83], v[52:55], v[40:43], 0
    v_exp_f32 v84, v84
    v_exp_f32 v85, v85
    v_exp_f32 v86, v86
    v_exp_f32 v87, v87
    v_exp_f32 v88, v88
    v_mfma_f32_32x32x8_bf16 v[68:83], v[56:57], v[44:45], v[68:83]
    v_cvt_pk_bf16_f32 v108, v84, v85
    v_cvt_pk_bf16_f32 v109, v86, v87
    v_exp_f32 v89, v89
    v_exp_f32 v90, v90
    v_exp_f32 v91, v91
    v_exp_f32 v92, v92
    s_waitcnt lgkmcnt(0)
    v_mfma_f32_32x32x16_bf16 v[116:131], v[60:63], v[100:103], v[116:131]
    s_cmp_ge_u32 s3, 2
    s_cbranch_scc1 L_va_44
    s_mul_i32 s50, s47, 10240
    s_add_u32 s50, s50, s53
    s_add_u32 s50, s50, 5246720
    s_mov_b64 exec, s[34:35]
    buffer_load_dwordx4 v[216:219], v58, s[8:11], s50 offen sc1
    buffer_load_dwordx4 v[220:223], v58, s[8:11], s50 offen offset:640 sc1
    s_mov_b64 exec, -1

L_va_44:
    v_cvt_pk_bf16_f32 v110, v88, v89
    v_cvt_pk_bf16_f32 v111, v90, v91
    v_exp_f32 v93, v93
    v_exp_f32 v94, v94
    v_exp_f32 v95, v95
    v_exp_f32 v96, v96
    v_mfma_f32_32x32x16_bf16 v[116:131], v[64:67], v[104:107], v[116:131]
    v_cvt_pk_bf16_f32 v112, v92, v93
    v_cvt_pk_bf16_f32 v113, v94, v95
    v_exp_f32 v97, v97
    v_exp_f32 v98, v98
    v_exp_f32 v99, v99
    v_cvt_pk_bf16_f32 v114, v96, v97
    v_cvt_pk_bf16_f32 v115, v98, v99
    v_mfma_f32_32x32x16_bf16 v[84:99], v[52:55], v[46:49], 0
    v_exp_f32 v68, v68
    v_exp_f32 v69, v69
    v_exp_f32 v70, v70
    v_exp_f32 v71, v71
    v_exp_f32 v72, v72
    v_mfma_f32_32x32x8_bf16 v[84:99], v[56:57], v[50:51], v[84:99]
    ds_read_b128 v[52:55], v28 offset:2560
    s_mov_b64 exec, s[32:33]
    ds_read_b64 v[56:57], v59 offset:2560
    s_mov_b64 exec, -1
    v_cvt_pk_bf16_f32 v100, v68, v69
    v_cvt_pk_bf16_f32 v101, v70, v71
    v_exp_f32 v73, v73
    v_exp_f32 v74, v74
    v_exp_f32 v75, v75
    v_exp_f32 v76, v76
    v_mfma_f32_32x32x16_bf16 v[132:147], v[60:63], v[108:111], v[132:147]
    s_cmp_ge_u32 s3, 2
    s_cbranch_scc1 L_va_45
    s_mul_i32 s50, s47, 10240
    s_add_u32 s50, s50, s53
    s_add_u32 s50, s50, 5248000
    s_mov_b64 exec, s[34:35]
    buffer_load_dwordx4 v[224:227], v58, s[8:11], s50 offen sc1
    buffer_load_dwordx4 v[228:231], v58, s[8:11], s50 offen offset:640 sc1
    s_mov_b64 exec, -1

L_va_45:
    v_cvt_pk_bf16_f32 v102, v72, v73
    v_cvt_pk_bf16_f32 v103, v74, v75
    v_exp_f32 v77, v77
    v_exp_f32 v78, v78
    v_exp_f32 v79, v79
    v_exp_f32 v80, v80
    v_mfma_f32_32x32x16_bf16 v[132:147], v[64:67], v[112:115], v[132:147]
    s_mov_b64 exec, s[34:35]
    ds_read_b128 v[60:63], v29 offset:5120
    ds_read_b128 v[64:67], v29 offset:5760
    s_mov_b64 exec, -1
    v_cvt_pk_bf16_f32 v104, v76, v77
    v_cvt_pk_bf16_f32 v105, v78, v79
    v_exp_f32 v81, v81
    v_exp_f32 v82, v82
    v_exp_f32 v83, v83
    v_cvt_pk_bf16_f32 v106, v80, v81
    v_cvt_pk_bf16_f32 v107, v82, v83
    s_waitcnt lgkmcnt(2)
    v_mfma_f32_32x32x16_bf16 v[68:83], v[52:55], v[40:43], 0
    v_exp_f32 v84, v84
    v_exp_f32 v85, v85
    v_exp_f32 v86, v86
    v_exp_f32 v87, v87
    v_exp_f32 v88, v88
    v_mfma_f32_32x32x8_bf16 v[68:83], v[56:57], v[44:45], v[68:83]
    v_cvt_pk_bf16_f32 v108, v84, v85
    v_cvt_pk_bf16_f32 v109, v86, v87
    v_exp_f32 v89, v89
    v_exp_f32 v90, v90
    v_exp_f32 v91, v91
    v_exp_f32 v92, v92
    s_waitcnt lgkmcnt(0)
    v_mfma_f32_32x32x16_bf16 v[116:131], v[60:63], v[100:103], v[116:131]
    s_cmp_ge_u32 s3, 2
    s_cbranch_scc1 L_va_46
    s_mul_i32 s50, s47, 10240
    s_add_u32 s50, s50, s53
    s_add_u32 s50, s50, 5249280
    s_mov_b64 exec, s[34:35]
    buffer_load_dwordx4 v[232:235], v58, s[8:11], s50 offen sc1
    buffer_load_dwordx4 v[236:239], v58, s[8:11], s50 offen offset:640 sc1
    s_mov_b64 exec, -1

L_va_46:
    v_cvt_pk_bf16_f32 v110, v88, v89
    v_cvt_pk_bf16_f32 v111, v90, v91
    v_exp_f32 v93, v93
    v_exp_f32 v94, v94
    v_exp_f32 v95, v95
    v_exp_f32 v96, v96
    v_mfma_f32_32x32x16_bf16 v[116:131], v[64:67], v[104:107], v[116:131]
    v_cvt_pk_bf16_f32 v112, v92, v93
    v_cvt_pk_bf16_f32 v113, v94, v95
    v_exp_f32 v97, v97
    v_exp_f32 v98, v98
    v_exp_f32 v99, v99
    v_cvt_pk_bf16_f32 v114, v96, v97
    v_cvt_pk_bf16_f32 v115, v98, v99
    s_waitcnt vmcnt(15)
    s_cmp_lt_u32 s3, 2
    s_cbranch_scc1 L_pk_47
    s_waitcnt vmcnt(3)
L_pk_47:
    v_mfma_f32_32x32x16_bf16 v[160:175], v[2:5], v[8:11], 0
    v_mfma_f32_32x32x8_bf16 v[160:175], v[6:7], v[12:13], v[160:175]
    s_nop 11
    v_max3_f32 v30, v160, v161, v162
    v_min3_f32 v31, v160, v161, v162
    v_max3_f32 v30, v30, v163, v164
    v_min3_f32 v31, v31, v163, v164
    v_max3_f32 v30, v30, v165, v166
    v_min3_f32 v31, v31, v165, v166
    v_max3_f32 v30, v30, v167, v168
    v_min3_f32 v31, v31, v167, v168
    v_max_f32 v30, v30, v169
    v_min_f32 v31, v31, v169
    v_mov_b32 v32, v30
    v_mov_b32 v33, v31
    s_nop 1
    v_permlane32_swap_b32 v30, v32
    v_permlane32_swap_b32 v31, v33
    s_nop 0
    v_max_f32 v30, v30, v32
    v_min_f32 v31, v31, v33
    v_pk_add_f32 v[176:177], v[160:161], v[30:31] op_sel:[0,0] op_sel_hi:[1,0] neg_lo:[0,1] neg_hi:[0,1]
    v_pk_add_f32 v[186:187], v[160:161], v[30:31] op_sel:[0,1] op_sel_hi:[1,1] neg_lo:[1,0] neg_hi:[1,0]
    v_pk_add_f32 v[178:179], v[162:163], v[30:31] op_sel:[0,0] op_sel_hi:[1,0] neg_lo:[0,1] neg_hi:[0,1]
    v_pk_add_f32 v[188:189], v[162:163], v[30:31] op_sel:[0,1] op_sel_hi:[1,1] neg_lo:[1,0] neg_hi:[1,0]
    v_pk_add_f32 v[180:181], v[164:165], v[30:31] op_sel:[0,0] op_sel_hi:[1,0] neg_lo:[0,1] neg_hi:[0,1]
    v_pk_add_f32 v[190:191], v[164:165], v[30:31] op_sel:[0,1] op_sel_hi:[1,1] neg_lo:[1,0] neg_hi:[1,0]
    v_pk_add_f32 v[182:183], v[166:167], v[30:31] op_sel:[0,0] op_sel_hi:[1,0] neg_lo:[0,1] neg_hi:[0,1]
    v_pk_add_f32 v[20:21], v[166:167], v[30:31] op_sel:[0,1] op_sel_hi:[1,1] neg_lo:[1,0] neg_hi:[1,0]
    v_pk_add_f32 v[184:185], v[168:169], v[30:31] op_sel:[0,0] op_sel_hi:[1,0] neg_lo:[0,1] neg_hi:[0,1]
    v_pk_add_f32 v[22:23], v[168:169], v[30:31] op_sel:[0,1] op_sel_hi:[1,1] neg_lo:[1,0] neg_hi:[1,0]
    v_exp_f32 v176, v176
    v_exp_f32 v186, v186
    v_exp_f32 v177, v177
    v_exp_f32 v187, v187
    v_exp_f32 v178, v178
    v_exp_f32 v188, v188
    v_exp_f32 v179, v179
    v_exp_f32 v189, v189
    v_exp_f32 v180, v180
    v_exp_f32 v190, v190
    v_exp_f32 v181, v181
    v_exp_f32 v191, v191
    v_exp_f32 v182, v182
    v_exp_f32 v20, v20
    v_exp_f32 v183, v183
    v_exp_f32 v21, v21
    v_exp_f32 v184, v184
    v_exp_f32 v22, v22
    v_exp_f32 v185, v185
    v_exp_f32 v23, v23
    v_pk_add_f32 v[160:161], v[176:177], v[178:179]
    v_pk_add_f32 v[162:163], v[186:187], v[188:189]
    v_pk_add_f32 v[160:161], v[160:161], v[180:181]
    v_pk_add_f32 v[162:163], v[162:163], v[190:191]
    v_pk_add_f32 v[160:161], v[160:161], v[182:183]
    v_pk_add_f32 v[162:163], v[162:163], v[20:21]
    v_pk_add_f32 v[160:161], v[160:161], v[184:185]
    v_pk_add_f32 v[162:163], v[162:163], v[22:23]
    v_add_f32 v30, v160, v161
    v_add_f32 v31, v162, v163
    v_mov_b32 v32, v30
    v_mov_b32 v33, v31
    s_nop 1
    v_permlane32_swap_b32 v30, v32
    v_permlane32_swap_b32 v31, v33
    s_nop 0
    v_pk_add_f32 v[30:31], v[30:31], v[32:33]
    v_rcp_f32 v30, v30
    v_rcp_f32 v31, v31
    s_nop 0
    v_pk_mul_f32 v[176:177], v[176:177], v[30:31] op_sel:[0,0] op_sel_hi:[1,0]
    v_pk_mul_f32 v[186:187], v[186:187], v[30:31] op_sel:[0,1] op_sel_hi:[1,1]
    v_pk_mul_f32 v[178:179], v[178:179], v[30:31] op_sel:[0,0] op_sel_hi:[1,0]
    v_pk_mul_f32 v[188:189], v[188:189], v[30:31] op_sel:[0,1] op_sel_hi:[1,1]
    v_pk_mul_f32 v[180:181], v[180:181], v[30:31] op_sel:[0,0] op_sel_hi:[1,0]
    v_pk_mul_f32 v[190:191], v[190:191], v[30:31] op_sel:[0,1] op_sel_hi:[1,1]
    v_pk_mul_f32 v[182:183], v[182:183], v[30:31] op_sel:[0,0] op_sel_hi:[1,0]
    v_pk_mul_f32 v[20:21], v[20:21], v[30:31] op_sel:[0,1] op_sel_hi:[1,1]
    v_pk_mul_f32 v[184:185], v[184:185], v[30:31] op_sel:[0,0] op_sel_hi:[1,0]
    v_pk_mul_f32 v[22:23], v[22:23], v[30:31] op_sel:[0,1] op_sel_hi:[1,1]
    v_cvt_pk_bf16_f32 v148, v176, v177
    v_cvt_pk_bf16_f32 v154, v186, v187
    v_cvt_pk_bf16_f32 v149, v178, v179
    v_cvt_pk_bf16_f32 v155, v188, v189
    v_cvt_pk_bf16_f32 v150, v180, v181
    v_cvt_pk_bf16_f32 v156, v190, v191
    v_cvt_pk_bf16_f32 v151, v182, v183
    v_cvt_pk_bf16_f32 v157, v20, v21
    v_cvt_pk_bf16_f32 v152, v184, v185
    v_cvt_pk_bf16_f32 v158, v22, v23
    s_mul_i32 s50, s55, 1536
    s_add_u32 s50, s50, 135168
    v_mul_u32_u24 v30, 48, v25
    v_lshl_add_u32 v30, v26, 3, v30
    v_add_u32 v30, s50, v30

    ds_write_b64 v30, v[148:149] offset:0
    ds_write_b64 v30, v[150:151] offset:16
    ds_write_b64 v30, v[152:153] offset:32
    ds_write_b64 v30, v[154:155] offset:12288
    ds_write_b64 v30, v[156:157] offset:12304
    ds_write_b64 v30, v[158:159] offset:12320
    s_waitcnt lgkmcnt(0)
    s_setprio 1
    v_mfma_f32_32x32x16_bf16 v[84:99], v[52:55], v[46:49], 0
    v_exp_f32 v68, v68
    v_exp_f32 v69, v69
    v_exp_f32 v70, v70
    v_exp_f32 v71, v71
    v_exp_f32 v72, v72
    v_mfma_f32_32x32x8_bf16 v[84:99], v[56:57], v[50:51], v[84:99]
    ds_read_b128 v[52:55], v28 offset:3072
    s_mov_b64 exec, s[32:33]
    ds_read_b64 v[56:57], v59 offset:3072
    s_mov_b64 exec, -1
    v_cvt_pk_bf16_f32 v100, v68, v69
    v_cvt_pk_bf16_f32 v101, v70, v71
    v_exp_f32 v73, v73
    v_exp_f32 v74, v74
    v_exp_f32 v75, v75
    v_exp_f32 v76, v76
    v_mfma_f32_32x32x16_bf16 v[132:147], v[60:63], v[108:111], v[132:147]
    s_cmp_ge_u32 s3, 2
    s_cbranch_scc1 L_va_48
    s_mul_i32 s50, s47, 10240
    s_add_u32 s50, s50, s53
    s_add_u32 s50, s50, 5250560
    s_mov_b64 exec, s[34:35]
    buffer_load_dwordx4 v[240:243], v58, s[8:11], s50 offen sc1
    buffer_load_dwordx4 v[244:247], v58, s[8:11], s50 offen offset:640 sc1
    s_mov_b64 exec, -1

L_va_48:
    v_cvt_pk_bf16_f32 v102, v72, v73
    v_cvt_pk_bf16_f32 v103, v74, v75
    v_exp_f32 v77, v77
    v_exp_f32 v78, v78
    v_exp_f32 v79, v79
    v_exp_f32 v80, v80
    v_mfma_f32_32x32x16_bf16 v[132:147], v[64:67], v[112:115], v[132:147]
    s_mov_b64 exec, s[34:35]
    ds_read_b128 v[60:63], v29 offset:6400
    ds_read_b128 v[64:67], v29 offset:7040
    s_mov_b64 exec, -1
    v_cvt_pk_bf16_f32 v104, v76, v77
    v_cvt_pk_bf16_f32 v105, v78, v79
    v_exp_f32 v81, v81
    v_exp_f32 v82, v82
    v_exp_f32 v83, v83
    v_cvt_pk_bf16_f32 v106, v80, v81
    v_cvt_pk_bf16_f32 v107, v82, v83
    s_waitcnt lgkmcnt(2)
    v_mfma_f32_32x32x16_bf16 v[68:83], v[52:55], v[40:43], 0
    v_exp_f32 v84, v84
    v_exp_f32 v85, v85
    v_exp_f32 v86, v86
    v_exp_f32 v87, v87
    v_exp_f32 v88, v88
    v_mfma_f32_32x32x8_bf16 v[68:83], v[56:57], v[44:45], v[68:83]
    v_cvt_pk_bf16_f32 v108, v84, v85
    v_cvt_pk_bf16_f32 v109, v86, v87
    v_exp_f32 v89, v89
    v_exp_f32 v90, v90
    v_exp_f32 v91, v91
    v_exp_f32 v92, v92
    s_waitcnt lgkmcnt(0)
    v_mfma_f32_32x32x16_bf16 v[116:131], v[60:63], v[100:103], v[116:131]
    s_cmp_ge_u32 s3, 2
    s_cbranch_scc1 L_va_49
    s_mul_i32 s50, s47, 10240
    s_add_u32 s50, s50, s53
    s_add_u32 s50, s50, 5251840
    s_mov_b64 exec, s[34:35]
    buffer_load_dwordx4 v[248:251], v58, s[8:11], s50 offen sc1
    buffer_load_dwordx4 v[252:255], v58, s[8:11], s50 offen offset:640 sc1
    s_mov_b64 exec, -1

L_va_49:
    v_cvt_pk_bf16_f32 v110, v88, v89
    v_cvt_pk_bf16_f32 v111, v90, v91
    v_exp_f32 v93, v93
    v_exp_f32 v94, v94
    v_exp_f32 v95, v95
    v_exp_f32 v96, v96
    v_mfma_f32_32x32x16_bf16 v[116:131], v[64:67], v[104:107], v[116:131]
    v_cvt_pk_bf16_f32 v112, v92, v93
    v_cvt_pk_bf16_f32 v113, v94, v95
    v_exp_f32 v97, v97
    v_exp_f32 v98, v98
    v_exp_f32 v99, v99
    v_cvt_pk_bf16_f32 v114, v96, v97
    v_cvt_pk_bf16_f32 v115, v98, v99
    v_mfma_f32_32x32x16_bf16 v[84:99], v[52:55], v[46:49], 0
    v_exp_f32 v68, v68
    v_exp_f32 v69, v69
    v_exp_f32 v70, v70
    v_exp_f32 v71, v71
    v_exp_f32 v72, v72
    v_mfma_f32_32x32x8_bf16 v[84:99], v[56:57], v[50:51], v[84:99]
    ds_read_b128 v[52:55], v28 offset:3584
    s_mov_b64 exec, s[32:33]
    ds_read_b64 v[56:57], v59 offset:3584
    s_mov_b64 exec, -1
    v_cvt_pk_bf16_f32 v100, v68, v69
    v_cvt_pk_bf16_f32 v101, v70, v71
    v_exp_f32 v73, v73
    v_exp_f32 v74, v74
    v_exp_f32 v75, v75
    v_exp_f32 v76, v76
    v_mfma_f32_32x32x16_bf16 v[132:147], v[60:63], v[108:111], v[132:147]
    v_cvt_pk_bf16_f32 v102, v72, v73
    v_cvt_pk_bf16_f32 v103, v74, v75
    v_exp_f32 v77, v77
    v_exp_f32 v78, v78
    v_exp_f32 v79, v79
    v_exp_f32 v80, v80
    v_mfma_f32_32x32x16_bf16 v[132:147], v[64:67], v[112:115], v[132:147]
    s_mov_b64 exec, s[34:35]
    ds_read_b128 v[60:63], v29 offset:7680
    ds_read_b128 v[64:67], v29 offset:8320
    s_mov_b64 exec, -1
    v_cvt_pk_bf16_f32 v104, v76, v77
    v_cvt_pk_bf16_f32 v105, v78, v79
    v_exp_f32 v81, v81
    v_exp_f32 v82, v82
    v_exp_f32 v83, v83
    v_cvt_pk_bf16_f32 v106, v80, v81
    v_cvt_pk_bf16_f32 v107, v82, v83
    s_setprio 0
    s_waitcnt lgkmcnt(2)
    v_mfma_f32_32x32x16_bf16 v[68:83], v[52:55], v[40:43], 0
    v_exp_f32 v84, v84
    v_exp_f32 v85, v85
    v_exp_f32 v86, v86
    v_exp_f32 v87, v87
    v_exp_f32 v88, v88
    v_mfma_f32_32x32x8_bf16 v[68:83], v[56:57], v[44:45], v[68:83]
    v_cvt_pk_bf16_f32 v108, v84, v85
    v_cvt_pk_bf16_f32 v109, v86, v87
    v_exp_f32 v89, v89
    v_exp_f32 v90, v90
    v_exp_f32 v91, v91
    v_exp_f32 v92, v92
    s_waitcnt lgkmcnt(0)
    v_mfma_f32_32x32x16_bf16 v[116:131], v[60:63], v[100:103], v[116:131]
    v_cvt_pk_bf16_f32 v110, v88, v89
    v_cvt_pk_bf16_f32 v111, v90, v91
    v_exp_f32 v93, v93
    v_exp_f32 v94, v94
    v_exp_f32 v95, v95
    v_exp_f32 v96, v96
    v_mfma_f32_32x32x16_bf16 v[116:131], v[64:67], v[104:107], v[116:131]
    v_cvt_pk_bf16_f32 v112, v92, v93
    v_cvt_pk_bf16_f32 v113, v94, v95
    v_exp_f32 v97, v97
    v_exp_f32 v98, v98
    v_exp_f32 v99, v99
    v_cvt_pk_bf16_f32 v114, v96, v97
    v_cvt_pk_bf16_f32 v115, v98, v99
    v_mfma_f32_32x32x16_bf16 v[84:99], v[52:55], v[46:49], 0
    v_exp_f32 v68, v68
    v_exp_f32 v69, v69
    v_exp_f32 v70, v70
    v_exp_f32 v71, v71
    v_exp_f32 v72, v72
    v_mfma_f32_32x32x8_bf16 v[84:99], v[56:57], v[50:51], v[84:99]
    s_waitcnt vmcnt(0)
    s_barrier
    s_setprio 3
    v_add_u32 v28, 45056, v28
    v_add_u32 v59, 45056, v59
    ds_read_b128 v[52:55], v28 offset:0
    s_mov_b64 exec, s[32:33]
    ds_read_b64 v[56:57], v59 offset:0
    s_mov_b64 exec, -1
    v_cvt_pk_bf16_f32 v100, v68, v69
    v_cvt_pk_bf16_f32 v101, v70, v71
    v_exp_f32 v73, v73
    v_exp_f32 v74, v74
    v_exp_f32 v75, v75
    v_exp_f32 v76, v76
    v_mfma_f32_32x32x16_bf16 v[132:147], v[60:63], v[108:111], v[132:147]
    v_cvt_pk_bf16_f32 v102, v72, v73
    v_cvt_pk_bf16_f32 v103, v74, v75
    v_exp_f32 v77, v77
    v_exp_f32 v78, v78
    v_exp_f32 v79, v79
    v_exp_f32 v80, v80
    v_mfma_f32_32x32x16_bf16 v[132:147], v[64:67], v[112:115], v[132:147]
    s_mov_b64 exec, s[34:35]
    ds_read_b128 v[60:63], v29 offset:8960
    ds_read_b128 v[64:67], v29 offset:9600
    s_mov_b64 exec, -1
    v_cvt_pk_bf16_f32 v104, v76, v77
    v_cvt_pk_bf16_f32 v105, v78, v79
    v_exp_f32 v81, v81
    v_exp_f32 v82, v82
    v_exp_f32 v83, v83
    v_cvt_pk_bf16_f32 v106, v80, v81
    v_cvt_pk_bf16_f32 v107, v82, v83
    s_waitcnt lgkmcnt(2)
    v_mfma_f32_32x32x16_bf16 v[68:83], v[52:55], v[40:43], 0
    v_exp_f32 v84, v84
    v_exp_f32 v85, v85
    v_exp_f32 v86, v86
    v_exp_f32 v87, v87
    v_exp_f32 v88, v88
    v_mfma_f32_32x32x8_bf16 v[68:83], v[56:57], v[44:45], v[68:83]
    v_cvt_pk_bf16_f32 v108, v84, v85
    v_cvt_pk_bf16_f32 v109, v86, v87
    v_exp_f32 v89, v89
    v_exp_f32 v90, v90
    v_exp_f32 v91, v91
    v_exp_f32 v92, v92
    s_waitcnt lgkmcnt(0)
    v_mfma_f32_32x32x16_bf16 v[116:131], v[60:63], v[100:103], v[116:131]
    v_cvt_pk_bf16_f32 v110, v88, v89
    v_cvt_pk_bf16_f32 v111, v90, v91
    v_exp_f32 v93, v93
    v_exp_f32 v94, v94
    v_exp_f32 v95, v95
    v_exp_f32 v96, v96
    v_mfma_f32_32x32x16_bf16 v[116:131], v[64:67], v[104:107], v[116:131]
    v_cvt_pk_bf16_f32 v112, v92, v93
    v_cvt_pk_bf16_f32 v113, v94, v95
    v_exp_f32 v97, v97
    v_exp_f32 v98, v98
    v_exp_f32 v99, v99
    v_cvt_pk_bf16_f32 v114, v96, v97
    v_cvt_pk_bf16_f32 v115, v98, v99
    s_cmp_ge_u32 s3, 2
    s_cbranch_scc1 L_kv_50

    v_lshrrev_b32 v30, 2, v24
    v_and_b32 v30, 3, v30
    v_lshl_add_u32 v30, v26, 3, v30
    v_mul_u32_u24 v30, 48, v30
    v_and_b32 v31, 16, v24
    v_lshl_add_u32 v30, v31, 1, v30
    v_and_b32 v31, 3, v24
    v_lshl_add_u32 v30, v31, 3, v30
    s_mul_i32 s50, s3, 12288
    s_add_u32 s50, s50, 135168
    v_add_u32 v39, s50, v30

    ds_read_b64_tr_b16 v[176:177], v39 offset:0
    ds_read_b64_tr_b16 v[178:179], v39 offset:192
    ds_read_b64_tr_b16 v[180:181], v39 offset:768
    ds_read_b64_tr_b16 v[182:183], v39 offset:960
    ds_read_b64_tr_b16 v[184:185], v39 offset:1536
    ds_read_b64_tr_b16 v[186:187], v39 offset:1728
    ds_read_b64_tr_b16 v[188:189], v39 offset:2304
    ds_read_b64_tr_b16 v[190:191], v39 offset:2496
    s_waitcnt lgkmcnt(0)
    v_mfma_f32_32x32x16_bf16 v[160:175], v[176:179], v[192:195], 0
    v_mfma_f32_32x32x16_bf16 v[160:175], v[180:183], v[196:199], v[160:175]
    v_mfma_f32_32x32x16_bf16 v[160:175], v[184:187], v[200:203], v[160:175]
    v_mfma_f32_32x32x16_bf16 v[160:175], v[188:191], v[204:207], v[160:175]
    ds_read_b64_tr_b16 v[176:177], v39 offset:3072
    ds_read_b64_tr_b16 v[178:179], v39 offset:3264
    ds_read_b64_tr_b16 v[180:181], v39 offset:3840
    ds_read_b64_tr_b16 v[182:183], v39 offset:4032
    ds_read_b64_tr_b16 v[184:185], v39 offset:4608
    ds_read_b64_tr_b16 v[186:187], v39 offset:4800
    ds_read_b64_tr_b16 v[188:189], v39 offset:5376
    ds_read_b64_tr_b16 v[190:191], v39 offset:5568
    s_waitcnt lgkmcnt(0)
    v_mfma_f32_32x32x16_bf16 v[160:175], v[176:179], v[208:211], v[160:175]
    v_mfma_f32_32x32x16_bf16 v[160:175], v[180:183], v[212:215], v[160:175]
    v_mfma_f32_32x32x16_bf16 v[160:175], v[184:187], v[216:219], v[160:175]
    v_mfma_f32_32x32x16_bf16 v[160:175], v[188:191], v[220:223], v[160:175]
    ds_read_b64_tr_b16 v[176:177], v39 offset:6144
    ds_read_b64_tr_b16 v[178:179], v39 offset:6336
    ds_read_b64_tr_b16 v[180:181], v39 offset:6912
    ds_read_b64_tr_b16 v[182:183], v39 offset:7104
    ds_read_b64_tr_b16 v[184:185], v39 offset:7680
    ds_read_b64_tr_b16 v[186:187], v39 offset:7872
    ds_read_b64_tr_b16 v[188:189], v39 offset:8448
    ds_read_b64_tr_b16 v[190:191], v39 offset:8640
    s_waitcnt lgkmcnt(0)
    v_mfma_f32_32x32x16_bf16 v[160:175], v[176:179], v[224:227], v[160:175]
    v_mfma_f32_32x32x16_bf16 v[160:175], v[180:183], v[228:231], v[160:175]
    v_mfma_f32_32x32x16_bf16 v[160:175], v[184:187], v[232:235], v[160:175]
    v_mfma_f32_32x32x16_bf16 v[160:175], v[188:191], v[236:239], v[160:175]
    ds_read_b64_tr_b16 v[176:177], v39 offset:9216
    ds_read_b64_tr_b16 v[178:179], v39 offset:9408
    ds_read_b64_tr_b16 v[180:181], v39 offset:9984
    ds_read_b64_tr_b16 v[182:183], v39 offset:10176
    ds_read_b64_tr_b16 v[184:185], v39 offset:10752
    ds_read_b64_tr_b16 v[186:187], v39 offset:10944
    ds_read_b64_tr_b16 v[188:189], v39 offset:11520
    ds_read_b64_tr_b16 v[190:191], v39 offset:11712
    s_waitcnt lgkmcnt(0)
    v_mfma_f32_32x32x16_bf16 v[160:175], v[176:179], v[240:243], v[160:175]
    v_mfma_f32_32x32x16_bf16 v[160:175], v[180:183], v[244:247], v[160:175]
    v_mfma_f32_32x32x16_bf16 v[160:175], v[184:187], v[248:251], v[160:175]
    v_mfma_f32_32x32x16_bf16 v[160:175], v[188:191], v[252:255], v[160:175]
    s_lshl_b32 s50, s46, 3
    s_add_u32 s50, s50, s47
    s_lshl_b32 s50, s50, 1
    s_add_u32 s50, s50, s3
    s_mul_i32 s50, s50, 3072
    s_add_u32 s50, s50, 15736832
    s_nop 6

    buffer_store_dwordx4 v[160:163], v34, s[8:11], s50 offen offset:0 sc1
    buffer_store_dwordx4 v[164:167], v34, s[8:11], s50 offen offset:1024 sc1
    buffer_store_dwordx4 v[168:171], v34, s[8:11], s50 offen offset:2048 sc1
L_kv_50:
    v_add_u32 v29, 45056, v29
    v_mfma_f32_32x32x16_bf16 v[84:99], v[52:55], v[46:49], 0
    v_exp_f32 v68, v68
    v_exp_f32 v69, v69
    v_exp_f32 v70, v70
    v_exp_f32 v71, v71
    v_exp_f32 v72, v72
    v_mfma_f32_32x32x8_bf16 v[84:99], v[56:57], v[50:51], v[84:99]
    ds_read_b128 v[52:55], v28 offset:512
    s_mov_b64 exec, s[32:33]
    ds_read_b64 v[56:57], v59 offset:512
    s_mov_b64 exec, -1
    v_cvt_pk_bf16_f32 v100, v68, v69
    v_cvt_pk_bf16_f32 v101, v70, v71
    v_exp_f32 v73, v73
    v_exp_f32 v74, v74
    v_exp_f32 v75, v75
    v_exp_f32 v76, v76
    v_mfma_f32_32x32x16_bf16 v[132:147], v[60:63], v[108:111], v[132:147]
    v_cvt_pk_bf16_f32 v102, v72, v73
    v_cvt_pk_bf16_f32 v103, v74, v75
    v_exp_f32 v77, v77
    v_exp_f32 v78, v78
    v_exp_f32 v79, v79
    v_exp_f32 v80, v80
    v_mfma_f32_32x32x16_bf16 v[132:147], v[64:67], v[112:115], v[132:147]
    s_mov_b64 exec, s[34:35]
    ds_read_b128 v[60:63], v29 offset:0
    ds_read_b128 v[64:67], v29 offset:640
    s_mov_b64 exec, -1
    v_cvt_pk_bf16_f32 v104, v76, v77
    v_cvt_pk_bf16_f32 v105, v78, v79
    v_exp_f32 v81, v81
    v_exp_f32 v82, v82
    v_exp_f32 v83, v83
    v_cvt_pk_bf16_f32 v106, v80, v81
    v_cvt_pk_bf16_f32 v107, v82, v83
    s_waitcnt lgkmcnt(2)
    v_mfma_f32_32x32x16_bf16 v[68:83], v[52:55], v[40:43], 0
    v_exp_f32 v84, v84
    v_exp_f32 v85, v85
    v_exp_f32 v86, v86
    v_exp_f32 v87, v87
    v_exp_f32 v88, v88
    v_mfma_f32_32x32x8_bf16 v[68:83], v[56:57], v[44:45], v[68:83]
    v_cvt_pk_bf16_f32 v108, v84, v85
    v_cvt_pk_bf16_f32 v109, v86, v87
    v_exp_f32 v89, v89
    v_exp_f32 v90, v90
    v_exp_f32 v91, v91
    v_exp_f32 v92, v92
    s_waitcnt lgkmcnt(0)
    v_mfma_f32_32x32x16_bf16 v[116:131], v[60:63], v[100:103], v[116:131]
    v_cvt_pk_bf16_f32 v110, v88, v89
    v_cvt_pk_bf16_f32 v111, v90, v91
    v_exp_f32 v93, v93
    v_exp_f32 v94, v94
    v_exp_f32 v95, v95
    v_exp_f32 v96, v96
    v_mfma_f32_32x32x16_bf16 v[116:131], v[64:67], v[104:107], v[116:131]
    v_cvt_pk_bf16_f32 v112, v92, v93
    v_cvt_pk_bf16_f32 v113, v94, v95
    v_exp_f32 v97, v97
    v_exp_f32 v98, v98
    v_exp_f32 v99, v99
    v_cvt_pk_bf16_f32 v114, v96, v97
    v_cvt_pk_bf16_f32 v115, v98, v99
    v_mfma_f32_32x32x16_bf16 v[84:99], v[52:55], v[46:49], 0
    v_exp_f32 v68, v68
    v_exp_f32 v69, v69
    v_exp_f32 v70, v70
    v_exp_f32 v71, v71
    v_exp_f32 v72, v72
    v_mfma_f32_32x32x8_bf16 v[84:99], v[56:57], v[50:51], v[84:99]
    ds_read_b128 v[52:55], v28 offset:1024
    s_mov_b64 exec, s[32:33]
    ds_read_b64 v[56:57], v59 offset:1024
    s_mov_b64 exec, -1
    v_cvt_pk_bf16_f32 v100, v68, v69
    v_cvt_pk_bf16_f32 v101, v70, v71
    v_exp_f32 v73, v73
    v_exp_f32 v74, v74
    v_exp_f32 v75, v75
    v_exp_f32 v76, v76
    v_mfma_f32_32x32x16_bf16 v[132:147], v[60:63], v[108:111], v[132:147]
    v_cvt_pk_bf16_f32 v102, v72, v73
    v_cvt_pk_bf16_f32 v103, v74, v75
    v_exp_f32 v77, v77
    v_exp_f32 v78, v78
    v_exp_f32 v79, v79
    v_exp_f32 v80, v80
    v_mfma_f32_32x32x16_bf16 v[132:147], v[64:67], v[112:115], v[132:147]
    s_mov_b64 exec, s[34:35]
    ds_read_b128 v[60:63], v29 offset:1280
    ds_read_b128 v[64:67], v29 offset:1920
    s_mov_b64 exec, -1
    v_cvt_pk_bf16_f32 v104, v76, v77
    v_cvt_pk_bf16_f32 v105, v78, v79
    v_exp_f32 v81, v81
    v_exp_f32 v82, v82
    v_exp_f32 v83, v83
    v_cvt_pk_bf16_f32 v106, v80, v81
    v_cvt_pk_bf16_f32 v107, v82, v83
    s_waitcnt lgkmcnt(2)
    v_mfma_f32_32x32x16_bf16 v[68:83], v[52:55], v[40:43], 0
    v_exp_f32 v84, v84
    v_exp_f32 v85, v85
    v_exp_f32 v86, v86
    v_exp_f32 v87, v87
    v_exp_f32 v88, v88
    v_mfma_f32_32x32x8_bf16 v[68:83], v[56:57], v[44:45], v[68:83]
    v_cvt_pk_bf16_f32 v108, v84, v85
    v_cvt_pk_bf16_f32 v109, v86, v87
    v_exp_f32 v89, v89
    v_exp_f32 v90, v90
    v_exp_f32 v91, v91
    v_exp_f32 v92, v92
    s_waitcnt lgkmcnt(0)
    v_mfma_f32_32x32x16_bf16 v[116:131], v[60:63], v[100:103], v[116:131]
    s_cmp_ge_u32 s3, 2
    s_cbranch_scc1 L_fl_51
    s_waitcnt vmcnt(0)

    s_lshl_b32 s50, s46, 7
    v_mov_b32 v30, s50
    v_mov_b32 v31, 1
    s_mov_b64 exec, 1
    global_atomic_add v30, v31, s[16:17]
    s_mov_b64 exec, -1

L_fl_51:
    v_cvt_pk_bf16_f32 v110, v88, v89
    v_cvt_pk_bf16_f32 v111, v90, v91
    v_exp_f32 v93, v93
    v_exp_f32 v94, v94
    v_exp_f32 v95, v95
    v_exp_f32 v96, v96
    v_mfma_f32_32x32x16_bf16 v[116:131], v[64:67], v[104:107], v[116:131]
    v_cvt_pk_bf16_f32 v112, v92, v93
    v_cvt_pk_bf16_f32 v113, v94, v95
    v_exp_f32 v97, v97
    v_exp_f32 v98, v98
    v_exp_f32 v99, v99
    v_cvt_pk_bf16_f32 v114, v96, v97
    v_cvt_pk_bf16_f32 v115, v98, v99
    v_mfma_f32_32x32x16_bf16 v[84:99], v[52:55], v[46:49], 0
    v_exp_f32 v68, v68
    v_exp_f32 v69, v69
    v_exp_f32 v70, v70
    v_exp_f32 v71, v71
    v_exp_f32 v72, v72
    v_mfma_f32_32x32x8_bf16 v[84:99], v[56:57], v[50:51], v[84:99]
    ds_read_b128 v[52:55], v28 offset:1536
    s_mov_b64 exec, s[32:33]
    ds_read_b64 v[56:57], v59 offset:1536
    s_mov_b64 exec, -1
    v_cvt_pk_bf16_f32 v100, v68, v69
    v_cvt_pk_bf16_f32 v101, v70, v71
    v_exp_f32 v73, v73
    v_exp_f32 v74, v74
    v_exp_f32 v75, v75
    v_exp_f32 v76, v76
    v_mfma_f32_32x32x16_bf16 v[132:147], v[60:63], v[108:111], v[132:147]
    s_add_u32 m0, s52, 0
    s_nop 0
    buffer_load_dwordx4 v34, s[8:11], s40 offen sc1 lds
    s_add_u32 s40, s40, 4096
    v_cvt_pk_bf16_f32 v102, v72, v73
    v_cvt_pk_bf16_f32 v103, v74, v75
    v_exp_f32 v77, v77
    v_exp_f32 v78, v78
    v_exp_f32 v79, v79
    v_exp_f32 v80, v80
    v_mfma_f32_32x32x16_bf16 v[132:147], v[64:67], v[112:115], v[132:147]
    s_mov_b64 exec, s[34:35]
    ds_read_b128 v[60:63], v29 offset:2560
    ds_read_b128 v[64:67], v29 offset:3200
    s_mov_b64 exec, -1
    v_cvt_pk_bf16_f32 v104, v76, v77
    v_cvt_pk_bf16_f32 v105, v78, v79
    v_exp_f32 v81, v81
    v_exp_f32 v82, v82
    v_exp_f32 v83, v83
    v_cvt_pk_bf16_f32 v106, v80, v81
    v_cvt_pk_bf16_f32 v107, v82, v83
    s_waitcnt lgkmcnt(2)
    v_mfma_f32_32x32x16_bf16 v[68:83], v[52:55], v[40:43], 0
    v_exp_f32 v84, v84
    v_exp_f32 v85, v85
    v_exp_f32 v86, v86
    v_exp_f32 v87, v87
    v_exp_f32 v88, v88
    v_mfma_f32_32x32x8_bf16 v[68:83], v[56:57], v[44:45], v[68:83]
    v_cvt_pk_bf16_f32 v108, v84, v85
    v_cvt_pk_bf16_f32 v109, v86, v87
    v_exp_f32 v89, v89
    v_exp_f32 v90, v90
    v_exp_f32 v91, v91
    v_exp_f32 v92, v92
    s_waitcnt lgkmcnt(0)
    v_mfma_f32_32x32x16_bf16 v[116:131], v[60:63], v[100:103], v[116:131]
    s_add_u32 m0, s52, 4096
    s_nop 0
    buffer_load_dwordx4 v34, s[8:11], s41 offen sc1 lds
    s_add_u32 s41, s41, 4096
    v_cvt_pk_bf16_f32 v110, v88, v89
    v_cvt_pk_bf16_f32 v111, v90, v91
    v_exp_f32 v93, v93
    v_exp_f32 v94, v94
    v_exp_f32 v95, v95
    v_exp_f32 v96, v96
    v_mfma_f32_32x32x16_bf16 v[116:131], v[64:67], v[104:107], v[116:131]
    v_cvt_pk_bf16_f32 v112, v92, v93
    v_cvt_pk_bf16_f32 v113, v94, v95
    v_exp_f32 v97, v97
    v_exp_f32 v98, v98
    v_exp_f32 v99, v99
    v_cvt_pk_bf16_f32 v114, v96, v97
    v_cvt_pk_bf16_f32 v115, v98, v99
    s_setprio 2
    v_mfma_f32_32x32x16_bf16 v[84:99], v[52:55], v[46:49], 0
    v_exp_f32 v68, v68
    v_exp_f32 v69, v69
    v_exp_f32 v70, v70
    v_exp_f32 v71, v71
    v_exp_f32 v72, v72
    v_mfma_f32_32x32x8_bf16 v[84:99], v[56:57], v[50:51], v[84:99]
    ds_read_b128 v[52:55], v28 offset:2048
    s_mov_b64 exec, s[32:33]
    ds_read_b64 v[56:57], v59 offset:2048
    s_mov_b64 exec, -1
    v_cvt_pk_bf16_f32 v100, v68, v69
    v_cvt_pk_bf16_f32 v101, v70, v71
    v_exp_f32 v73, v73
    v_exp_f32 v74, v74
    v_exp_f32 v75, v75
    v_exp_f32 v76, v76
    v_mfma_f32_32x32x16_bf16 v[132:147], v[60:63], v[108:111], v[132:147]
    s_add_u32 m0, s52, 8192
    s_nop 0
    buffer_load_dwordx4 v34, s[8:11], s42 offen sc1 lds
    s_add_u32 s42, s42, 4096
    v_cvt_pk_bf16_f32 v102, v72, v73
    v_cvt_pk_bf16_f32 v103, v74, v75
    v_exp_f32 v77, v77
    v_exp_f32 v78, v78
    v_exp_f32 v79, v79
    v_exp_f32 v80, v80
    v_mfma_f32_32x32x16_bf16 v[132:147], v[64:67], v[112:115], v[132:147]
    s_mov_b64 exec, s[34:35]
    ds_read_b128 v[60:63], v29 offset:3840
    ds_read_b128 v[64:67], v29 offset:4480
    s_mov_b64 exec, -1
    v_cvt_pk_bf16_f32 v104, v76, v77
    v_cvt_pk_bf16_f32 v105, v78, v79
    v_exp_f32 v81, v81
    v_exp_f32 v82, v82
    v_exp_f32 v83, v83
    v_cvt_pk_bf16_f32 v106, v80, v81
    v_cvt_pk_bf16_f32 v107, v82, v83
    s_waitcnt lgkmcnt(2)
    v_mfma_f32_32x32x16_bf16 v[68:83], v[52:55], v[40:43], 0
    v_exp_f32 v84, v84
    v_exp_f32 v85, v85
    v_exp_f32 v86, v86
    v_exp_f32 v87, v87
    v_exp_f32 v88, v88
    v_mfma_f32_32x32x8_bf16 v[68:83], v[56:57], v[44:45], v[68:83]
    v_cvt_pk_bf16_f32 v108, v84, v85
    v_cvt_pk_bf16_f32 v109, v86, v87
    v_exp_f32 v89, v89
    v_exp_f32 v90, v90
    v_exp_f32 v91, v91
    v_exp_f32 v92, v92
    s_waitcnt lgkmcnt(0)
    v_mfma_f32_32x32x16_bf16 v[116:131], v[60:63], v[100:103], v[116:131]
    s_add_u32 m0, s52, 12288
    s_nop 0
    buffer_load_dwordx4 v34, s[8:11], s43 offen sc1 lds
    s_add_u32 s43, s43, 10240
    v_cvt_pk_bf16_f32 v110, v88, v89
    v_cvt_pk_bf16_f32 v111, v90, v91
    v_exp_f32 v93, v93
    v_exp_f32 v94, v94
    v_exp_f32 v95, v95
    v_exp_f32 v96, v96
    v_mfma_f32_32x32x16_bf16 v[116:131], v[64:67], v[104:107], v[116:131]
    v_cvt_pk_bf16_f32 v112, v92, v93
    v_cvt_pk_bf16_f32 v113, v94, v95
    v_exp_f32 v97, v97
    v_exp_f32 v98, v98
    v_exp_f32 v99, v99
    v_cvt_pk_bf16_f32 v114, v96, v97
    v_cvt_pk_bf16_f32 v115, v98, v99
    v_mfma_f32_32x32x16_bf16 v[160:175], v[2:5], v[14:17], 0
    v_mfma_f32_32x32x8_bf16 v[160:175], v[6:7], v[18:19], v[160:175]
    s_nop 11
    v_max3_f32 v30, v160, v161, v162
    v_min3_f32 v31, v160, v161, v162
    v_max3_f32 v30, v30, v163, v164
    v_min3_f32 v31, v31, v163, v164
    v_max3_f32 v30, v30, v165, v166
    v_min3_f32 v31, v31, v165, v166
    v_max3_f32 v30, v30, v167, v168
    v_min3_f32 v31, v31, v167, v168
    v_max_f32 v30, v30, v169
    v_min_f32 v31, v31, v169
    v_mov_b32 v32, v30
    v_mov_b32 v33, v31
    s_nop 1
    v_permlane32_swap_b32 v30, v32
    v_permlane32_swap_b32 v31, v33
    s_nop 0
    v_max_f32 v30, v30, v32
    v_min_f32 v31, v31, v33
    v_pk_add_f32 v[176:177], v[160:161], v[30:31] op_sel:[0,0] op_sel_hi:[1,0] neg_lo:[0,1] neg_hi:[0,1]
    v_pk_add_f32 v[186:187], v[160:161], v[30:31] op_sel:[0,1] op_sel_hi:[1,1] neg_lo:[1,0] neg_hi:[1,0]
    v_pk_add_f32 v[178:179], v[162:163], v[30:31] op_sel:[0,0] op_sel_hi:[1,0] neg_lo:[0,1] neg_hi:[0,1]
    v_pk_add_f32 v[188:189], v[162:163], v[30:31] op_sel:[0,1] op_sel_hi:[1,1] neg_lo:[1,0] neg_hi:[1,0]
    v_pk_add_f32 v[180:181], v[164:165], v[30:31] op_sel:[0,0] op_sel_hi:[1,0] neg_lo:[0,1] neg_hi:[0,1]
    v_pk_add_f32 v[190:191], v[164:165], v[30:31] op_sel:[0,1] op_sel_hi:[1,1] neg_lo:[1,0] neg_hi:[1,0]
    v_pk_add_f32 v[182:183], v[166:167], v[30:31] op_sel:[0,0] op_sel_hi:[1,0] neg_lo:[0,1] neg_hi:[0,1]
    v_pk_add_f32 v[20:21], v[166:167], v[30:31] op_sel:[0,1] op_sel_hi:[1,1] neg_lo:[1,0] neg_hi:[1,0]
    v_pk_add_f32 v[184:185], v[168:169], v[30:31] op_sel:[0,0] op_sel_hi:[1,0] neg_lo:[0,1] neg_hi:[0,1]
    v_pk_add_f32 v[22:23], v[168:169], v[30:31] op_sel:[0,1] op_sel_hi:[1,1] neg_lo:[1,0] neg_hi:[1,0]
    v_exp_f32 v176, v176
    v_exp_f32 v186, v186
    v_exp_f32 v177, v177
    v_exp_f32 v187, v187
    v_exp_f32 v178, v178
    v_exp_f32 v188, v188
    v_exp_f32 v179, v179
    v_exp_f32 v189, v189
    v_exp_f32 v180, v180
    v_exp_f32 v190, v190
    v_exp_f32 v181, v181
    v_exp_f32 v191, v191
    v_exp_f32 v182, v182
    v_exp_f32 v20, v20
    v_exp_f32 v183, v183
    v_exp_f32 v21, v21
    v_exp_f32 v184, v184
    v_exp_f32 v22, v22
    v_exp_f32 v185, v185
    v_exp_f32 v23, v23
    s_nop 0
    v_cvt_pk_bf16_f32 v148, v176, v177
    v_cvt_pk_bf16_f32 v154, v186, v187
    v_cvt_pk_bf16_f32 v149, v178, v179
    v_cvt_pk_bf16_f32 v155, v188, v189
    v_cvt_pk_bf16_f32 v150, v180, v181
    v_cvt_pk_bf16_f32 v156, v190, v191
    v_cvt_pk_bf16_f32 v151, v182, v183
    v_cvt_pk_bf16_f32 v157, v20, v21
    v_cvt_pk_bf16_f32 v152, v184, v185
    v_cvt_pk_bf16_f32 v158, v22, v23
    v_mfma_f32_32x32x16_bf16 v[84:99], v[52:55], v[46:49], 0
    v_exp_f32 v68, v68
    v_exp_f32 v69, v69
    v_exp_f32 v70, v70
    v_exp_f32 v71, v71
    v_exp_f32 v72, v72
    v_mfma_f32_32x32x8_bf16 v[84:99], v[56:57], v[50:51], v[84:99]
    ds_read_b128 v[52:55], v28 offset:2560
    s_mov_b64 exec, s[32:33]
    ds_read_b64 v[56:57], v59 offset:2560
    s_mov_b64 exec, -1
    v_cvt_pk_bf16_f32 v100, v68, v69
    v_cvt_pk_bf16_f32 v101, v70, v71
    v_exp_f32 v73, v73
    v_exp_f32 v74, v74
    v_exp_f32 v75, v75
    v_exp_f32 v76, v76
    v_mfma_f32_32x32x16_bf16 v[132:147], v[60:63], v[108:111], v[132:147]
    s_add_u32 m0, s52, 16384
    s_nop 0
    buffer_load_dwordx4 v34, s[8:11], s44 offen sc1 lds
    s_add_u32 s44, s44, 10240
    v_cvt_pk_bf16_f32 v102, v72, v73
    v_cvt_pk_bf16_f32 v103, v74, v75
    v_exp_f32 v77, v77
    v_exp_f32 v78, v78
    v_exp_f32 v79, v79
    v_exp_f32 v80, v80
    v_mfma_f32_32x32x16_bf16 v[132:147], v[64:67], v[112:115], v[132:147]
    s_mov_b64 exec, s[34:35]
    ds_read_b128 v[60:63], v29 offset:5120
    ds_read_b128 v[64:67], v29 offset:5760
    s_mov_b64 exec, -1
    v_cvt_pk_bf16_f32 v104, v76, v77
    v_cvt_pk_bf16_f32 v105, v78, v79
    v_exp_f32 v81, v81
    v_exp_f32 v82, v82
    v_exp_f32 v83, v83
    v_cvt_pk_bf16_f32 v106, v80, v81
    v_cvt_pk_bf16_f32 v107, v82, v83
    s_waitcnt lgkmcnt(2)
    v_mfma_f32_32x32x16_bf16 v[68:83], v[52:55], v[40:43], 0
    v_exp_f32 v84, v84
    v_exp_f32 v85, v85
    v_exp_f32 v86, v86
    v_exp_f32 v87, v87
    v_exp_f32 v88, v88
    v_mfma_f32_32x32x8_bf16 v[68:83], v[56:57], v[44:45], v[68:83]
    v_cvt_pk_bf16_f32 v108, v84, v85
    v_cvt_pk_bf16_f32 v109, v86, v87
    v_exp_f32 v89, v89
    v_exp_f32 v90, v90
    v_exp_f32 v91, v91
    v_exp_f32 v92, v92
    s_waitcnt lgkmcnt(0)
    v_mfma_f32_32x32x16_bf16 v[116:131], v[60:63], v[100:103], v[116:131]
    s_add_u32 m0, s59, 20480
    s_nop 0
    buffer_load_dwordx4 v34, s[8:11], s45 offen sc1 lds
    s_add_u32 s45, s45, 10240
    v_cvt_pk_bf16_f32 v110, v88, v89
    v_cvt_pk_bf16_f32 v111, v90, v91
    v_exp_f32 v93, v93
    v_exp_f32 v94, v94
    v_exp_f32 v95, v95
    v_exp_f32 v96, v96
    v_mfma_f32_32x32x16_bf16 v[116:131], v[64:67], v[104:107], v[116:131]
    v_cvt_pk_bf16_f32 v112, v92, v93
    v_cvt_pk_bf16_f32 v113, v94, v95
    v_exp_f32 v97, v97
    v_exp_f32 v98, v98
    v_exp_f32 v99, v99
    v_cvt_pk_bf16_f32 v114, v96, v97
    v_cvt_pk_bf16_f32 v115, v98, v99
    s_setprio 1
    v_mfma_f32_32x32x16_bf16 v[84:99], v[52:55], v[46:49], 0
    v_exp_f32 v68, v68
    v_exp_f32 v69, v69
    v_exp_f32 v70, v70
    v_exp_f32 v71, v71
    v_exp_f32 v72, v72
    v_mfma_f32_32x32x8_bf16 v[84:99], v[56:57], v[50:51], v[84:99]
    ds_read_b128 v[52:55], v28 offset:3072
    s_mov_b64 exec, s[32:33]
    ds_read_b64 v[56:57], v59 offset:3072
    s_mov_b64 exec, -1
    v_cvt_pk_bf16_f32 v100, v68, v69
    v_cvt_pk_bf16_f32 v101, v70, v71
    v_exp_f32 v73, v73
    v_exp_f32 v74, v74
    v_exp_f32 v75, v75
    v_exp_f32 v76, v76
    v_mfma_f32_32x32x16_bf16 v[132:147], v[60:63], v[108:111], v[132:147]
    v_cvt_pk_bf16_f32 v102, v72, v73
    v_cvt_pk_bf16_f32 v103, v74, v75
    v_exp_f32 v77, v77
    v_exp_f32 v78, v78
    v_exp_f32 v79, v79
    v_exp_f32 v80, v80
    v_mfma_f32_32x32x16_bf16 v[132:147], v[64:67], v[112:115], v[132:147]
    s_mov_b64 exec, s[34:35]
    ds_read_b128 v[60:63], v29 offset:6400
    ds_read_b128 v[64:67], v29 offset:7040
    s_mov_b64 exec, -1
    v_cvt_pk_bf16_f32 v104, v76, v77
    v_cvt_pk_bf16_f32 v105, v78, v79
    v_exp_f32 v81, v81
    v_exp_f32 v82, v82
    v_exp_f32 v83, v83
    v_cvt_pk_bf16_f32 v106, v80, v81
    v_cvt_pk_bf16_f32 v107, v82, v83
    s_waitcnt lgkmcnt(2)
    v_mfma_f32_32x32x16_bf16 v[68:83], v[52:55], v[40:43], 0
    v_exp_f32 v84, v84
    v_exp_f32 v85, v85
    v_exp_f32 v86, v86
    v_exp_f32 v87, v87
    v_exp_f32 v88, v88
    v_mfma_f32_32x32x8_bf16 v[68:83], v[56:57], v[44:45], v[68:83]
    v_cvt_pk_bf16_f32 v108, v84, v85
    v_cvt_pk_bf16_f32 v109, v86, v87
    v_exp_f32 v89, v89
    v_exp_f32 v90, v90
    v_exp_f32 v91, v91
    v_exp_f32 v92, v92
    s_waitcnt lgkmcnt(0)
    v_mfma_f32_32x32x16_bf16 v[116:131], v[60:63], v[100:103], v[116:131]
    s_cmp_eq_u32 s3, 0
    s_cbranch_scc0 L_w0_52
    s_lshl_b32 s50, s46, 7
    v_mov_b32 v30, s50
    s_mov_b64 exec, 1
    global_load_dword v37, v30, s[16:17] sc1
    s_mov_b64 exec, -1
L_w0_52:
    v_cvt_pk_bf16_f32 v110, v88, v89
    v_cvt_pk_bf16_f32 v111, v90, v91
    v_exp_f32 v93, v93
    v_exp_f32 v94, v94
    v_exp_f32 v95, v95
    v_exp_f32 v96, v96
    v_mfma_f32_32x32x16_bf16 v[116:131], v[64:67], v[104:107], v[116:131]
    v_cvt_pk_bf16_f32 v112, v92, v93
    v_cvt_pk_bf16_f32 v113, v94, v95
    v_exp_f32 v97, v97
    v_exp_f32 v98, v98
    v_exp_f32 v99, v99
    v_cvt_pk_bf16_f32 v114, v96, v97
    v_cvt_pk_bf16_f32 v115, v98, v99
    v_mfma_f32_32x32x16_bf16 v[84:99], v[52:55], v[46:49], 0
    v_exp_f32 v68, v68
    v_exp_f32 v69, v69
    v_exp_f32 v70, v70
    v_exp_f32 v71, v71
    v_exp_f32 v72, v72
    v_mfma_f32_32x32x8_bf16 v[84:99], v[56:57], v[50:51], v[84:99]
    ds_read_b128 v[52:55], v28 offset:3584
    s_mov_b64 exec, s[32:33]
    ds_read_b64 v[56:57], v59 offset:3584
    s_mov_b64 exec, -1
    v_cvt_pk_bf16_f32 v100, v68, v69
    v_cvt_pk_bf16_f32 v101, v70, v71
    v_exp_f32 v73, v73
    v_exp_f32 v74, v74
    v_exp_f32 v75, v75
    v_exp_f32 v76, v76
    v_mfma_f32_32x32x16_bf16 v[132:147], v[60:63], v[108:111], v[132:147]
    v_cvt_pk_bf16_f32 v102, v72, v73
    v_cvt_pk_bf16_f32 v103, v74, v75
    v_exp_f32 v77, v77
    v_exp_f32 v78, v78
    v_exp_f32 v79, v79
    v_exp_f32 v80, v80
    v_mfma_f32_32x32x16_bf16 v[132:147], v[64:67], v[112:115], v[132:147]
    s_mov_b64 exec, s[34:35]
    ds_read_b128 v[60:63], v29 offset:7680
    ds_read_b128 v[64:67], v29 offset:8320
    s_mov_b64 exec, -1
    v_cvt_pk_bf16_f32 v104, v76, v77
    v_cvt_pk_bf16_f32 v105, v78, v79
    v_exp_f32 v81, v81
    v_exp_f32 v82, v82
    v_exp_f32 v83, v83
    v_cvt_pk_bf16_f32 v106, v80, v81
    v_cvt_pk_bf16_f32 v107, v82, v83
    s_setprio 0
    s_waitcnt lgkmcnt(2)
    v_mfma_f32_32x32x16_bf16 v[68:83], v[52:55], v[40:43], 0
    v_exp_f32 v84, v84
    v_exp_f32 v85, v85
    v_exp_f32 v86, v86
    v_exp_f32 v87, v87
    v_exp_f32 v88, v88
    v_mfma_f32_32x32x8_bf16 v[68:83], v[56:57], v[44:45], v[68:83]
    v_cvt_pk_bf16_f32 v108, v84, v85
    v_cvt_pk_bf16_f32 v109, v86, v87
    v_exp_f32 v89, v89
    v_exp_f32 v90, v90
    v_exp_f32 v91, v91
    v_exp_f32 v92, v92
    s_waitcnt lgkmcnt(0)
    v_mfma_f32_32x32x16_bf16 v[116:131], v[60:63], v[100:103], v[116:131]
    v_cvt_pk_bf16_f32 v110, v88, v89
    v_cvt_pk_bf16_f32 v111, v90, v91
    v_exp_f32 v93, v93
    v_exp_f32 v94, v94
    v_exp_f32 v95, v95
    v_exp_f32 v96, v96
    v_mfma_f32_32x32x16_bf16 v[116:131], v[64:67], v[104:107], v[116:131]
    v_cvt_pk_bf16_f32 v112, v92, v93
    v_cvt_pk_bf16_f32 v113, v94, v95
    v_exp_f32 v97, v97
    v_exp_f32 v98, v98
    v_exp_f32 v99, v99
    v_cvt_pk_bf16_f32 v114, v96, v97
    v_cvt_pk_bf16_f32 v115, v98, v99
    v_mfma_f32_32x32x16_bf16 v[84:99], v[52:55], v[46:49], 0
    v_exp_f32 v68, v68
    v_exp_f32 v69, v69
    v_exp_f32 v70, v70
    v_exp_f32 v71, v71
    v_exp_f32 v72, v72
    v_mfma_f32_32x32x8_bf16 v[84:99], v[56:57], v[50:51], v[84:99]
    s_waitcnt vmcnt(0)
    s_cmp_eq_u32 s3, 0
    s_cbranch_scc0 L_w0_55
L_pl_56:
    v_cmp_le_u32 vcc, 16, v37
    s_nop 1
    s_and_b32 s50, vcc_lo, 1
    s_cmp_eq_u32 s50, 1
    s_cbranch_scc1 L_pd_57

    s_sleep 4
    s_lshl_b32 s50, s46, 7
    v_mov_b32 v30, s50
    s_mov_b64 exec, 1
    global_load_dword v37, v30, s[16:17] sc1
    s_mov_b64 exec, -1
    s_waitcnt vmcnt(0)
    s_branch L_pl_56
L_pd_57:
L_w0_55:
    s_barrier
    s_setprio 3
    v_add_u32 v28, 4294877184, v28
    v_add_u32 v59, 4294877184, v59
    ds_read_b128 v[52:55], v28 offset:0
    s_mov_b64 exec, s[32:33]
    ds_read_b64 v[56:57], v59 offset:0
    s_mov_b64 exec, -1
    v_cvt_pk_bf16_f32 v100, v68, v69
    v_cvt_pk_bf16_f32 v101, v70, v71
    v_exp_f32 v73, v73
    v_exp_f32 v74, v74
    v_exp_f32 v75, v75
    v_exp_f32 v76, v76
    v_mfma_f32_32x32x16_bf16 v[132:147], v[60:63], v[108:111], v[132:147]
    v_cvt_pk_bf16_f32 v102, v72, v73
    v_cvt_pk_bf16_f32 v103, v74, v75
    v_exp_f32 v77, v77
    v_exp_f32 v78, v78
    v_exp_f32 v79, v79
    v_exp_f32 v80, v80
    v_mfma_f32_32x32x16_bf16 v[132:147], v[64:67], v[112:115], v[132:147]
    s_mov_b64 exec, s[34:35]
    ds_read_b128 v[60:63], v29 offset:8960
    ds_read_b128 v[64:67], v29 offset:9600
    s_mov_b64 exec, -1
    v_cvt_pk_bf16_f32 v104, v76, v77
    v_cvt_pk_bf16_f32 v105, v78, v79
    v_exp_f32 v81, v81
    v_exp_f32 v82, v82
    v_exp_f32 v83, v83
    v_cvt_pk_bf16_f32 v106, v80, v81
    v_cvt_pk_bf16_f32 v107, v82, v83
    s_waitcnt lgkmcnt(2)
    v_mfma_f32_32x32x16_bf16 v[68:83], v[52:55], v[40:43], 0
    v_exp_f32 v84, v84
    v_exp_f32 v85, v85
    v_exp_f32 v86, v86
    v_exp_f32 v87, v87
    v_exp_f32 v88, v88
    v_mfma_f32_32x32x8_bf16 v[68:83], v[56:57], v[44:45], v[68:83]
    v_cvt_pk_bf16_f32 v108, v84, v85
    v_cvt_pk_bf16_f32 v109, v86, v87
    v_exp_f32 v89, v89
    v_exp_f32 v90, v90
    v_exp_f32 v91, v91
    v_exp_f32 v92, v92
    s_waitcnt lgkmcnt(0)
    v_mfma_f32_32x32x16_bf16 v[116:131], v[60:63], v[100:103], v[116:131]
    s_cmp_lt_u32 s3, 6
    s_cbranch_scc0 L_kl_58
    s_mul_i32 s50, s46, 49152
    s_add_u32 s50, s50, s29
    s_add_u32 s50, s50, 15736832
    buffer_load_dwordx4 v[160:163], v34, s[8:11], s50 offen sc1
    s_add_u32 s50, s50, 6144
    buffer_load_dwordx4 v[164:167], v34, s[8:11], s50 offen sc1

L_kl_58:
    v_cvt_pk_bf16_f32 v110, v88, v89
    v_cvt_pk_bf16_f32 v111, v90, v91
    v_exp_f32 v93, v93
    v_exp_f32 v94, v94
    v_exp_f32 v95, v95
    v_exp_f32 v96, v96
    v_mfma_f32_32x32x16_bf16 v[116:131], v[64:67], v[104:107], v[116:131]
    v_cvt_pk_bf16_f32 v112, v92, v93
    v_cvt_pk_bf16_f32 v113, v94, v95
    v_exp_f32 v97, v97
    v_exp_f32 v98, v98
    v_exp_f32 v99, v99
    v_cvt_pk_bf16_f32 v114, v96, v97
    v_cvt_pk_bf16_f32 v115, v98, v99
    v_add_u32 v29, 4294877184, v29
    v_mfma_f32_32x32x16_bf16 v[84:99], v[52:55], v[46:49], 0
    v_exp_f32 v68, v68
    v_exp_f32 v69, v69
    v_exp_f32 v70, v70
    v_exp_f32 v71, v71
    v_exp_f32 v72, v72
    v_mfma_f32_32x32x8_bf16 v[84:99], v[56:57], v[50:51], v[84:99]
    ds_read_b128 v[52:55], v28 offset:512
    s_mov_b64 exec, s[32:33]
    ds_read_b64 v[56:57], v59 offset:512
    s_mov_b64 exec, -1
    v_cvt_pk_bf16_f32 v100, v68, v69
    v_cvt_pk_bf16_f32 v101, v70, v71
    v_exp_f32 v73, v73
    v_exp_f32 v74, v74
    v_exp_f32 v75, v75
    v_exp_f32 v76, v76
    v_mfma_f32_32x32x16_bf16 v[132:147], v[60:63], v[108:111], v[132:147]
    s_cmp_lt_u32 s3, 6
    s_cbranch_scc0 L_kl_59
    s_mul_i32 s50, s46, 49152
    s_add_u32 s50, s50, s29
    s_add_u32 s50, s50, 15749120
    buffer_load_dwordx4 v[168:171], v34, s[8:11], s50 offen sc1
    s_add_u32 s50, s50, 6144
    buffer_load_dwordx4 v[172:175], v34, s[8:11], s50 offen sc1

L_kl_59:
    s_add_u32 m0, s29, 49152
    s_add_u32 s50, s21, s29
    s_add_u32 s50, s50, 163840
    buffer_load_dwordx4 v34, s[8:11], s50 offen sc1 lds
    v_cvt_pk_bf16_f32 v102, v72, v73
    v_cvt_pk_bf16_f32 v103, v74, v75
    v_exp_f32 v77, v77
    v_exp_f32 v78, v78
    v_exp_f32 v79, v79
    v_exp_f32 v80, v80
    v_mfma_f32_32x32x16_bf16 v[132:147], v[64:67], v[112:115], v[132:147]
    s_mov_b64 exec, s[34:35]
    ds_read_b128 v[60:63], v29 offset:0
    ds_read_b128 v[64:67], v29 offset:640
    s_mov_b64 exec, -1
    v_cvt_pk_bf16_f32 v104, v76, v77
    v_cvt_pk_bf16_f32 v105, v78, v79
    v_exp_f32 v81, v81
    v_exp_f32 v82, v82
    v_exp_f32 v83, v83
    v_cvt_pk_bf16_f32 v106, v80, v81
    v_cvt_pk_bf16_f32 v107, v82, v83
    s_waitcnt lgkmcnt(2)
    v_mfma_f32_32x32x16_bf16 v[68:83], v[52:55], v[40:43], 0
    v_exp_f32 v84, v84
    v_exp_f32 v85, v85
    v_exp_f32 v86, v86
    v_exp_f32 v87, v87
    v_exp_f32 v88, v88
    v_mfma_f32_32x32x8_bf16 v[68:83], v[56:57], v[44:45], v[68:83]
    v_cvt_pk_bf16_f32 v108, v84, v85
    v_cvt_pk_bf16_f32 v109, v86, v87
    v_exp_f32 v89, v89
    v_exp_f32 v90, v90
    v_exp_f32 v91, v91
    v_exp_f32 v92, v92
    s_waitcnt lgkmcnt(0)
    v_mfma_f32_32x32x16_bf16 v[116:131], v[60:63], v[100:103], v[116:131]
    s_cmp_lt_u32 s3, 6
    s_cbranch_scc0 L_kl_60
    s_mul_i32 s50, s46, 49152
    s_add_u32 s50, s50, s29
    s_add_u32 s50, s50, 15761408
    buffer_load_dwordx4 v[176:179], v34, s[8:11], s50 offen sc1
    s_add_u32 s50, s50, 6144
    buffer_load_dwordx4 v[180:183], v34, s[8:11], s50 offen sc1

L_kl_60:
    s_add_u32 m0, s29, 57344
    s_add_u32 s50, s21, s29
    s_add_u32 s50, s50, 172032
    buffer_load_dwordx4 v34, s[8:11], s50 offen sc1 lds
    v_cvt_pk_bf16_f32 v110, v88, v89
    v_cvt_pk_bf16_f32 v111, v90, v91
    v_exp_f32 v93, v93
    v_exp_f32 v94, v94
    v_exp_f32 v95, v95
    v_exp_f32 v96, v96
    v_mfma_f32_32x32x16_bf16 v[116:131], v[64:67], v[104:107], v[116:131]
    v_cvt_pk_bf16_f32 v112, v92, v93
    v_cvt_pk_bf16_f32 v113, v94, v95
    v_exp_f32 v97, v97
    v_exp_f32 v98, v98
    v_exp_f32 v99, v99
    v_cvt_pk_bf16_f32 v114, v96, v97
    v_cvt_pk_bf16_f32 v115, v98, v99
    v_mfma_f32_32x32x16_bf16 v[84:99], v[52:55], v[46:49], 0
    v_exp_f32 v68, v68
    v_exp_f32 v69, v69
    v_exp_f32 v70, v70
    v_exp_f32 v71, v71
    v_exp_f32 v72, v72
    v_mfma_f32_32x32x8_bf16 v[84:99], v[56:57], v[50:51], v[84:99]
    ds_read_b128 v[52:55], v28 offset:1024
    s_mov_b64 exec, s[32:33]
    ds_read_b64 v[56:57], v59 offset:1024
    s_mov_b64 exec, -1
    v_cvt_pk_bf16_f32 v100, v68, v69
    v_cvt_pk_bf16_f32 v101, v70, v71
    v_exp_f32 v73, v73
    v_exp_f32 v74, v74
    v_exp_f32 v75, v75
    v_exp_f32 v76, v76
    v_mfma_f32_32x32x16_bf16 v[132:147], v[60:63], v[108:111], v[132:147]
    s_cmp_lt_u32 s3, 6
    s_cbranch_scc0 L_kl_61
    s_mul_i32 s50, s46, 49152
    s_add_u32 s50, s50, s29
    s_add_u32 s50, s50, 15773696
    buffer_load_dwordx4 v[184:187], v34, s[8:11], s50 offen sc1
    s_add_u32 s50, s50, 6144
    buffer_load_dwordx4 v[188:191], v34, s[8:11], s50 offen sc1

L_kl_61:
    s_add_u32 m0, s29, 65536
    s_add_u32 s50, s21, s29
    s_add_u32 s50, s50, 180224
    buffer_load_dwordx4 v34, s[8:11], s50 offen sc1 lds
    v_cvt_pk_bf16_f32 v102, v72, v73
    v_cvt_pk_bf16_f32 v103, v74, v75
    v_exp_f32 v77, v77
    v_exp_f32 v78, v78
    v_exp_f32 v79, v79
    v_exp_f32 v80, v80
    v_mfma_f32_32x32x16_bf16 v[132:147], v[64:67], v[112:115], v[132:147]
    s_mov_b64 exec, s[34:35]
    ds_read_b128 v[60:63], v29 offset:1280
    ds_read_b128 v[64:67], v29 offset:1920
    s_mov_b64 exec, -1
    v_cvt_pk_bf16_f32 v104, v76, v77
    v_cvt_pk_bf16_f32 v105, v78, v79
    v_exp_f32 v81, v81
    v_exp_f32 v82, v82
    v_exp_f32 v83, v83
    v_cvt_pk_bf16_f32 v106, v80, v81
    v_cvt_pk_bf16_f32 v107, v82, v83
    s_setprio 2
    s_waitcnt lgkmcnt(2)
    v_mfma_f32_32x32x16_bf16 v[68:83], v[52:55], v[40:43], 0
    v_exp_f32 v84, v84
    v_exp_f32 v85, v85
    v_exp_f32 v86, v86
    v_exp_f32 v87, v87
    v_exp_f32 v88, v88
    v_mfma_f32_32x32x8_bf16 v[68:83], v[56:57], v[44:45], v[68:83]
    v_cvt_pk_bf16_f32 v108, v84, v85
    v_cvt_pk_bf16_f32 v109, v86, v87
    v_exp_f32 v89, v89
    v_exp_f32 v90, v90
    v_exp_f32 v91, v91
    v_exp_f32 v92, v92
    s_waitcnt lgkmcnt(0)
    v_mfma_f32_32x32x16_bf16 v[116:131], v[60:63], v[100:103], v[116:131]
    s_add_u32 m0, s29, 73728
    s_add_u32 s50, s21, s29
    s_add_u32 s50, s50, 188416
    buffer_load_dwordx4 v34, s[8:11], s50 offen sc1 lds
    v_cvt_pk_bf16_f32 v110, v88, v89
    v_cvt_pk_bf16_f32 v111, v90, v91
    v_exp_f32 v93, v93
    v_exp_f32 v94, v94
    v_exp_f32 v95, v95
    v_exp_f32 v96, v96
    v_mfma_f32_32x32x16_bf16 v[116:131], v[64:67], v[104:107], v[116:131]
    v_cvt_pk_bf16_f32 v112, v92, v93
    v_cvt_pk_bf16_f32 v113, v94, v95
    v_exp_f32 v97, v97
    v_exp_f32 v98, v98
    v_exp_f32 v99, v99
    v_cvt_pk_bf16_f32 v114, v96, v97
    v_cvt_pk_bf16_f32 v115, v98, v99
    v_mfma_f32_32x32x16_bf16 v[84:99], v[52:55], v[46:49], 0
    v_exp_f32 v68, v68
    v_exp_f32 v69, v69
    v_exp_f32 v70, v70
    v_exp_f32 v71, v71
    v_exp_f32 v72, v72
    v_mfma_f32_32x32x8_bf16 v[84:99], v[56:57], v[50:51], v[84:99]
    ds_read_b128 v[52:55], v28 offset:1536
    s_mov_b64 exec, s[32:33]
    ds_read_b64 v[56:57], v59 offset:1536
    s_mov_b64 exec, -1
    v_cvt_pk_bf16_f32 v100, v68, v69
    v_cvt_pk_bf16_f32 v101, v70, v71
    v_exp_f32 v73, v73
    v_exp_f32 v74, v74
    v_exp_f32 v75, v75
    v_exp_f32 v76, v76
    v_mfma_f32_32x32x16_bf16 v[132:147], v[60:63], v[108:111], v[132:147]
    s_add_u32 m0, s29, 81920
    s_add_u32 s50, s21, s29
    s_add_u32 s50, s50, 196608
    buffer_load_dwordx4 v34, s[8:11], s50 offen sc1 lds
    v_cvt_pk_bf16_f32 v102, v72, v73
    v_cvt_pk_bf16_f32 v103, v74, v75
    v_exp_f32 v77, v77
    v_exp_f32 v78, v78
    v_exp_f32 v79, v79
    v_exp_f32 v80, v80
    v_mfma_f32_32x32x16_bf16 v[132:147], v[64:67], v[112:115], v[132:147]
    s_mov_b64 exec, s[34:35]
    ds_read_b128 v[60:63], v29 offset:2560
    ds_read_b128 v[64:67], v29 offset:3200
    s_mov_b64 exec, -1
    v_cvt_pk_bf16_f32 v104, v76, v77
    v_cvt_pk_bf16_f32 v105, v78, v79
    v_exp_f32 v81, v81
    v_exp_f32 v82, v82
    v_exp_f32 v83, v83
    v_cvt_pk_bf16_f32 v106, v80, v81
    v_cvt_pk_bf16_f32 v107, v82, v83
    s_waitcnt lgkmcnt(2)
    v_mfma_f32_32x32x16_bf16 v[68:83], v[52:55], v[40:43], 0
    v_exp_f32 v84, v84
    v_exp_f32 v85, v85
    v_exp_f32 v86, v86
    v_exp_f32 v87, v87
    v_exp_f32 v88, v88
    v_mfma_f32_32x32x8_bf16 v[68:83], v[56:57], v[44:45], v[68:83]
    v_cvt_pk_bf16_f32 v108, v84, v85
    v_cvt_pk_bf16_f32 v109, v86, v87
    v_exp_f32 v89, v89
    v_exp_f32 v90, v90
    v_exp_f32 v91, v91
    v_exp_f32 v92, v92
    s_waitcnt lgkmcnt(0)
    v_mfma_f32_32x32x16_bf16 v[116:131], v[60:63], v[100:103], v[116:131]
    v_cvt_pk_bf16_f32 v110, v88, v89
    v_cvt_pk_bf16_f32 v111, v90, v91
    v_exp_f32 v93, v93
    v_exp_f32 v94, v94
    v_exp_f32 v95, v95
    v_exp_f32 v96, v96
    v_mfma_f32_32x32x16_bf16 v[116:131], v[64:67], v[104:107], v[116:131]
    v_cvt_pk_bf16_f32 v112, v92, v93
    v_cvt_pk_bf16_f32 v113, v94, v95
    v_exp_f32 v97, v97
    v_exp_f32 v98, v98
    v_exp_f32 v99, v99
    v_cvt_pk_bf16_f32 v114, v96, v97
    v_cvt_pk_bf16_f32 v115, v98, v99
    s_waitcnt vmcnt(2)
    s_cmp_lt_u32 s3, 6
    s_cbranch_scc0 L_ks_62

    v_pk_add_f32 v[160:161], v[160:161], v[164:165]
    v_pk_add_f32 v[162:163], v[162:163], v[166:167]
    v_pk_add_f32 v[160:161], v[160:161], v[168:169]
    v_pk_add_f32 v[162:163], v[162:163], v[170:171]
    v_pk_add_f32 v[160:161], v[160:161], v[172:173]
    v_pk_add_f32 v[162:163], v[162:163], v[174:175]
    v_pk_add_f32 v[160:161], v[160:161], v[176:177]
    v_pk_add_f32 v[162:163], v[162:163], v[178:179]
    v_pk_add_f32 v[160:161], v[160:161], v[180:181]
    v_pk_add_f32 v[162:163], v[162:163], v[182:183]
    v_pk_add_f32 v[160:161], v[160:161], v[184:185]
    v_pk_add_f32 v[162:163], v[162:163], v[186:187]
    v_pk_add_f32 v[160:161], v[160:161], v[188:189]
    v_pk_add_f32 v[162:163], v[162:163], v[190:191]
    v_cvt_pk_bf16_f32 v160, v160, v161
    v_cvt_pk_bf16_f32 v161, v162, v163
    s_mov_b64 exec, s[36:37]
    v_mov_b32 v160, 1065369472
    v_mov_b32 v161, 1065369472
    s_mov_b64 exec, -1
    s_lshl_b32 s50, s3, 9
    s_add_u32 s50, s50, 159744
    v_lshrrev_b32 v30, 1, v34
    v_add_u32 v30, s50, v30
    ds_write_b64 v30, v[160:161]
    s_waitcnt lgkmcnt(0)

L_ks_62:
    s_setprio 1
    v_mfma_f32_32x32x16_bf16 v[84:99], v[52:55], v[46:49], 0
    v_exp_f32 v68, v68
    v_exp_f32 v69, v69
    v_exp_f32 v70, v70
    v_exp_f32 v71, v71
    v_exp_f32 v72, v72
    v_mfma_f32_32x32x8_bf16 v[84:99], v[56:57], v[50:51], v[84:99]
    ds_read_b128 v[52:55], v28 offset:2048
    s_mov_b64 exec, s[32:33]
    ds_read_b64 v[56:57], v59 offset:2048
    s_mov_b64 exec, -1
    v_cvt_pk_bf16_f32 v100, v68, v69
    v_cvt_pk_bf16_f32 v101, v70, v71
    v_exp_f32 v73, v73
    v_exp_f32 v74, v74
    v_exp_f32 v75, v75
    v_exp_f32 v76, v76
    v_mfma_f32_32x32x16_bf16 v[132:147], v[60:63], v[108:111], v[132:147]
    v_cvt_pk_bf16_f32 v102, v72, v73
    v_cvt_pk_bf16_f32 v103, v74, v75
    v_exp_f32 v77, v77
    v_exp_f32 v78, v78
    v_exp_f32 v79, v79
    v_exp_f32 v80, v80
    v_mfma_f32_32x32x16_bf16 v[132:147], v[64:67], v[112:115], v[132:147]
    s_mov_b64 exec, s[34:35]
    ds_read_b128 v[60:63], v29 offset:3840
    ds_read_b128 v[64:67], v29 offset:4480
    s_mov_b64 exec, -1
    v_cvt_pk_bf16_f32 v104, v76, v77
    v_cvt_pk_bf16_f32 v105, v78, v79
    v_exp_f32 v81, v81
    v_exp_f32 v82, v82
    v_exp_f32 v83, v83
    v_cvt_pk_bf16_f32 v106, v80, v81
    v_cvt_pk_bf16_f32 v107, v82, v83
    s_setprio 0
    s_waitcnt lgkmcnt(2)
    v_mfma_f32_32x32x16_bf16 v[68:83], v[52:55], v[40:43], 0
    v_exp_f32 v84, v84
    v_exp_f32 v85, v85
    v_exp_f32 v86, v86
    v_exp_f32 v87, v87
    v_exp_f32 v88, v88
    v_mfma_f32_32x32x8_bf16 v[68:83], v[56:57], v[44:45], v[68:83]
    v_cvt_pk_bf16_f32 v108, v84, v85
    v_cvt_pk_bf16_f32 v109, v86, v87
    v_exp_f32 v89, v89
    v_exp_f32 v90, v90
    v_exp_f32 v91, v91
    v_exp_f32 v92, v92
    s_waitcnt lgkmcnt(0)
    v_mfma_f32_32x32x16_bf16 v[116:131], v[60:63], v[100:103], v[116:131]
    v_cvt_pk_bf16_f32 v110, v88, v89
    v_cvt_pk_bf16_f32 v111, v90, v91
    v_exp_f32 v93, v93
    v_exp_f32 v94, v94
    v_exp_f32 v95, v95
    v_exp_f32 v96, v96
    v_mfma_f32_32x32x16_bf16 v[116:131], v[64:67], v[104:107], v[116:131]
    v_cvt_pk_bf16_f32 v112, v92, v93
    v_cvt_pk_bf16_f32 v113, v94, v95
    v_exp_f32 v97, v97
    v_exp_f32 v98, v98
    v_exp_f32 v99, v99
    v_cvt_pk_bf16_f32 v114, v96, v97
    v_cvt_pk_bf16_f32 v115, v98, v99
    v_mfma_f32_32x32x16_bf16 v[84:99], v[52:55], v[46:49], 0
    v_exp_f32 v68, v68
    v_exp_f32 v69, v69
    v_exp_f32 v70, v70
    v_exp_f32 v71, v71
    v_exp_f32 v72, v72
    v_mfma_f32_32x32x8_bf16 v[84:99], v[56:57], v[50:51], v[84:99]
    s_waitcnt vmcnt(0)
    s_barrier
    s_setprio 3
    ds_read_b128 v[52:55], v28 offset:2560
    s_mov_b64 exec, s[32:33]
    ds_read_b64 v[56:57], v59 offset:2560
    s_mov_b64 exec, -1
    v_cvt_pk_bf16_f32 v100, v68, v69
    v_cvt_pk_bf16_f32 v101, v70, v71
    v_exp_f32 v73, v73
    v_exp_f32 v74, v74
    v_exp_f32 v75, v75
    v_exp_f32 v76, v76
    v_mfma_f32_32x32x16_bf16 v[132:147], v[60:63], v[108:111], v[132:147]
    v_cvt_pk_bf16_f32 v102, v72, v73
    v_cvt_pk_bf16_f32 v103, v74, v75
    v_exp_f32 v77, v77
    v_exp_f32 v78, v78
    v_exp_f32 v79, v79
    v_exp_f32 v80, v80
    v_mfma_f32_32x32x16_bf16 v[132:147], v[64:67], v[112:115], v[132:147]
    s_mov_b64 exec, s[34:35]
    ds_read_b128 v[60:63], v29 offset:5120
    ds_read_b128 v[64:67], v29 offset:5760
    s_mov_b64 exec, -1
    v_cvt_pk_bf16_f32 v104, v76, v77
    v_cvt_pk_bf16_f32 v105, v78, v79
    v_exp_f32 v81, v81
    v_exp_f32 v82, v82
    v_exp_f32 v83, v83
    v_cvt_pk_bf16_f32 v106, v80, v81
    v_cvt_pk_bf16_f32 v107, v82, v83
    s_waitcnt lgkmcnt(2)
    v_mfma_f32_32x32x16_bf16 v[68:83], v[52:55], v[40:43], 0
    v_exp_f32 v84, v84
    v_exp_f32 v85, v85
    v_exp_f32 v86, v86
    v_exp_f32 v87, v87
    v_exp_f32 v88, v88
    v_mfma_f32_32x32x8_bf16 v[68:83], v[56:57], v[44:45], v[68:83]
    v_cvt_pk_bf16_f32 v108, v84, v85
    v_cvt_pk_bf16_f32 v109, v86, v87
    v_exp_f32 v89, v89
    v_exp_f32 v90, v90
    v_exp_f32 v91, v91
    v_exp_f32 v92, v92
    s_waitcnt lgkmcnt(0)
    v_mfma_f32_32x32x16_bf16 v[116:131], v[60:63], v[100:103], v[116:131]
    s_add_u32 m0, s29, 90112
    s_add_u32 s50, s21, s29
    s_add_u32 s50, s50, 40960
    buffer_load_dwordx4 v34, s[8:11], s50 offen sc1 lds
    v_cvt_pk_bf16_f32 v110, v88, v89
    v_cvt_pk_bf16_f32 v111, v90, v91
    v_exp_f32 v93, v93
    v_exp_f32 v94, v94
    v_exp_f32 v95, v95
    v_exp_f32 v96, v96
    v_mfma_f32_32x32x16_bf16 v[116:131], v[64:67], v[104:107], v[116:131]
    v_cvt_pk_bf16_f32 v112, v92, v93
    v_cvt_pk_bf16_f32 v113, v94, v95
    v_exp_f32 v97, v97
    v_exp_f32 v98, v98
    v_exp_f32 v99, v99
    v_cvt_pk_bf16_f32 v114, v96, v97
    v_cvt_pk_bf16_f32 v115, v98, v99
    v_lshrrev_b32 v32, 1, v34
    v_add_u32 v32, 159744, v32

    ds_read_b64 v[176:177], v32 offset:0
    ds_read_b64 v[178:179], v32 offset:512
    ds_read_b64 v[180:181], v32 offset:1024
    ds_read_b64 v[0:1], v32 offset:1536
    ds_read_b64 v[2:3], v32 offset:2048
    ds_read_b64 v[20:21], v32 offset:2560
    s_lshr_b32 s50, s46, 4
    s_mul_i32 s30, s50, 2621440
    s_add_u32 s30, s30, 17309696
    s_add_u32 s30, s54, s30
    s_and_b32 s50, s46, 15
    s_lshl_b32 s51, s50, 16
    s_cmp_lt_u32 s50, 8
    s_cselect_b32 s50, 2097152, 0
    s_add_u32 s51, s51, s50
    s_add_u32 s51, s51, s30
    s_waitcnt lgkmcnt(0)
    v_mfma_f32_32x32x16_bf16 v[160:175], v[176:179], v[148:151], 0
    v_mfma_f32_32x32x8_bf16 v[160:175], v[180:181], v[152:153], v[160:175]
    v_mfma_f32_32x32x16_bf16 v[176:191], v[0:3], v[154:157], 0
    v_mfma_f32_32x32x8_bf16 v[176:191], v[20:21], v[158:159], v[176:191]
    v_lshlrev_b32 v36, 4, v25
    v_lshl_add_u32 v36, v26, 15, v36
    s_nop 9
    v_rcp_f32 v30, v173
    v_rcp_f32 v31, v189
    s_nop 0
    v_mul_f32 v32, v172, v30
    v_fmac_f32 v32, v188, v31
    v_add_f32 v32, 0x358637bd, v32
    v_rcp_f32 v32, v32
    s_nop 0
    v_mul_f32 v32, v32, v35
    v_mul_f32 v30, v30, v32
    v_mul_f32 v31, v31, v32

    v_pk_mul_f32 v[160:161], v[160:161], v[30:31] op_sel:[0,0] op_sel_hi:[1,0]
    v_pk_mul_f32 v[162:163], v[162:163], v[30:31] op_sel:[0,0] op_sel_hi:[1,0]
    v_pk_mul_f32 v[164:165], v[164:165], v[30:31] op_sel:[0,0] op_sel_hi:[1,0]
    v_pk_mul_f32 v[166:167], v[166:167], v[30:31] op_sel:[0,0] op_sel_hi:[1,0]
    v_pk_mul_f32 v[168:169], v[168:169], v[30:31] op_sel:[0,0] op_sel_hi:[1,0]
    v_pk_mul_f32 v[170:171], v[170:171], v[30:31] op_sel:[0,0] op_sel_hi:[1,0]
    v_pk_fma_f32 v[160:161], v[176:177], v[30:31], v[160:161] op_sel:[0,1,0] op_sel_hi:[1,1,1]
    v_pk_fma_f32 v[162:163], v[178:179], v[30:31], v[162:163] op_sel:[0,1,0] op_sel_hi:[1,1,1]
    v_pk_fma_f32 v[164:165], v[180:181], v[30:31], v[164:165] op_sel:[0,1,0] op_sel_hi:[1,1,1]
    v_pk_fma_f32 v[166:167], v[182:183], v[30:31], v[166:167] op_sel:[0,1,0] op_sel_hi:[1,1,1]
    v_pk_fma_f32 v[168:169], v[184:185], v[30:31], v[168:169] op_sel:[0,1,0] op_sel_hi:[1,1,1]
    v_pk_fma_f32 v[170:171], v[186:187], v[30:31], v[170:171] op_sel:[0,1,0] op_sel_hi:[1,1,1]
    v_cvt_pk_bf16_f32 v160, v160, v161
    v_cvt_pk_bf16_f32 v161, v162, v163
    v_cvt_pk_bf16_f32 v162, v164, v165
    v_cvt_pk_bf16_f32 v163, v166, v167
    v_cvt_pk_bf16_f32 v20, v168, v169
    v_cvt_pk_bf16_f32 v21, v170, v171
    buffer_store_dwordx4 v[160:163], v36, s[8:11], s51 offen sc1
    v_mfma_f32_32x32x16_bf16 v[84:99], v[52:55], v[46:49], 0
    v_exp_f32 v68, v68
    v_exp_f32 v69, v69
    v_exp_f32 v70, v70
    v_exp_f32 v71, v71
    v_exp_f32 v72, v72
    v_mfma_f32_32x32x8_bf16 v[84:99], v[56:57], v[50:51], v[84:99]
    ds_read_b128 v[52:55], v28 offset:3072
    s_mov_b64 exec, s[32:33]
    ds_read_b64 v[56:57], v59 offset:3072
    s_mov_b64 exec, -1
    v_cvt_pk_bf16_f32 v100, v68, v69
    v_cvt_pk_bf16_f32 v101, v70, v71
    v_exp_f32 v73, v73
    v_exp_f32 v74, v74
    v_exp_f32 v75, v75
    v_exp_f32 v76, v76
    v_mfma_f32_32x32x16_bf16 v[132:147], v[60:63], v[108:111], v[132:147]
    s_add_u32 m0, s29, 98304
    s_add_u32 s50, s21, s29
    s_add_u32 s50, s50, 49152
    buffer_load_dwordx4 v34, s[8:11], s50 offen sc1 lds
    v_cvt_pk_bf16_f32 v102, v72, v73
    v_cvt_pk_bf16_f32 v103, v74, v75
    v_exp_f32 v77, v77
    v_exp_f32 v78, v78
    v_exp_f32 v79, v79
    v_exp_f32 v80, v80
    v_mfma_f32_32x32x16_bf16 v[132:147], v[64:67], v[112:115], v[132:147]
    s_mov_b64 exec, s[34:35]
    ds_read_b128 v[60:63], v29 offset:6400
    ds_read_b128 v[64:67], v29 offset:7040
    s_mov_b64 exec, -1
    v_cvt_pk_bf16_f32 v104, v76, v77
    v_cvt_pk_bf16_f32 v105, v78, v79
    v_exp_f32 v81, v81
    v_exp_f32 v82, v82
    v_exp_f32 v83, v83
    v_cvt_pk_bf16_f32 v106, v80, v81
    v_cvt_pk_bf16_f32 v107, v82, v83
    s_waitcnt lgkmcnt(2)
    v_mfma_f32_32x32x16_bf16 v[68:83], v[52:55], v[40:43], 0
    v_exp_f32 v84, v84
    v_exp_f32 v85, v85
    v_exp_f32 v86, v86
    v_exp_f32 v87, v87
    v_exp_f32 v88, v88
    v_mfma_f32_32x32x8_bf16 v[68:83], v[56:57], v[44:45], v[68:83]
    v_cvt_pk_bf16_f32 v108, v84, v85
    v_cvt_pk_bf16_f32 v109, v86, v87
    v_exp_f32 v89, v89
    v_exp_f32 v90, v90
    v_exp_f32 v91, v91
    v_exp_f32 v92, v92
    s_waitcnt lgkmcnt(0)
    v_mfma_f32_32x32x16_bf16 v[116:131], v[60:63], v[100:103], v[116:131]
    s_add_u32 m0, s29, 106496
    s_add_u32 s50, s21, s29
    s_add_u32 s50, s50, 57344
    buffer_load_dwordx4 v34, s[8:11], s50 offen sc1 lds
    v_cvt_pk_bf16_f32 v110, v88, v89
    v_cvt_pk_bf16_f32 v111, v90, v91
    v_exp_f32 v93, v93
    v_exp_f32 v94, v94
    v_exp_f32 v95, v95
    v_exp_f32 v96, v96
    v_mfma_f32_32x32x16_bf16 v[116:131], v[64:67], v[104:107], v[116:131]
    v_cvt_pk_bf16_f32 v112, v92, v93
    v_cvt_pk_bf16_f32 v113, v94, v95
    v_exp_f32 v97, v97
    v_exp_f32 v98, v98
    v_exp_f32 v99, v99
    v_cvt_pk_bf16_f32 v114, v96, v97
    v_cvt_pk_bf16_f32 v115, v98, v99
    s_mul_i32 s50, s49, 5120
    s_add_u32 s50, s50, 49152
    v_add_u32 v33, s50, v34
    ds_read_b128 v[192:195], v33 offset:0
    ds_read_b128 v[196:199], v33 offset:1024
    ds_read_b128 v[200:203], v33 offset:2048
    ds_read_b128 v[204:207], v33 offset:3072
    ds_read_b128 v[208:211], v33 offset:4096
    ds_read_b128 v[212:215], v33 offset:10240
    ds_read_b128 v[216:219], v33 offset:11264
    ds_read_b128 v[220:223], v33 offset:12288
    ds_read_b128 v[224:227], v33 offset:13312
    ds_read_b128 v[228:231], v33 offset:14336
    s_setprio 2
    v_mfma_f32_32x32x16_bf16 v[84:99], v[52:55], v[46:49], 0
    v_exp_f32 v68, v68
    v_exp_f32 v69, v69
    v_exp_f32 v70, v70
    v_exp_f32 v71, v71
    v_exp_f32 v72, v72
    v_mfma_f32_32x32x8_bf16 v[84:99], v[56:57], v[50:51], v[84:99]
    ds_read_b128 v[52:55], v28 offset:3584
    s_mov_b64 exec, s[32:33]
    ds_read_b64 v[56:57], v59 offset:3584
    s_mov_b64 exec, -1
    v_cvt_pk_bf16_f32 v100, v68, v69
    v_cvt_pk_bf16_f32 v101, v70, v71
    v_exp_f32 v73, v73
    v_exp_f32 v74, v74
    v_exp_f32 v75, v75
    v_exp_f32 v76, v76
    v_mfma_f32_32x32x16_bf16 v[132:147], v[60:63], v[108:111], v[132:147]
    s_add_u32 m0, s29, 114688
    s_add_u32 s50, s21, s29
    s_add_u32 s50, s50, 65536
    buffer_load_dwordx4 v34, s[8:11], s50 offen sc1 lds
    v_cvt_pk_bf16_f32 v102, v72, v73
    v_cvt_pk_bf16_f32 v103, v74, v75
    v_exp_f32 v77, v77
    v_exp_f32 v78, v78
    v_exp_f32 v79, v79
    v_exp_f32 v80, v80
    v_mfma_f32_32x32x16_bf16 v[132:147], v[64:67], v[112:115], v[132:147]
    s_mov_b64 exec, s[34:35]
    ds_read_b128 v[60:63], v29 offset:7680
    ds_read_b128 v[64:67], v29 offset:8320
    s_mov_b64 exec, -1
    v_cvt_pk_bf16_f32 v104, v76, v77
    v_cvt_pk_bf16_f32 v105, v78, v79
    v_exp_f32 v81, v81
    v_exp_f32 v82, v82
    v_exp_f32 v83, v83
    v_cvt_pk_bf16_f32 v106, v80, v81
    v_cvt_pk_bf16_f32 v107, v82, v83
    s_waitcnt lgkmcnt(2)
    v_mfma_f32_32x32x16_bf16 v[68:83], v[52:55], v[40:43], 0
    v_exp_f32 v84, v84
    v_exp_f32 v85, v85
    v_exp_f32 v86, v86
    v_exp_f32 v87, v87
    v_exp_f32 v88, v88
    v_mfma_f32_32x32x8_bf16 v[68:83], v[56:57], v[44:45], v[68:83]
    v_cvt_pk_bf16_f32 v108, v84, v85
    v_cvt_pk_bf16_f32 v109, v86, v87
    v_exp_f32 v89, v89
    v_exp_f32 v90, v90
    v_exp_f32 v91, v91
    v_exp_f32 v92, v92
    s_waitcnt lgkmcnt(0)
    v_mfma_f32_32x32x16_bf16 v[116:131], v[60:63], v[100:103], v[116:131]
    s_add_u32 m0, s29, 122880
    s_add_u32 s50, s21, s29
    s_add_u32 s50, s50, 73728
    buffer_load_dwordx4 v34, s[8:11], s50 offen sc1 lds
    v_cvt_pk_bf16_f32 v110, v88, v89
    v_cvt_pk_bf16_f32 v111, v90, v91
    v_exp_f32 v93, v93
    v_exp_f32 v94, v94
    v_exp_f32 v95, v95
    v_exp_f32 v96, v96
    v_mfma_f32_32x32x16_bf16 v[116:131], v[64:67], v[104:107], v[116:131]
    v_cvt_pk_bf16_f32 v112, v92, v93
    v_cvt_pk_bf16_f32 v113, v94, v95
    v_exp_f32 v97, v97
    v_exp_f32 v98, v98
    v_exp_f32 v99, v99
    v_cvt_pk_bf16_f32 v114, v96, v97
    v_cvt_pk_bf16_f32 v115, v98, v99
    ds_read_b128 v[232:235], v33 offset:20480
    ds_read_b128 v[236:239], v33 offset:21504
    ds_read_b128 v[240:243], v33 offset:22528
    ds_read_b128 v[244:247], v33 offset:23552
    ds_read_b128 v[248:251], v33 offset:24576
    ds_read_b128 v[252:255], v33 offset:30720
    ds_read_b128 v[4:7], v33 offset:31744
    ds_read_b128 v[8:11], v33 offset:32768
    ds_read_b128 v[12:15], v33 offset:33792
    ds_read_b128 v[16:19], v33 offset:34816
    s_setprio 1
    v_mfma_f32_32x32x16_bf16 v[84:99], v[52:55], v[46:49], 0
    v_exp_f32 v68, v68
    v_exp_f32 v69, v69
    v_exp_f32 v70, v70
    v_exp_f32 v71, v71
    v_exp_f32 v72, v72
    v_mfma_f32_32x32x8_bf16 v[84:99], v[56:57], v[50:51], v[84:99]
    v_cvt_pk_bf16_f32 v100, v68, v69
    v_cvt_pk_bf16_f32 v101, v70, v71
    v_exp_f32 v73, v73
    v_exp_f32 v74, v74
    v_exp_f32 v75, v75
    v_exp_f32 v76, v76
    v_mfma_f32_32x32x16_bf16 v[132:147], v[60:63], v[108:111], v[132:147]
    v_cvt_pk_bf16_f32 v102, v72, v73
    v_cvt_pk_bf16_f32 v103, v74, v75
    v_exp_f32 v77, v77
    v_exp_f32 v78, v78
    v_exp_f32 v79, v79
    v_exp_f32 v80, v80
    v_mfma_f32_32x32x16_bf16 v[132:147], v[64:67], v[112:115], v[132:147]
    s_mov_b64 exec, s[34:35]
    ds_read_b128 v[60:63], v29 offset:8960
    ds_read_b128 v[64:67], v29 offset:9600
    s_mov_b64 exec, -1
    v_cvt_pk_bf16_f32 v104, v76, v77
    v_cvt_pk_bf16_f32 v105, v78, v79
    v_exp_f32 v81, v81
    v_exp_f32 v82, v82
    v_exp_f32 v83, v83
    v_cvt_pk_bf16_f32 v106, v80, v81
    v_cvt_pk_bf16_f32 v107, v82, v83
    s_setprio 0
    v_exp_f32 v84, v84
    v_exp_f32 v85, v85
    v_exp_f32 v86, v86
    v_exp_f32 v87, v87
    v_exp_f32 v88, v88
    v_cvt_pk_bf16_f32 v108, v84, v85
    v_cvt_pk_bf16_f32 v109, v86, v87
    v_exp_f32 v89, v89
    v_exp_f32 v90, v90
    v_exp_f32 v91, v91
    v_exp_f32 v92, v92
    s_waitcnt lgkmcnt(0)
    v_mfma_f32_32x32x16_bf16 v[116:131], v[60:63], v[100:103], v[116:131]
    v_cvt_pk_bf16_f32 v110, v88, v89
    v_cvt_pk_bf16_f32 v111, v90, v91
    v_exp_f32 v93, v93
    v_exp_f32 v94, v94
    v_exp_f32 v95, v95
    v_exp_f32 v96, v96
    v_mfma_f32_32x32x16_bf16 v[116:131], v[64:67], v[104:107], v[116:131]
    v_cvt_pk_bf16_f32 v112, v92, v93
    v_cvt_pk_bf16_f32 v113, v94, v95
    v_exp_f32 v97, v97
    v_exp_f32 v98, v98
    v_exp_f32 v99, v99
    v_cvt_pk_bf16_f32 v114, v96, v97
    v_cvt_pk_bf16_f32 v115, v98, v99
    s_mul_i32 s50, s3, 3072
    s_add_u32 s50, s50, 135168
    v_mfma_f32_32x32x16_bf16 v[132:147], v[60:63], v[108:111], v[132:147]
    v_mfma_f32_32x32x16_bf16 v[132:147], v[64:67], v[112:115], v[132:147]
    v_add_u32 v30, s50, v34
    s_xor_b32 s50, s3, 4
    s_mul_i32 s50, s50, 3072
    s_add_u32 s50, s50, 135168
    v_add_u32 v33, s50, v34
    s_cmp_eq_u32 s49, 0
    s_cbranch_scc1 L_k2_send_b

    ds_write_b128 v30, v[116:119] offset:0
    ds_write_b128 v30, v[120:123] offset:1024
    ds_write_b128 v30, v[124:127] offset:2048
    s_nop 1
    v_mov_b32 v116, v132
    v_mov_b32 v117, v133
    v_mov_b32 v118, v134
    v_mov_b32 v119, v135
    v_mov_b32 v120, v136
    v_mov_b32 v121, v137
    v_mov_b32 v122, v138
    v_mov_b32 v123, v139
    v_mov_b32 v124, v140
    v_mov_b32 v125, v141
    v_mov_b32 v126, v142
    v_mov_b32 v127, v143
    s_branch L_k2_sent
L_k2_send_b:
    s_nop 4
    ds_write_b128 v30, v[132:135] offset:0
    ds_write_b128 v30, v[136:139] offset:1024
    ds_write_b128 v30, v[140:143] offset:2048
L_k2_sent:
    s_waitcnt vmcnt(4)
    s_waitcnt lgkmcnt(0)
    s_barrier

    ds_read_b128 v[132:135], v33 offset:0
    ds_read_b128 v[136:139], v33 offset:1024
    ds_read_b128 v[140:143], v33 offset:2048
    s_cmp_eq_u32 s3, 7
    s_cbranch_scc0 L_nooa
    s_add_u32 s50, s47, 56
    s_lshl_b32 s50, s50, 7
    v_mov_b32 v30, s50
    v_mov_b32 v31, 1
    s_mov_b64 exec, 1
    global_atomic_add v30, v31, s[16:17]
    s_mov_b64 exec, -1

L_nooa:
    s_waitcnt lgkmcnt(0)
    v_pk_add_f32 v[116:117], v[116:117], v[132:133]
    v_pk_add_f32 v[118:119], v[118:119], v[134:135]
    v_pk_add_f32 v[120:121], v[120:121], v[136:137]
    v_pk_add_f32 v[122:123], v[122:123], v[138:139]
    v_pk_add_f32 v[124:125], v[124:125], v[140:141]
    v_pk_add_f32 v[126:127], v[126:127], v[142:143]
    v_mov_b32 v128, v124
    v_mov_b32 v31, v124
    s_nop 1
    v_permlane32_swap_b32 v31, v128
    s_nop 0
    v_mov_b32 v30, v128

    v_fmac_f32 v30, 0, v116
    v_fmac_f32 v30, 0, v117
    v_fmac_f32 v30, 0, v118
    v_fmac_f32 v30, 0, v119
    v_fmac_f32 v30, 0, v120
    v_fmac_f32 v30, 0, v121
    v_fmac_f32 v30, 0, v122
    v_fmac_f32 v30, 0, v123
    v_fmac_f32 v30, 0, v124
    v_fmac_f32 v30, 0, v125
    v_fmac_f32 v30, 0, v126
    v_fmac_f32 v30, 0, v127
    v_cmp_gt_f32 vcc, 0x5f800000, v30
    s_nop 1
    s_cmp_eq_u64 vcc, -1
    s_cbranch_scc0 L_k2_slow

L_k2_bfin:
    v_rcp_f32 v30, v128
    v_sub_f32 v31, 1.0, v35
    v_cvt_pk_bf16_f32 v31, v31, v31
    v_lshlrev_b32 v31, 16, v31
    v_mul_f32 v30, v30, v31

    v_pk_mul_f32 v[116:117], v[116:117], v[30:31] op_sel:[0,0] op_sel_hi:[1,0]
    v_pk_mul_f32 v[118:119], v[118:119], v[30:31] op_sel:[0,0] op_sel_hi:[1,0]
    v_pk_mul_f32 v[120:121], v[120:121], v[30:31] op_sel:[0,0] op_sel_hi:[1,0]
    v_pk_mul_f32 v[122:123], v[122:123], v[30:31] op_sel:[0,0] op_sel_hi:[1,0]
    v_pk_mul_f32 v[124:125], v[124:125], v[30:31] op_sel:[0,0] op_sel_hi:[1,0]
    v_pk_mul_f32 v[126:127], v[126:127], v[30:31] op_sel:[0,0] op_sel_hi:[1,0]
    v_cvt_pk_bf16_f32 v116, v116, v117
    v_cvt_pk_bf16_f32 v117, v118, v119
    v_cvt_pk_bf16_f32 v118, v120, v121
    v_cvt_pk_bf16_f32 v119, v122, v123
    v_cvt_pk_bf16_f32 v22, v124, v125
    v_cvt_pk_bf16_f32 v23, v126, v127
    s_and_b32 s56, s46, 15
    s_mul_i32 s51, s56, 98304
    s_add_u32 s51, s51, s30
    s_cmp_ge_u32 s56, 5
    s_cselect_b32 s50, 524288, 0
    s_add_u32 s50, s50, s51
    s_add_u32 s50, s50, 32768
    buffer_store_dwordx4 v[116:119], v36, s[8:11], s50 offen sc1
    s_cmp_ge_u32 s56, 6
    s_cselect_b32 s50, 524288, 0
    s_add_u32 s50, s50, s51
    s_mov_b64 exec, s[32:33]
    buffer_store_dwordx4 v[20:23], v36, s[8:11], s50 offen sc1
    s_mov_b64 exec, -1

    s_and_b32 s30, s2, 7
    s_add_u32 s30, s30, 56
    s_cmp_eq_u32 s3, 7
    s_cbranch_scc0 L_w7_63
    s_lshl_b32 s50, s30, 7
    v_mov_b32 v30, s50
    s_mov_b64 exec, 1
    global_load_dword v37, v30, s[16:17] sc1
    s_mov_b64 exec, -1
L_w7_63:
    s_add_u32 m0, s29, 49152
    s_add_u32 s50, s21, s29
    s_add_u32 s50, s50, 0
    buffer_load_dwordx4 v34, s[8:11], s50 offen sc1 lds
    s_add_u32 m0, s29, 57344
    s_add_u32 s50, s21, s29
    s_add_u32 s50, s50, 8192
    buffer_load_dwordx4 v34, s[8:11], s50 offen sc1 lds
    s_add_u32 m0, s29, 65536
    s_add_u32 s50, s21, s29
    s_add_u32 s50, s50, 16384
    buffer_load_dwordx4 v34, s[8:11], s50 offen sc1 lds
    s_add_u32 m0, s29, 73728
    s_add_u32 s50, s21, s29
    s_add_u32 s50, s50, 24576
    buffer_load_dwordx4 v34, s[8:11], s50 offen sc1 lds
    s_add_u32 m0, s29, 81920
    s_add_u32 s50, s21, s29
    s_add_u32 s50, s50, 32768
    buffer_load_dwordx4 v34, s[8:11], s50 offen sc1 lds
    s_add_u32 m0, s29, 0
    s_add_u32 s50, s21, s29
    s_add_u32 s50, s50, 81920
    buffer_load_dwordx4 v34, s[8:11], s50 offen sc1 lds
    s_add_u32 m0, s29, 8192
    s_add_u32 s50, s21, s29
    s_add_u32 s50, s50, 90112
    buffer_load_dwordx4 v34, s[8:11], s50 offen sc1 lds
    s_add_u32 m0, s29, 16384
    s_add_u32 s50, s21, s29
    s_add_u32 s50, s50, 98304
    buffer_load_dwordx4 v34, s[8:11], s50 offen sc1 lds
    s_add_u32 m0, s29, 24576
    s_add_u32 s50, s21, s29
    s_add_u32 s50, s50, 106496
    buffer_load_dwordx4 v34, s[8:11], s50 offen sc1 lds
    s_add_u32 m0, s29, 32768
    s_add_u32 s50, s21, s29
    s_add_u32 s50, s50, 114688
    buffer_load_dwordx4 v34, s[8:11], s50 offen sc1 lds
    s_mul_i32 s51, s49, 5120
    v_add_u32 v28, s51, v34
    v_add_u32 v29, 0x10000, v28
    v_add_u32 v32, 122880, v28
    s_mul_i32 s51, s49, 81920
    v_add_u32 v27, s51, v28

    v_and_b32 v30, 15, v24
    v_lshrrev_b32 v31, 4, v24
    v_lshlrev_b32 v33, 4, v30
    v_lshl_add_u32 v33, v31, 15, v33
    v_mul_u32_u24 v35, 1280, v30
    v_lshl_add_u32 v35, v31, 3, v35
    s_lshl_b32 s50, s19, 2
    s_add_u32 s50, s50, s48
    s_lshl_b32 s54, s50, 8
    s_mul_i32 s51, s49, 2621440
    s_add_u32 s54, s54, s51
    s_add_u32 s54, s54, 17309696
    s_mul_i32 s53, s50, 20480
    s_mul_i32 s51, s20, 160
    s_add_u32 s53, s53, s51
    s_and_b32 s56, s2, 7
    s_add_u32 s56, s56, 48

    s_waitcnt vmcnt(10)
    s_cmp_eq_u32 s3, 7
    s_cbranch_scc0 L_w7_66
L_pl_67:
    v_cmp_le_u32 vcc, 32, v37
    s_nop 1
    s_and_b32 s50, vcc_lo, 1
    s_cmp_eq_u32 s50, 1
    s_cbranch_scc1 L_pd_68

    s_sleep 4
    s_lshl_b32 s50, s30, 7
    v_mov_b32 v30, s50
    s_mov_b64 exec, 1
    global_load_dword v37, v30, s[16:17] sc1
    s_mov_b64 exec, -1
    s_waitcnt vmcnt(0)
    s_branch L_pl_67
L_pd_68:
L_w7_66:
    s_barrier
    s_cmp_eq_u32 s3, 0
    s_cbranch_scc0 L_w0_69
    s_add_u32 s50, s47, 48
    s_lshl_b32 s50, s50, 7
    v_mov_b32 v30, s50
    v_mov_b32 v31, 1
    s_mov_b64 exec, 1
    global_atomic_add v30, v31, s[16:17]
    s_mov_b64 exec, -1

L_w0_69:
    s_add_u32 s50, s54, 2097152
    buffer_load_dwordx4 v[104:107], v33, s[8:11], s50 offen sc1
    s_add_u32 s50, s54, 2228224
    buffer_load_dwordx4 v[108:111], v33, s[8:11], s50 offen sc1
    s_add_u32 s50, s54, 2359296
    buffer_load_dwordx4 v[112:115], v33, s[8:11], s50 offen sc1
    s_add_u32 s50, s54, 2490368
    buffer_load_dwordx4 v[116:119], v33, s[8:11], s50 offen sc1
    s_add_u32 s50, s54, 524288
    buffer_load_dwordx4 v[56:59], v33, s[8:11], s50 offen sc1
    s_add_u32 s50, s54, 655360
    buffer_load_dwordx4 v[60:63], v33, s[8:11], s50 offen sc1
    s_add_u32 s50, s54, 786432
    buffer_load_dwordx4 v[64:67], v33, s[8:11], s50 offen sc1
    s_add_u32 s50, s54, 917504
    buffer_load_dwordx4 v[68:71], v33, s[8:11], s50 offen sc1
    s_add_u32 m0, s29, 40960
    s_add_u32 s50, s21, s29
    s_add_u32 s50, s50, 122880
    buffer_load_dwordx4 v34, s[8:11], s50 offen sc1 lds
    s_add_u32 m0, s29, 131072
    s_add_u32 s50, s21, s29
    s_add_u32 s50, s50, 131072
    buffer_load_dwordx4 v34, s[8:11], s50 offen sc1 lds
    s_add_u32 m0, s29, 139264
    s_add_u32 s50, s21, s29
    s_add_u32 s50, s50, 139264
    buffer_load_dwordx4 v34, s[8:11], s50 offen sc1 lds
    s_add_u32 m0, s29, 147456
    s_add_u32 s50, s21, s29
    s_add_u32 s50, s50, 147456
    buffer_load_dwordx4 v34, s[8:11], s50 offen sc1 lds
    s_add_u32 m0, s29, 155648
    s_add_u32 s50, s21, s29
    s_add_u32 s50, s50, 155648
    buffer_load_dwordx4 v34, s[8:11], s50 offen sc1 lds
    s_cmp_eq_u32 s3, 7
    s_cbranch_scc0 L_w7_70
    s_lshl_b32 s50, s56, 7
    v_mov_b32 v30, s50
    s_mov_b64 exec, 1
    global_load_dword v37, v30, s[16:17] sc1
    s_mov_b64 exec, -1
L_w7_70:
    ds_read_b128 v[156:159], v29 offset:24576
    ds_read_b128 v[160:163], v29 offset:25600
    ds_read_b128 v[164:167], v29 offset:26624
    ds_read_b128 v[168:171], v29 offset:27648
    ds_read_b128 v[172:175], v29 offset:28672
    ds_read_b128 v[176:179], v29 offset:34816
    ds_read_b128 v[180:183], v29 offset:35840
    s_waitcnt vmcnt(12)
    v_mfma_f32_16x16x32_bf16 v[120:123], v[192:195], v[104:107], 0
    v_mfma_f32_16x16x32_bf16 v[124:127], v[196:199], v[104:107], 0
    v_mfma_f32_16x16x32_bf16 v[128:131], v[200:203], v[104:107], 0
    v_mfma_f32_16x16x32_bf16 v[132:135], v[204:207], v[104:107], 0
    v_mfma_f32_16x16x32_bf16 v[136:139], v[208:211], v[104:107], 0
    s_waitcnt vmcnt(11)
    v_mfma_f32_16x16x32_bf16 v[120:123], v[212:215], v[108:111], v[120:123]
    v_mfma_f32_16x16x32_bf16 v[124:127], v[216:219], v[108:111], v[124:127]
    v_mfma_f32_16x16x32_bf16 v[128:131], v[220:223], v[108:111], v[128:131]
    v_mfma_f32_16x16x32_bf16 v[132:135], v[224:227], v[108:111], v[132:135]
    v_mfma_f32_16x16x32_bf16 v[136:139], v[228:231], v[108:111], v[136:139]
    s_waitcnt vmcnt(10)
    v_mfma_f32_16x16x32_bf16 v[120:123], v[232:235], v[112:115], v[120:123]
    v_mfma_f32_16x16x32_bf16 v[124:127], v[236:239], v[112:115], v[124:127]
    v_mfma_f32_16x16x32_bf16 v[128:131], v[240:243], v[112:115], v[128:131]
    v_mfma_f32_16x16x32_bf16 v[132:135], v[244:247], v[112:115], v[132:135]
    v_mfma_f32_16x16x32_bf16 v[136:139], v[248:251], v[112:115], v[136:139]
    s_waitcnt vmcnt(9)
    v_mfma_f32_16x16x32_bf16 v[120:123], v[252:255], v[116:119], v[120:123]
    v_mfma_f32_16x16x32_bf16 v[124:127], v[4:7], v[116:119], v[124:127]
    v_mfma_f32_16x16x32_bf16 v[128:131], v[8:11], v[116:119], v[128:131]
    v_mfma_f32_16x16x32_bf16 v[132:135], v[12:15], v[116:119], v[132:135]
    v_mfma_f32_16x16x32_bf16 v[136:139], v[16:19], v[116:119], v[136:139]
    ds_read_b128 v[184:187], v29 offset:36864
    s_waitcnt vmcnt(8)
    s_waitcnt lgkmcnt(7)
    v_mfma_f32_16x16x32_bf16 v[120:123], v[156:159], v[56:59], v[120:123]
    ds_read_b128 v[188:191], v29 offset:37888
    s_waitcnt lgkmcnt(7)
    v_mfma_f32_16x16x32_bf16 v[124:127], v[160:163], v[56:59], v[124:127]
    ds_read_b128 v[156:159], v29 offset:38912
    s_waitcnt lgkmcnt(7)
    v_mfma_f32_16x16x32_bf16 v[128:131], v[164:167], v[56:59], v[128:131]
    ds_read_b128 v[160:163], v29 offset:45056
    s_waitcnt lgkmcnt(7)
    v_mfma_f32_16x16x32_bf16 v[132:135], v[168:171], v[56:59], v[132:135]
    ds_read_b128 v[164:167], v29 offset:46080
    s_waitcnt lgkmcnt(7)
    v_mfma_f32_16x16x32_bf16 v[136:139], v[172:175], v[56:59], v[136:139]
    ds_read_b128 v[168:171], v29 offset:47104
    s_waitcnt vmcnt(7)
    s_waitcnt lgkmcnt(7)
    v_mfma_f32_16x16x32_bf16 v[120:123], v[176:179], v[60:63], v[120:123]
    ds_read_b128 v[172:175], v29 offset:48128
    s_waitcnt lgkmcnt(7)
    v_mfma_f32_16x16x32_bf16 v[124:127], v[180:183], v[60:63], v[124:127]
    ds_read_b128 v[176:179], v29 offset:49152
    s_waitcnt lgkmcnt(7)
    v_mfma_f32_16x16x32_bf16 v[128:131], v[184:187], v[60:63], v[128:131]
    ds_read_b128 v[180:183], v29 offset:55296
    s_waitcnt lgkmcnt(7)
    v_mfma_f32_16x16x32_bf16 v[132:135], v[188:191], v[60:63], v[132:135]
    ds_read_b128 v[184:187], v29 offset:56320
    s_waitcnt lgkmcnt(7)
    v_mfma_f32_16x16x32_bf16 v[136:139], v[156:159], v[60:63], v[136:139]
    ds_read_b128 v[188:191], v29 offset:57344
    s_waitcnt vmcnt(6)
    s_waitcnt lgkmcnt(7)
    v_mfma_f32_16x16x32_bf16 v[120:123], v[160:163], v[64:67], v[120:123]
    ds_read_b128 v[156:159], v29 offset:58368
    s_waitcnt lgkmcnt(7)
    v_mfma_f32_16x16x32_bf16 v[124:127], v[164:167], v[64:67], v[124:127]
    ds_read_b128 v[160:163], v29 offset:59392
    s_waitcnt lgkmcnt(7)
    v_mfma_f32_16x16x32_bf16 v[128:131], v[168:171], v[64:67], v[128:131]
    s_waitcnt lgkmcnt(6)
    v_mfma_f32_16x16x32_bf16 v[132:135], v[172:175], v[64:67], v[132:135]
    s_waitcnt lgkmcnt(5)
    v_mfma_f32_16x16x32_bf16 v[136:139], v[176:179], v[64:67], v[136:139]
    s_waitcnt vmcnt(5)
    s_waitcnt lgkmcnt(4)
    v_mfma_f32_16x16x32_bf16 v[120:123], v[180:183], v[68:71], v[120:123]
    s_waitcnt lgkmcnt(3)
    v_mfma_f32_16x16x32_bf16 v[124:127], v[184:187], v[68:71], v[124:127]
    s_waitcnt lgkmcnt(2)
    v_mfma_f32_16x16x32_bf16 v[128:131], v[188:191], v[68:71], v[128:131]
    s_waitcnt lgkmcnt(1)
    v_mfma_f32_16x16x32_bf16 v[132:135], v[156:159], v[68:71], v[132:135]
    s_waitcnt lgkmcnt(0)
    v_mfma_f32_16x16x32_bf16 v[136:139], v[160:163], v[68:71], v[136:139]
    s_waitcnt vmcnt(0)
    s_cmp_eq_u32 s3, 7
    s_cbranch_scc0 L_w7_73
L_pl_74:
    v_cmp_le_u32 vcc, 32, v37
    s_nop 1
    s_and_b32 s50, vcc_lo, 1
    s_cmp_eq_u32 s50, 1
    s_cbranch_scc1 L_pd_75

    s_sleep 4
    s_lshl_b32 s50, s56, 7
    v_mov_b32 v30, s50
    s_mov_b64 exec, 1
    global_load_dword v37, v30, s[16:17] sc1
    s_mov_b64 exec, -1
    s_waitcnt vmcnt(0)
    s_branch L_pl_74
L_pd_75:
L_w7_73:
    s_barrier
    s_add_u32 s50, s54, 0
    buffer_load_dwordx4 v[40:43], v33, s[8:11], s50 offen sc1
    s_add_u32 s50, s54, 131072
    buffer_load_dwordx4 v[44:47], v33, s[8:11], s50 offen sc1
    s_add_u32 s50, s54, 262144
    buffer_load_dwordx4 v[48:51], v33, s[8:11], s50 offen sc1
    s_add_u32 s50, s54, 393216
    buffer_load_dwordx4 v[52:55], v33, s[8:11], s50 offen sc1
    s_add_u32 s50, s54, 1048576
    buffer_load_dwordx4 v[72:75], v33, s[8:11], s50 offen sc1
    s_add_u32 s50, s54, 1179648
    buffer_load_dwordx4 v[76:79], v33, s[8:11], s50 offen sc1
    s_add_u32 s50, s54, 1310720
    buffer_load_dwordx4 v[80:83], v33, s[8:11], s50 offen sc1
    s_add_u32 s50, s54, 1441792
    buffer_load_dwordx4 v[84:87], v33, s[8:11], s50 offen sc1
    s_add_u32 s50, s54, 1572864
    buffer_load_dwordx4 v[88:91], v33, s[8:11], s50 offen sc1
    s_add_u32 s50, s54, 1703936
    buffer_load_dwordx4 v[92:95], v33, s[8:11], s50 offen sc1
    s_add_u32 s50, s54, 1835008
    buffer_load_dwordx4 v[96:99], v33, s[8:11], s50 offen sc1
    s_add_u32 s50, s54, 1966080
    buffer_load_dwordx4 v[100:103], v33, s[8:11], s50 offen sc1
    ds_read_b128 v[156:159], v28 offset:49152
    ds_read_b128 v[160:163], v28 offset:50176
    ds_read_b128 v[164:167], v28 offset:51200
    ds_read_b128 v[168:171], v28 offset:52224
    ds_read_b128 v[172:175], v28 offset:53248
    ds_read_b128 v[176:179], v28 offset:59392
    ds_read_b128 v[180:183], v28 offset:60416
    ds_read_b128 v[184:187], v28 offset:61440
    s_waitcnt vmcnt(11)
    s_waitcnt lgkmcnt(7)
    v_mfma_f32_16x16x32_bf16 v[120:123], v[156:159], v[40:43], v[120:123]
    ds_read_b128 v[188:191], v28 offset:62464
    s_waitcnt lgkmcnt(7)
    v_mfma_f32_16x16x32_bf16 v[124:127], v[160:163], v[40:43], v[124:127]
    ds_read_b128 v[156:159], v28 offset:63488
    s_waitcnt lgkmcnt(7)
    v_mfma_f32_16x16x32_bf16 v[128:131], v[164:167], v[40:43], v[128:131]
    ds_read_b128 v[160:163], v29 offset:4096
    s_waitcnt lgkmcnt(7)
    v_mfma_f32_16x16x32_bf16 v[132:135], v[168:171], v[40:43], v[132:135]
    ds_read_b128 v[164:167], v29 offset:5120
    s_waitcnt lgkmcnt(7)
    v_mfma_f32_16x16x32_bf16 v[136:139], v[172:175], v[40:43], v[136:139]
    ds_read_b128 v[168:171], v29 offset:6144
    s_waitcnt vmcnt(10)
    s_waitcnt lgkmcnt(7)
    v_mfma_f32_16x16x32_bf16 v[120:123], v[176:179], v[44:47], v[120:123]
    ds_read_b128 v[172:175], v29 offset:7168
    s_waitcnt lgkmcnt(7)
    v_mfma_f32_16x16x32_bf16 v[124:127], v[180:183], v[44:47], v[124:127]
    ds_read_b128 v[176:179], v29 offset:8192
    s_waitcnt lgkmcnt(7)
    v_mfma_f32_16x16x32_bf16 v[128:131], v[184:187], v[44:47], v[128:131]
    ds_read_b128 v[180:183], v29 offset:14336
    s_waitcnt lgkmcnt(7)
    v_mfma_f32_16x16x32_bf16 v[132:135], v[188:191], v[44:47], v[132:135]
    ds_read_b128 v[184:187], v29 offset:15360
    s_waitcnt lgkmcnt(7)
    v_mfma_f32_16x16x32_bf16 v[136:139], v[156:159], v[44:47], v[136:139]
    ds_read_b128 v[188:191], v29 offset:16384
    s_waitcnt vmcnt(9)
    s_waitcnt lgkmcnt(7)
    v_mfma_f32_16x16x32_bf16 v[120:123], v[160:163], v[48:51], v[120:123]
    ds_read_b128 v[156:159], v29 offset:17408
    s_waitcnt lgkmcnt(7)
    v_mfma_f32_16x16x32_bf16 v[124:127], v[164:167], v[48:51], v[124:127]
    ds_read_b128 v[160:163], v29 offset:18432
    s_waitcnt lgkmcnt(7)
    v_mfma_f32_16x16x32_bf16 v[128:131], v[168:171], v[48:51], v[128:131]
    ds_read_b128 v[164:167], v28 offset:0
    s_waitcnt lgkmcnt(7)
    v_mfma_f32_16x16x32_bf16 v[132:135], v[172:175], v[48:51], v[132:135]
    ds_read_b128 v[168:171], v28 offset:1024
    s_waitcnt lgkmcnt(7)
    v_mfma_f32_16x16x32_bf16 v[136:139], v[176:179], v[48:51], v[136:139]
    ds_read_b128 v[172:175], v28 offset:2048
    s_waitcnt vmcnt(8)
    s_waitcnt lgkmcnt(7)
    v_mfma_f32_16x16x32_bf16 v[120:123], v[180:183], v[52:55], v[120:123]
    ds_read_b128 v[176:179], v28 offset:3072
    s_waitcnt lgkmcnt(7)
    v_mfma_f32_16x16x32_bf16 v[124:127], v[184:187], v[52:55], v[124:127]
    ds_read_b128 v[180:183], v28 offset:4096
    s_waitcnt lgkmcnt(7)
    v_mfma_f32_16x16x32_bf16 v[128:131], v[188:191], v[52:55], v[128:131]
    ds_read_b128 v[184:187], v28 offset:10240
    s_waitcnt lgkmcnt(7)
    v_mfma_f32_16x16x32_bf16 v[132:135], v[156:159], v[52:55], v[132:135]
    ds_read_b128 v[188:191], v28 offset:11264
    s_waitcnt lgkmcnt(7)
    v_mfma_f32_16x16x32_bf16 v[136:139], v[160:163], v[52:55], v[136:139]
    ds_read_b128 v[156:159], v28 offset:12288
    s_waitcnt vmcnt(7)
    s_waitcnt lgkmcnt(7)
    v_mfma_f32_16x16x32_bf16 v[120:123], v[164:167], v[72:75], v[120:123]
    ds_read_b128 v[160:163], v28 offset:13312
    s_waitcnt lgkmcnt(7)
    v_mfma_f32_16x16x32_bf16 v[124:127], v[168:171], v[72:75], v[124:127]
    ds_read_b128 v[164:167], v28 offset:14336
    s_waitcnt lgkmcnt(7)
    v_mfma_f32_16x16x32_bf16 v[128:131], v[172:175], v[72:75], v[128:131]
    ds_read_b128 v[168:171], v28 offset:20480
    s_waitcnt lgkmcnt(7)
    v_mfma_f32_16x16x32_bf16 v[132:135], v[176:179], v[72:75], v[132:135]
    ds_read_b128 v[172:175], v28 offset:21504
    s_waitcnt lgkmcnt(7)
    v_mfma_f32_16x16x32_bf16 v[136:139], v[180:183], v[72:75], v[136:139]
    ds_read_b128 v[176:179], v28 offset:22528
    s_waitcnt vmcnt(6)
    s_waitcnt lgkmcnt(7)
    v_mfma_f32_16x16x32_bf16 v[120:123], v[184:187], v[76:79], v[120:123]
    ds_read_b128 v[180:183], v28 offset:23552
    s_waitcnt lgkmcnt(7)
    v_mfma_f32_16x16x32_bf16 v[124:127], v[188:191], v[76:79], v[124:127]
    ds_read_b128 v[184:187], v28 offset:24576
    s_waitcnt lgkmcnt(7)
    v_mfma_f32_16x16x32_bf16 v[128:131], v[156:159], v[76:79], v[128:131]
    ds_read_b128 v[188:191], v28 offset:30720
    s_waitcnt lgkmcnt(7)
    v_mfma_f32_16x16x32_bf16 v[132:135], v[160:163], v[76:79], v[132:135]
    ds_read_b128 v[156:159], v28 offset:31744
    s_waitcnt lgkmcnt(7)
    v_mfma_f32_16x16x32_bf16 v[136:139], v[164:167], v[76:79], v[136:139]
    ds_read_b128 v[160:163], v28 offset:32768
    s_waitcnt vmcnt(5)
    s_waitcnt lgkmcnt(7)
    v_mfma_f32_16x16x32_bf16 v[120:123], v[168:171], v[80:83], v[120:123]
    ds_read_b128 v[164:167], v28 offset:33792
    s_waitcnt lgkmcnt(7)
    v_mfma_f32_16x16x32_bf16 v[124:127], v[172:175], v[80:83], v[124:127]
    ds_read_b128 v[168:171], v28 offset:34816
    s_waitcnt lgkmcnt(7)
    v_mfma_f32_16x16x32_bf16 v[128:131], v[176:179], v[80:83], v[128:131]
    ds_read_b128 v[172:175], v28 offset:40960
    s_waitcnt lgkmcnt(7)
    v_mfma_f32_16x16x32_bf16 v[132:135], v[180:183], v[80:83], v[132:135]
    ds_read_b128 v[176:179], v28 offset:41984
    s_waitcnt lgkmcnt(7)
    v_mfma_f32_16x16x32_bf16 v[136:139], v[184:187], v[80:83], v[136:139]
    ds_read_b128 v[180:183], v28 offset:43008
    s_waitcnt vmcnt(4)
    s_waitcnt lgkmcnt(7)
    v_mfma_f32_16x16x32_bf16 v[120:123], v[188:191], v[84:87], v[120:123]
    ds_read_b128 v[184:187], v27 offset:44032
    s_waitcnt lgkmcnt(7)
    v_mfma_f32_16x16x32_bf16 v[124:127], v[156:159], v[84:87], v[124:127]
    ds_read_b128 v[188:191], v27 offset:45056
    s_waitcnt lgkmcnt(7)
    v_mfma_f32_16x16x32_bf16 v[128:131], v[160:163], v[84:87], v[128:131]
    ds_read_b128 v[156:159], v32 offset:10240
    s_waitcnt lgkmcnt(7)
    v_mfma_f32_16x16x32_bf16 v[132:135], v[164:167], v[84:87], v[132:135]
    ds_read_b128 v[160:163], v32 offset:11264
    s_waitcnt lgkmcnt(7)
    v_mfma_f32_16x16x32_bf16 v[136:139], v[168:171], v[84:87], v[136:139]
    ds_read_b128 v[164:167], v32 offset:12288
    s_waitcnt vmcnt(3)
    s_waitcnt lgkmcnt(7)
    v_mfma_f32_16x16x32_bf16 v[120:123], v[172:175], v[88:91], v[120:123]
    ds_read_b128 v[168:171], v32 offset:13312
    s_waitcnt lgkmcnt(7)
    v_mfma_f32_16x16x32_bf16 v[124:127], v[176:179], v[88:91], v[124:127]
    ds_read_b128 v[172:175], v32 offset:14336
    s_waitcnt lgkmcnt(7)
    v_mfma_f32_16x16x32_bf16 v[128:131], v[180:183], v[88:91], v[128:131]
    ds_read_b128 v[176:179], v32 offset:20480
    s_waitcnt lgkmcnt(7)
    v_mfma_f32_16x16x32_bf16 v[132:135], v[184:187], v[88:91], v[132:135]
    ds_read_b128 v[180:183], v32 offset:21504
    s_waitcnt lgkmcnt(7)
    v_mfma_f32_16x16x32_bf16 v[136:139], v[188:191], v[88:91], v[136:139]
    ds_read_b128 v[184:187], v32 offset:22528
    s_waitcnt vmcnt(2)
    s_waitcnt lgkmcnt(7)
    v_mfma_f32_16x16x32_bf16 v[120:123], v[156:159], v[92:95], v[120:123]
    ds_read_b128 v[188:191], v32 offset:23552
    s_waitcnt lgkmcnt(7)
    v_mfma_f32_16x16x32_bf16 v[124:127], v[160:163], v[92:95], v[124:127]
    ds_read_b128 v[156:159], v32 offset:24576
    s_waitcnt lgkmcnt(7)
    v_mfma_f32_16x16x32_bf16 v[128:131], v[164:167], v[92:95], v[128:131]
    ds_read_b128 v[160:163], v32 offset:30720
    s_waitcnt lgkmcnt(7)
    v_mfma_f32_16x16x32_bf16 v[132:135], v[168:171], v[92:95], v[132:135]
    ds_read_b128 v[164:167], v32 offset:31744
    s_waitcnt lgkmcnt(7)
    v_mfma_f32_16x16x32_bf16 v[136:139], v[172:175], v[92:95], v[136:139]
    ds_read_b128 v[168:171], v32 offset:32768
    s_waitcnt vmcnt(1)
    s_waitcnt lgkmcnt(7)
    v_mfma_f32_16x16x32_bf16 v[120:123], v[176:179], v[96:99], v[120:123]
    ds_read_b128 v[172:175], v32 offset:33792
    s_waitcnt lgkmcnt(7)
    v_mfma_f32_16x16x32_bf16 v[124:127], v[180:183], v[96:99], v[124:127]
    ds_read_b128 v[176:179], v32 offset:34816
    s_waitcnt lgkmcnt(7)
    v_mfma_f32_16x16x32_bf16 v[128:131], v[184:187], v[96:99], v[128:131]
    s_waitcnt lgkmcnt(6)
    v_mfma_f32_16x16x32_bf16 v[132:135], v[188:191], v[96:99], v[132:135]
    s_waitcnt lgkmcnt(5)
    v_mfma_f32_16x16x32_bf16 v[136:139], v[156:159], v[96:99], v[136:139]
    s_waitcnt vmcnt(0)
    s_waitcnt lgkmcnt(4)
    v_mfma_f32_16x16x32_bf16 v[120:123], v[160:163], v[100:103], v[120:123]
    s_waitcnt lgkmcnt(3)
    v_mfma_f32_16x16x32_bf16 v[124:127], v[164:167], v[100:103], v[124:127]
    s_waitcnt lgkmcnt(2)
    v_mfma_f32_16x16x32_bf16 v[128:131], v[168:171], v[100:103], v[128:131]
    s_waitcnt lgkmcnt(1)
    v_mfma_f32_16x16x32_bf16 v[132:135], v[172:175], v[100:103], v[132:135]
    s_waitcnt lgkmcnt(0)
    v_mfma_f32_16x16x32_bf16 v[136:139], v[176:179], v[100:103], v[136:139]
    s_mul_i32 s50, s48, 5120
    s_add_u32 s50, s50, 90112
    v_add_u32 v30, s50, v34
    v_and_b32 v31, 15, v24
    v_mul_u32_u24 v36, 1280, v31
    v_and_b32 v31, 16, v24
    v_lshl_add_u32 v36, v31, 1, v36
    v_lshl_add_u32 v36, v26, 4, v36
    s_cmp_eq_u32 s49, 0
    s_cbranch_scc1 L_p3_lo

    ds_write_b128 v30, v[120:123] offset:0
    ds_write_b128 v30, v[124:127] offset:1024
    ds_write_b128 v30, v[128:131] offset:2048
    s_waitcnt lgkmcnt(0)
    s_barrier
    ds_read_b128 v[168:171], v30 offset:3072
    ds_read_b128 v[172:175], v30 offset:4096
    s_waitcnt lgkmcnt(1)
    v_pk_add_f32 v[132:133], v[132:133], v[168:169]
    v_pk_add_f32 v[134:135], v[134:135], v[170:171]
    v_cvt_pk_bf16_f32 v132, v132, v133
    v_cvt_pk_bf16_f32 v133, v134, v135
    s_waitcnt lgkmcnt(0)
    v_pk_add_f32 v[136:137], v[136:137], v[172:173]
    v_pk_add_f32 v[138:139], v[138:139], v[174:175]
    v_cvt_pk_bf16_f32 v134, v136, v137
    v_cvt_pk_bf16_f32 v135, v138, v139
    s_nop 1
    v_permlane16_swap_b32 v132, v134
    v_permlane16_swap_b32 v133, v135
    buffer_store_dwordx4 v[132:135], v36, s[12:15], s53 offen offset:96
    s_branch L_p3_done
L_p3_lo:
    ds_write_b128 v30, v[132:135] offset:3072
    ds_write_b128 v30, v[136:139] offset:4096
    s_waitcnt lgkmcnt(0)
    s_barrier
    ds_read_b128 v[156:159], v30 offset:0
    ds_read_b128 v[160:163], v30 offset:1024
    ds_read_b128 v[164:167], v30 offset:2048
    s_waitcnt lgkmcnt(2)
    v_pk_add_f32 v[120:121], v[120:121], v[156:157]
    v_pk_add_f32 v[122:123], v[122:123], v[158:159]
    v_cvt_pk_bf16_f32 v120, v120, v121
    v_cvt_pk_bf16_f32 v121, v122, v123
    s_waitcnt lgkmcnt(1)
    v_pk_add_f32 v[124:125], v[124:125], v[160:161]
    v_pk_add_f32 v[126:127], v[126:127], v[162:163]
    v_cvt_pk_bf16_f32 v122, v124, v125
    v_cvt_pk_bf16_f32 v123, v126, v127
    s_nop 1
    v_permlane16_swap_b32 v120, v122
    v_permlane16_swap_b32 v121, v123
    buffer_store_dwordx4 v[120:123], v36, s[12:15], s53 offen offset:0
    s_waitcnt lgkmcnt(0)
    v_pk_add_f32 v[128:129], v[128:129], v[164:165]
    v_pk_add_f32 v[130:131], v[130:131], v[166:167]
    v_cvt_pk_bf16_f32 v128, v128, v129
    v_cvt_pk_bf16_f32 v129, v130, v131
    buffer_store_dwordx2 v[128:129], v35, s[12:15], s53 offen offset:64
L_p3_done:
L_end:
    s_endpgm
L_k2_slow:
    s_cmp_eq_u32 s49, 0
    s_cbranch_scc1 L_k2_slow_q

    v_mov_b32 v40, v46
    v_mov_b32 v41, v47
    v_mov_b32 v42, v48
    v_mov_b32 v43, v49
    v_mov_b32 v44, v50
    v_mov_b32 v45, v51
L_k2_slow_q:
    s_mov_b64 exec, s[38:39]
    v_mov_b32 v44, 0
    v_mov_b32 v45, 0
    s_mov_b64 exec, -1
    v_and_b32 v30, 0x13, v25
    v_and_b32 v31, 4, v25
    v_lshl_or_b32 v30, v31, 1, v30
    v_and_b32 v31, 8, v25
    v_lshrrev_b32 v31, 1, v31
    v_or_b32 v30, v30, v31
    v_sub_u32 v30, v30, v25
    v_lshlrev_b32 v30, 4, v30
    v_add_u32 v28, v30, v38
    v_add_u32 v29, v30, v27
    v_mov_b32 v37, 0xff800000

    v_mov_b32 v116, 0
    v_mov_b32 v117, 0
    v_mov_b32 v118, 0
    v_mov_b32 v119, 0
    v_mov_b32 v120, 0
    v_mov_b32 v121, 0
    v_mov_b32 v122, 0
    v_mov_b32 v123, 0
    v_mov_b32 v124, 0
    v_mov_b32 v125, 0
    v_mov_b32 v126, 0
    v_mov_b32 v127, 0
    v_mov_b32 v128, 0
    v_mov_b32 v129, 0
    v_mov_b32 v130, 0
    v_mov_b32 v131, 0
    s_add_u32 s40, s57, 10485760
    s_mov_b32 s42, 64

L_k2_slow1:
    buffer_load_dwordx4 v[52:55], v28, s[8:11], s40 offen sc1
    buffer_load_dwordx2 v[56:57], v29, s[8:11], s40 offen sc1
    s_add_u32 s40, s40, 512
    s_waitcnt vmcnt(0)
    v_mfma_f32_32x32x16_bf16 v[68:83], v[52:55], v[40:43], 0
    v_mfma_f32_32x32x8_bf16 v[68:83], v[56:57], v[44:45], v[68:83]
    s_nop 11

    v_max3_f32 v37, v37, v68, v69
    v_max3_f32 v37, v37, v70, v71
    v_max3_f32 v37, v37, v72, v73
    v_max3_f32 v37, v37, v74, v75
    v_max3_f32 v37, v37, v76, v77
    v_max3_f32 v37, v37, v78, v79
    v_max3_f32 v37, v37, v80, v81
    v_max3_f32 v37, v37, v82, v83
    s_sub_u32 s42, s42, 1
    s_cmp_lg_u32 s42, 0
    s_cbranch_scc1 L_k2_slow1
    v_mov_b32 v31, v37
    s_nop 1
    v_permlane32_swap_b32 v37, v31
    s_nop 0
    v_max_f32 v37, v37, v31
    s_add_u32 s40, s57, 10485760
    s_add_u32 s41, s53, 13107200
    s_mov_b32 s42, 64

L_k2_slow2:
    s_mov_b64 exec, s[34:35]
    buffer_load_dwordx4 v[60:63], v58, s[8:11], s41 offen sc1
    buffer_load_dwordx4 v[64:67], v58, s[8:11], s41 offen offset:640 sc1
    s_mov_b64 exec, -1
    s_add_u32 s41, s41, 1280

    buffer_load_dwordx4 v[52:55], v28, s[8:11], s40 offen sc1
    buffer_load_dwordx2 v[56:57], v29, s[8:11], s40 offen sc1
    s_add_u32 s40, s40, 512
    s_waitcnt vmcnt(0)
    v_mfma_f32_32x32x16_bf16 v[68:83], v[52:55], v[40:43], 0
    v_mfma_f32_32x32x8_bf16 v[68:83], v[56:57], v[44:45], v[68:83]
    s_nop 11

    v_sub_f32 v68, v68, v37
    v_sub_f32 v69, v69, v37
    v_sub_f32 v70, v70, v37
    v_sub_f32 v71, v71, v37
    v_sub_f32 v72, v72, v37
    v_sub_f32 v73, v73, v37
    v_sub_f32 v74, v74, v37
    v_sub_f32 v75, v75, v37
    v_sub_f32 v76, v76, v37
    v_sub_f32 v77, v77, v37
    v_sub_f32 v78, v78, v37
    v_sub_f32 v79, v79, v37
    v_sub_f32 v80, v80, v37
    v_sub_f32 v81, v81, v37
    v_sub_f32 v82, v82, v37
    v_sub_f32 v83, v83, v37
    v_exp_f32 v68, v68
    v_exp_f32 v69, v69
    v_exp_f32 v70, v70
    v_exp_f32 v71, v71
    v_exp_f32 v72, v72
    v_exp_f32 v73, v73
    v_exp_f32 v74, v74
    v_exp_f32 v75, v75
    v_exp_f32 v76, v76
    v_exp_f32 v77, v77
    v_exp_f32 v78, v78
    v_exp_f32 v79, v79
    v_exp_f32 v80, v80
    v_exp_f32 v81, v81
    v_exp_f32 v82, v82
    v_exp_f32 v83, v83
    s_nop 0
    v_cvt_pk_bf16_f32 v100, v68, v69
    v_cvt_pk_bf16_f32 v101, v70, v71
    v_cvt_pk_bf16_f32 v102, v72, v73
    v_cvt_pk_bf16_f32 v103, v74, v75
    v_cvt_pk_bf16_f32 v104, v76, v77
    v_cvt_pk_bf16_f32 v105, v78, v79
    v_cvt_pk_bf16_f32 v106, v80, v81
    v_cvt_pk_bf16_f32 v107, v82, v83
    s_nop 1
    v_mfma_f32_32x32x16_bf16 v[116:131], v[60:63], v[100:103], v[116:131]
    v_mfma_f32_32x32x16_bf16 v[116:131], v[64:67], v[104:107], v[116:131]
    s_sub_u32 s42, s42, 1
    s_cmp_lg_u32 s42, 0
    s_cbranch_scc1 L_k2_slow2
    s_nop 11
    v_mov_b32 v128, v124
    v_mov_b32 v31, v124
    s_nop 1
    v_permlane32_swap_b32 v31, v128
    s_nop 0
    s_branch L_k2_bfin

L_code_end:
.section .rodata,"a"
.p2align 6
.amdhsa_kernel gated_mix__linear_kernel_hedgehog__softmax_full_mha__prompt_kernel
  .amdhsa_next_free_vgpr 256
  .amdhsa_next_free_sgpr 102
  .amdhsa_accum_offset 256
  .amdhsa_group_segment_fixed_size 0
  .amdhsa_kernarg_size 88
  .amdhsa_user_sgpr_count 2
  .amdhsa_user_sgpr_kernarg_segment_ptr 1
  .amdhsa_system_sgpr_workgroup_id_x 1
.end_amdhsa_kernel
```
